```python
import torch

def _softmax(x, axis=-1):
    return torch.softmax(x, dim=axis)
def _gelu(x):
    return torch.nn.functional.gelu(x, approximate="tanh")
def _silu(x):
    return torch.nn.functional.silu(x)
def _sigmoid(x):
    return torch.sigmoid(x)
def _layernorm(x, axis=-1, eps=1e-5):
    m = x.mean(dim=axis, keepdim=True)
    v = x.var(dim=axis, keepdim=True, unbiased=False)
    return (x - m) / torch.sqrt(v + eps)
def _scatter_add(tgt, idx, src, axis=0):
    return tgt.clone().index_add_(axis, idx, src)
def _segment_sum(src, seg, n):
    out = torch.zeros((n,) + src.shape[1:], dtype=src.dtype)
    return out.index_add_(0, seg, src)
def _pad(x, pw):
    flat = tuple(v for pair in reversed(pw) for v in pair)
    return torch.nn.functional.pad(x, flat)

kernel_name = 'gated_mix__ssm_conv_s5__mixer_token_mlp__prompt'

def setup_inputs():

    _w = (lambda a: (lambda t: t.to(torch.bfloat16) if t.is_floating_point() else t)(torch.as_tensor(a)))
    def _A_setup():
        B, S, D = 1, 2048, 512
        P = D
        Lambda_re = -0.5 * (lambda _x: torch.exp(torch.as_tensor(_x)))((lambda *s: torch.randn(*s, dtype=torch.bfloat16) * 0.2)(P))
        Lambda_im = (lambda *s: torch.randn(*s, dtype=torch.bfloat16) * 0.4)(P) * 1.0
        B_re = (lambda *s: torch.randn(*s, dtype=torch.bfloat16) * 0.2)(P, D) * (D ** -0.5)
        B_im = (lambda *s: torch.randn(*s, dtype=torch.bfloat16) * 0.2)(P, D) * (D ** -0.5)
        C_re = (lambda *s: torch.randn(*s, dtype=torch.bfloat16) * 0.2)(D, P) * (P ** -0.5)
        C_im = (lambda *s: torch.randn(*s, dtype=torch.bfloat16) * 0.2)(D, P) * (P ** -0.5)
        log_dt = (lambda *s: torch.randn(*s, dtype=torch.bfloat16) * 0.2)(P) * 0.3 - 2.0
        Dskip = (lambda *s: torch.randn(*s, dtype=torch.bfloat16) * 0.05)(D)
        return {
            "x": _w((lambda *s: torch.randn(*s, dtype=torch.bfloat16) * 0.05)(B, S, D)),
            "Lambda_re": _w(Lambda_re),
            "Lambda_im": _w(Lambda_im),
            "B_re": _w(B_re),
            "B_im": _w(B_im),
            "C_re": _w(C_re),
            "C_im": _w(C_im),
            "log_dt": _w(log_dt),
            "Dskip": _w(Dskip),
        }
    _A_in = _A_setup()

    def _B_setup():
        B, S, D, F = 1, 2048, 512, 1376
        return {
            "x": _w((lambda *s: torch.randn(*s, dtype=torch.bfloat16) * 0.05)(B, S, D)),
            "w1": _w((lambda *s: torch.randn(*s, dtype=torch.bfloat16) * 0.2)(S, F) * (S ** -0.5)),
            "b1": _w((lambda *s: torch.randn(*s, dtype=torch.bfloat16) * 3.2)(F) * 0.02),
            "w2": _w((lambda *s: torch.randn(*s, dtype=torch.bfloat16) * 0.05)(F, S) * (F ** -0.5)),
            "b2": _w((lambda *s: torch.randn(*s, dtype=torch.bfloat16) * 0.1)(S) * 0.02),
        }
    _B_in = _B_setup()

    return {
        "A_x": _A_in["x"],
        "A_Lambda_re": _A_in["Lambda_re"],
        "A_Lambda_im": _A_in["Lambda_im"],
        "A_B_re": _A_in["B_re"],
        "A_B_im": _A_in["B_im"],
        "A_C_re": _A_in["C_re"],
        "A_C_im": _A_in["C_im"],
        "A_log_dt": _A_in["log_dt"],
        "A_Dskip": _A_in["Dskip"],
        "B_x": _B_in["x"],
        "B_w1": _B_in["w1"],
        "B_b1": _B_in["b1"],
        "B_w2": _B_in["w2"],
        "B_b2": _B_in["b2"],
        "gate_w": _w((lambda *s: torch.randn(*s, dtype=torch.bfloat16) * 0.05)(512) * 16.0),
    }

def reference(A_x, A_Lambda_re, A_Lambda_im, A_B_re, A_B_im, A_C_re, A_C_im, A_log_dt, A_Dskip, B_x, B_w1, B_b1, B_w2, B_b2, gate_w):
    def _A_ref(x, Lambda_re, Lambda_im, B_re, B_im, C_re, C_im, log_dt, Dskip):
        Bsz, L, H = x.shape
        Lam = Lambda_re + 1j * Lambda_im
        Bmat = B_re + 1j * B_im
        Cmat = C_re + 1j * C_im
        dt = torch.exp(log_dt)
        Lam_bar = torch.exp(dt * Lam)
        B_bar = ((Lam_bar - 1.0) / Lam)[:, None] * Bmat
        Bu = torch.einsum("bld,pd->blp", x + 0j, B_bar)
        h = torch.zeros_like(Bu[:, 0, :])
        hs = []
        for t in range(L):
            h = Lam_bar[None, :] * h + Bu[:, t, :]
            hs.append(h)
        hseq = torch.stack(hs, 1)
        y = 2.0 * torch.einsum("blp,dp->bld", hseq, Cmat).real + x * Dskip[None, None, :]
        return y

    def _B_ref(x, w1, b1, w2, b2):
        B, S, D = x.shape
        h = _layernorm(x, axis=-1)
        u = torch.einsum("bsd,sf->bdf", h, w1) + b1
        u = _gelu(u)
        y = torch.einsum("bdf,fs->bds", u, w2) + b2
        return (lambda x, *d: x.permute(*d))(y, 0, 2, 1)

    x = A_x
    g = _sigmoid((x * gate_w).sum(-1, keepdims=True))
    a = _A_ref(x, A_Lambda_re, A_Lambda_im, A_B_re, A_B_im, A_C_re, A_C_im, A_log_dt, A_Dskip)
    b = _B_ref(x, B_w1, B_b1, B_w2, B_b2)
    return g * a + (1 - g) * b
```

```asm
; @launch grid=(256,1,1) block=(256,1,1) lds=163840
.amdgcn_target "amdgcn-amd-amdhsa--gfx950"
.text
.globl gated_mix__ssm_conv_s5__mixer_token_mlp__prompt_kernel
.p2align 8
.type gated_mix__ssm_conv_s5__mixer_token_mlp__prompt_kernel,@function
gated_mix__ssm_conv_s5__mixer_token_mlp__prompt_kernel:
    s_cmp_ge_u32 s2, 256
    s_cbranch_scc1 L_end
    s_load_dwordx16 s[64:79], s[0:1], 0
    s_load_dwordx16 s[80:95], s[0:1], 64
    s_load_dwordx4 s[96:99], s[0:1], 128
    v_and_b32 v1, 63, v0
    v_lshrrev_b32 v2, 6, v0
    s_and_b32 s40, s2, 7
    s_lshr_b32 s41, s2, 3
    s_add_u32 s41, s41, 24
    s_and_b32 s41, s41, 31
    v_readfirstlane_b32 s3, v2
    s_lshr_b32 s52, s40, 1
    s_lshl_b32 s52, s52, 3
    s_and_b32 s43, s41, 7
    s_add_u32 s52, s52, s43
    s_and_b32 s53, s40, 1
    s_lshl_b32 s53, s53, 2
    s_lshr_b32 s43, s41, 3
    s_add_u32 s53, s53, s43
    s_mul_i32 s42, s3, 40960
    s_waitcnt lgkmcnt(0)
    s_mov_b32 s4, s96
    s_and_b32 s5, s97, 0xffff
    s_mov_b32 s6, 256
    s_mov_b32 s7, 0x00020000
    s_lshl_b32 s48, s2, 2
    s_add_u32 s48, s48, s3
    s_cmp_lg_u32 s48, 0
    s_cbranch_scc1 L_nonw
    s_memrealtime s[100:101]
    s_mov_b64 exec, 1
    s_waitcnt lgkmcnt(0)
    s_or_b32 s100, s100, 1
    v_mov_b32 v14, s100
    v_mov_b32 v15, s101
    buffer_store_dwordx2 v[14:15], off, s[4:7], 0 sc1
    s_mov_b64 exec, -1
L_nonw:
    s_cmp_ge_u32 s41, 24
    s_cbranch_scc1 L_apath
    s_cmp_ge_u32 s40, 4
    s_cselect_b32 s47, 20, 24
    s_cmp_ge_u32 s41, s47
    s_cbranch_scc1 L_lpath
    s_mov_b32 s8, s64
    s_and_b32 s9, s65, 0xffff
    s_mov_b32 s10, 2097152
    s_mov_b32 s11, 0x00020000
    s_mov_b32 s12, s92
    s_and_b32 s13, s93, 0xffff
    s_mov_b32 s14, 1024
    s_mov_b32 s15, 0x00020000
    s_mul_i32 s54, s40, 24
    s_mul_i32 s44, s40, 20
    s_add_u32 s44, s44, 16
    s_cmp_ge_u32 s40, 4
    s_cselect_b32 s54, s44, s54
    s_add_u32 s54, s54, s41
    s_mul_i32 s45, s54, 3
    s_add_u32 s45, s45, s3
    s_min_u32 s45, s45, 511
    s_lshl_b32 s43, s45, 12
    v_lshlrev_b32 v30, 4, v1
    s_cmp_eq_u32 s3, 3
    s_cbranch_scc1 L_lnl_1
    s_add_u32 s44, s43, 0
    buffer_load_dwordx4 v[32:35], v30, s[8:11], s44 offen
    s_add_u32 s44, s43, 1024
    buffer_load_dwordx4 v[36:39], v30, s[8:11], s44 offen
    s_add_u32 s44, s43, 2048
    buffer_load_dwordx4 v[40:43], v30, s[8:11], s44 offen
    s_add_u32 s44, s43, 3072
    buffer_load_dwordx4 v[44:47], v30, s[8:11], s44 offen
    buffer_load_dwordx4 v[48:51], v30, s[12:15], 0 offen
L_lnl_1:
    s_add_u32 s16, s98, 0
    s_addc_u32 s17, s99, 0
    s_and_b32 s17, s17, 0xffff
    s_mov_b32 s18, 2097152
    s_mov_b32 s19, 0x00020000
    s_add_u32 s20, s98, 2097152
    s_addc_u32 s21, s99, 0
    s_and_b32 s21, s21, 0xffff
    s_mov_b32 s22, 98304
    s_mov_b32 s23, 0x00020000
    s_cmp_ge_u32 s41, 8
    s_cselect_b32 s36, s72, s70
    s_cselect_b32 s37, s73, s71
    s_and_b32 s48, s40, 1
    s_lshl_b32 s48, s48, 18
    s_mov_b32 s38, 524288
    s_xor_b32 s50, s40, 1
    s_lshl_b32 s50, s50, 18
    s_cmp_ge_u32 s41, 16
    s_cselect_b32 s36, s64, s36
    s_cselect_b32 s37, s65, s37
    s_cselect_b32 s38, 2097152, s38
    s_cselect_b32 s48, s50, s48
    s_and_b32 s49, s41, 7
    s_and_b32 s37, s37, 0xffff
    s_mov_b32 s39, 0x00020000
    s_lshl_b32 s49, s49, 2
    s_add_u32 s49, s49, s3
    s_lshl_b32 s49, s49, 13
    s_add_u32 s48, s48, s49
    v_lshlrev_b32 v18, 7, v1
    buffer_load_dword v5, v18, s[36:39], s48 offen
    buffer_load_dwordx2 v[28:29], off, s[4:7], 0 sc1
    s_lshr_b32 s46, s40, 1
    s_mul_i32 s55, s46, 6
    s_cmp_eq_u32 s46, 3
    s_cselect_b32 s55, 17, s55
    s_lshr_b32 s46, s41, 2
    s_add_u32 s55, s55, s46
    s_and_b32 s56, s40, 1
    s_lshl_b32 s56, s56, 2
    s_and_b32 s47, s41, 3
    s_add_u32 s56, s56, s47
    s_mov_b32 s24, s84
    s_and_b32 s25, s85, 0xffff
    s_mov_b32 s26, 5636096
    s_mov_b32 s27, 0x00020000
    s_mul_i32 s57, s3, 1409024
    s_lshl_b32 s44, s55, 7
    s_add_u32 s57, s57, s44
    v_lshrrev_b32 v14, 3, v1
    v_mul_u32_u24 v14, 2752, v14
    v_and_b32 v15, 7, v1
    v_lshrrev_b32 v16, 2, v1
    v_and_b32 v16, 4, v16
    v_xor_b32 v15, v15, v16
    v_lshl_add_u32 v4, v15, 4, v14
    v_lshrrev_b32 v14, 5, v1
    v_lshlrev_b32 v14, 3, v14
    v_lshrrev_b32 v15, 2, v1
    v_and_b32 v15, 3, v15
    v_add_u32 v14, v14, v15
    v_lshlrev_b32 v14, 7, v14
    v_lshrrev_b32 v16, 4, v1
    v_and_b32 v16, 1, v16
    v_lshlrev_b32 v16, 1, v16
    v_lshrrev_b32 v17, 1, v1
    v_and_b32 v17, 1, v17
    v_add_u32 v16, v16, v17
    v_lshrrev_b32 v15, 1, v15
    v_lshlrev_b32 v15, 2, v15
    v_xor_b32 v16, v16, v15
    v_lshl_add_u32 v14, v16, 4, v14
    v_and_b32 v17, 1, v1
    v_lshl_add_u32 v14, v17, 3, v14
    v_add_u32 v10, s42, v14
    v_xor_b32 v11, 64, v10
    s_cmp_eq_u32 s3, 3
    s_cbranch_scc1 L_ln3_2
    s_waitcnt vmcnt(2)
    buffer_load_dwordx2 v[28:29], off, s[4:7], 0 sc1
    v_lshlrev_b32 v60, 16, v32
    v_lshlrev_b32 v68, 16, v36
    v_lshlrev_b32 v76, 16, v40
    v_lshlrev_b32 v84, 16, v44
    v_lshlrev_b32 v52, 16, v48
    v_and_b32 v53, 0xffff0000, v48
    v_lshlrev_b32 v54, 16, v49
    v_and_b32 v55, 0xffff0000, v49
    v_lshlrev_b32 v56, 16, v50
    v_and_b32 v57, 0xffff0000, v50
    v_lshlrev_b32 v58, 16, v51
    v_and_b32 v59, 0xffff0000, v51
    v_readfirstlane_b32 s48, v60
    v_readfirstlane_b32 s50, v68
    v_readfirstlane_b32 s0, v76
    v_readfirstlane_b32 s82, v84
    s_mov_b32 s46, 0x3f803f80
    v_and_b32 v61, 0xffff0000, v32
    v_lshlrev_b32 v62, 16, v33
    v_and_b32 v63, 0xffff0000, v33
    v_lshlrev_b32 v64, 16, v34
    v_and_b32 v65, 0xffff0000, v34
    v_lshlrev_b32 v66, 16, v35
    v_and_b32 v67, 0xffff0000, v35
    v_and_b32 v69, 0xffff0000, v36
    v_lshlrev_b32 v70, 16, v37
    v_and_b32 v71, 0xffff0000, v37
    v_lshlrev_b32 v72, 16, v38
    v_and_b32 v73, 0xffff0000, v38
    v_lshlrev_b32 v74, 16, v39
    v_and_b32 v75, 0xffff0000, v39
    v_and_b32 v77, 0xffff0000, v40
    v_lshlrev_b32 v78, 16, v41
    v_and_b32 v79, 0xffff0000, v41
    v_lshlrev_b32 v80, 16, v42
    v_and_b32 v81, 0xffff0000, v42
    v_lshlrev_b32 v82, 16, v43
    v_and_b32 v83, 0xffff0000, v43
    v_and_b32 v85, 0xffff0000, v44
    v_lshlrev_b32 v86, 16, v45
    v_and_b32 v87, 0xffff0000, v45
    v_lshlrev_b32 v88, 16, v46
    v_and_b32 v89, 0xffff0000, v46
    v_lshlrev_b32 v90, 16, v47
    v_and_b32 v91, 0xffff0000, v47
    v_pk_add_f32 v[108:109], v[60:61], s[48:49] op_sel_hi:[1,0] neg_lo:[0,1] neg_hi:[0,1]
    v_pk_add_f32 v[110:111], v[68:69], s[50:51] op_sel_hi:[1,0] neg_lo:[0,1] neg_hi:[0,1]
    v_pk_add_f32 v[112:113], v[76:77], s[0:1] op_sel_hi:[1,0] neg_lo:[0,1] neg_hi:[0,1]
    v_pk_add_f32 v[114:115], v[84:85], s[82:83] op_sel_hi:[1,0] neg_lo:[0,1] neg_hi:[0,1]
    v_pk_mul_f32 v[92:93], v[60:61], v[52:53]
    v_pk_mul_f32 v[94:95], v[68:69], v[52:53]
    v_pk_mul_f32 v[96:97], v[76:77], v[52:53]
    v_pk_mul_f32 v[98:99], v[84:85], v[52:53]
    v_pk_mul_f32 v[100:101], v[108:109], v[108:109]
    v_pk_mul_f32 v[102:103], v[110:111], v[110:111]
    v_pk_mul_f32 v[104:105], v[112:113], v[112:113]
    v_pk_mul_f32 v[106:107], v[114:115], v[114:115]
    v_cvt_pk_bf16_f32 v92, v92, v93
    v_cvt_pk_bf16_f32 v94, v94, v95
    v_cvt_pk_bf16_f32 v96, v96, v97
    v_cvt_pk_bf16_f32 v98, v98, v99
    v_dot2_f32_bf16 v116, v92, s46, 0
    v_dot2_f32_bf16 v117, v94, s46, 0
    v_dot2_f32_bf16 v118, v96, s46, 0
    v_dot2_f32_bf16 v119, v98, s46, 0
    v_pk_add_f32 v[120:121], v[62:63], s[48:49] op_sel_hi:[1,0] neg_lo:[0,1] neg_hi:[0,1]
    v_pk_add_f32 v[122:123], v[70:71], s[50:51] op_sel_hi:[1,0] neg_lo:[0,1] neg_hi:[0,1]
    v_pk_add_f32 v[124:125], v[78:79], s[0:1] op_sel_hi:[1,0] neg_lo:[0,1] neg_hi:[0,1]
    v_pk_add_f32 v[126:127], v[86:87], s[82:83] op_sel_hi:[1,0] neg_lo:[0,1] neg_hi:[0,1]
    v_pk_mul_f32 v[92:93], v[62:63], v[54:55]
    v_pk_mul_f32 v[94:95], v[70:71], v[54:55]
    v_pk_mul_f32 v[96:97], v[78:79], v[54:55]
    v_pk_mul_f32 v[98:99], v[86:87], v[54:55]
    v_pk_fma_f32 v[100:101], v[120:121], v[120:121], v[100:101]
    v_pk_fma_f32 v[102:103], v[122:123], v[122:123], v[102:103]
    v_pk_fma_f32 v[104:105], v[124:125], v[124:125], v[104:105]
    v_pk_fma_f32 v[106:107], v[126:127], v[126:127], v[106:107]
    v_cvt_pk_bf16_f32 v92, v92, v93
    v_cvt_pk_bf16_f32 v94, v94, v95
    v_cvt_pk_bf16_f32 v96, v96, v97
    v_cvt_pk_bf16_f32 v98, v98, v99
    v_pk_add_f32 v[108:109], v[108:109], v[120:121]
    v_pk_add_f32 v[110:111], v[110:111], v[122:123]
    v_pk_add_f32 v[112:113], v[112:113], v[124:125]
    v_pk_add_f32 v[114:115], v[114:115], v[126:127]
    v_dot2_f32_bf16 v116, v92, s46, v116
    v_dot2_f32_bf16 v117, v94, s46, v117
    v_dot2_f32_bf16 v118, v96, s46, v118
    v_dot2_f32_bf16 v119, v98, s46, v119
    v_pk_add_f32 v[120:121], v[64:65], s[48:49] op_sel_hi:[1,0] neg_lo:[0,1] neg_hi:[0,1]
    v_pk_add_f32 v[122:123], v[72:73], s[50:51] op_sel_hi:[1,0] neg_lo:[0,1] neg_hi:[0,1]
    v_pk_add_f32 v[124:125], v[80:81], s[0:1] op_sel_hi:[1,0] neg_lo:[0,1] neg_hi:[0,1]
    v_pk_add_f32 v[126:127], v[88:89], s[82:83] op_sel_hi:[1,0] neg_lo:[0,1] neg_hi:[0,1]
    v_pk_mul_f32 v[92:93], v[64:65], v[56:57]
    v_pk_mul_f32 v[94:95], v[72:73], v[56:57]
    v_pk_mul_f32 v[96:97], v[80:81], v[56:57]
    v_pk_mul_f32 v[98:99], v[88:89], v[56:57]
    v_pk_fma_f32 v[100:101], v[120:121], v[120:121], v[100:101]
    v_pk_fma_f32 v[102:103], v[122:123], v[122:123], v[102:103]
    v_pk_fma_f32 v[104:105], v[124:125], v[124:125], v[104:105]
    v_pk_fma_f32 v[106:107], v[126:127], v[126:127], v[106:107]
    v_cvt_pk_bf16_f32 v92, v92, v93
    v_cvt_pk_bf16_f32 v94, v94, v95
    v_cvt_pk_bf16_f32 v96, v96, v97
    v_cvt_pk_bf16_f32 v98, v98, v99
    v_pk_add_f32 v[108:109], v[108:109], v[120:121]
    v_pk_add_f32 v[110:111], v[110:111], v[122:123]
    v_pk_add_f32 v[112:113], v[112:113], v[124:125]
    v_pk_add_f32 v[114:115], v[114:115], v[126:127]
    v_dot2_f32_bf16 v116, v92, s46, v116
    v_dot2_f32_bf16 v117, v94, s46, v117
    v_dot2_f32_bf16 v118, v96, s46, v118
    v_dot2_f32_bf16 v119, v98, s46, v119
    v_pk_add_f32 v[120:121], v[66:67], s[48:49] op_sel_hi:[1,0] neg_lo:[0,1] neg_hi:[0,1]
    v_pk_add_f32 v[122:123], v[74:75], s[50:51] op_sel_hi:[1,0] neg_lo:[0,1] neg_hi:[0,1]
    v_pk_add_f32 v[124:125], v[82:83], s[0:1] op_sel_hi:[1,0] neg_lo:[0,1] neg_hi:[0,1]
    v_pk_add_f32 v[126:127], v[90:91], s[82:83] op_sel_hi:[1,0] neg_lo:[0,1] neg_hi:[0,1]
    v_pk_mul_f32 v[92:93], v[66:67], v[58:59]
    v_pk_mul_f32 v[94:95], v[74:75], v[58:59]
    v_pk_mul_f32 v[96:97], v[82:83], v[58:59]
    v_pk_mul_f32 v[98:99], v[90:91], v[58:59]
    v_pk_fma_f32 v[100:101], v[120:121], v[120:121], v[100:101]
    v_pk_fma_f32 v[102:103], v[122:123], v[122:123], v[102:103]
    v_pk_fma_f32 v[104:105], v[124:125], v[124:125], v[104:105]
    v_pk_fma_f32 v[106:107], v[126:127], v[126:127], v[106:107]
    v_cvt_pk_bf16_f32 v92, v92, v93
    v_cvt_pk_bf16_f32 v94, v94, v95
    v_cvt_pk_bf16_f32 v96, v96, v97
    v_cvt_pk_bf16_f32 v98, v98, v99
    v_pk_add_f32 v[108:109], v[108:109], v[120:121]
    v_pk_add_f32 v[110:111], v[110:111], v[122:123]
    v_pk_add_f32 v[112:113], v[112:113], v[124:125]
    v_pk_add_f32 v[114:115], v[114:115], v[126:127]
    v_dot2_f32_bf16 v116, v92, s46, v116
    v_dot2_f32_bf16 v117, v94, s46, v117
    v_dot2_f32_bf16 v118, v96, s46, v118
    v_dot2_f32_bf16 v119, v98, s46, v119
    v_add_f32 v100, v100, v101
    v_add_f32 v108, v108, v109
    v_add_f32 v102, v102, v103
    v_add_f32 v110, v110, v111
    v_add_f32 v104, v104, v105
    v_add_f32 v112, v112, v113
    v_add_f32 v106, v106, v107
    v_add_f32 v114, v114, v115
    s_nop 1
    v_permlane32_swap_b32 v100, v104
    v_permlane32_swap_b32 v102, v106
    v_permlane32_swap_b32 v108, v112
    v_permlane32_swap_b32 v110, v114
    v_permlane32_swap_b32 v116, v118
    v_permlane32_swap_b32 v117, v119
    s_nop 1
    v_add_f32 v100, v100, v104
    v_add_f32 v102, v102, v106
    v_add_f32 v108, v108, v112
    v_add_f32 v110, v110, v114
    v_add_f32 v116, v116, v118
    v_add_f32 v117, v117, v119
    s_nop 1
    v_permlane16_swap_b32 v100, v102
    v_permlane16_swap_b32 v108, v110
    v_permlane16_swap_b32 v116, v117
    s_nop 1
    v_add_f32 v100, v100, v102
    v_add_f32 v108, v108, v110
    v_add_f32 v116, v116, v117
    v_mov_b32 v92, s48
    s_nop 1
    v_add_f32_dpp v100, v100, v100 row_ror:8 row_mask:0xf bank_mask:0xf
    v_add_f32_dpp v108, v108, v108 row_ror:8 row_mask:0xf bank_mask:0xf
    v_add_f32_dpp v116, v116, v116 row_ror:8 row_mask:0xf bank_mask:0xf
    s_nop 1
    v_add_f32_dpp v100, v100, v100 row_ror:4 row_mask:0xf bank_mask:0xf
    v_add_f32_dpp v108, v108, v108 row_ror:4 row_mask:0xf bank_mask:0xf
    v_add_f32_dpp v116, v116, v116 row_ror:4 row_mask:0xf bank_mask:0xf
    s_nop 1
    v_add_f32_dpp v100, v100, v100 row_ror:2 row_mask:0xf bank_mask:0xf
    v_add_f32_dpp v108, v108, v108 row_ror:2 row_mask:0xf bank_mask:0xf
    v_add_f32_dpp v116, v116, v116 row_ror:2 row_mask:0xf bank_mask:0xf
    s_nop 1
    v_add_f32_dpp v100, v100, v100 row_ror:1 row_mask:0xf bank_mask:0xf
    v_add_f32_dpp v108, v108, v108 row_ror:1 row_mask:0xf bank_mask:0xf
    v_add_f32_dpp v116, v116, v116 row_ror:1 row_mask:0xf bank_mask:0xf
    v_writelane_b32 v92, s50, 16
    v_writelane_b32 v92, s0, 32
    v_writelane_b32 v92, s82, 48
    v_mul_f32 v108, 0x3b000000, v108
    v_mul_f32 v100, 0x3b000000, v100
    v_add_f32 v92, v92, v108
    v_fma_f32 v100, -v108, v108, v100
    v_cvt_pk_bf16_f32 v92, v92, v92
    v_lshlrev_b32 v92, 16, v92
    v_max_f32 v100, 0, v100
    v_cvt_pk_bf16_f32 v100, v100, v100
    v_lshlrev_b32 v100, 16, v100
    v_readlane_b32 s48, v92, 0
    v_readlane_b32 s50, v92, 16
    v_readlane_b32 s0, v92, 32
    v_readlane_b32 s82, v92, 48
    v_add_f32 v100, 0x3727c5ac, v100
    v_cvt_pk_bf16_f32 v100, v100, v100
    v_lshlrev_b32 v100, 16, v100
    v_sqrt_f32 v100, v100
    v_cvt_pk_bf16_f32 v116, v116, v116
    v_lshlrev_b32 v116, 16, v116
    v_cvt_pk_bf16_f32 v100, v100, v100
    v_lshlrev_b32 v100, 16, v100
    v_rcp_f32 v100, v100
    v_pk_add_f32 v[60:61], v[60:61], s[48:49] op_sel_hi:[1,0] neg_lo:[0,1] neg_hi:[0,1]
    v_pk_add_f32 v[62:63], v[62:63], s[48:49] op_sel_hi:[1,0] neg_lo:[0,1] neg_hi:[0,1]
    v_pk_add_f32 v[64:65], v[64:65], s[48:49] op_sel_hi:[1,0] neg_lo:[0,1] neg_hi:[0,1]
    v_pk_add_f32 v[66:67], v[66:67], s[48:49] op_sel_hi:[1,0] neg_lo:[0,1] neg_hi:[0,1]
    v_mul_f32 v116, 0xbfb8aa3b, v116
    v_readlane_b32 s49, v100, 0
    v_readlane_b32 s51, v100, 16
    v_readlane_b32 s1, v100, 32
    v_readlane_b32 s83, v100, 48
    v_exp_f32 v116, v116
    v_cvt_pk_bf16_f32 v61, v60, v61
    v_cvt_pk_bf16_f32 v63, v62, v63
    v_cvt_pk_bf16_f32 v65, v64, v65
    v_cvt_pk_bf16_f32 v67, v66, v67
    v_lshlrev_b32 v60, 16, v61
    v_and_b32 v61, 0xffff0000, v61
    v_lshlrev_b32 v62, 16, v63
    v_and_b32 v63, 0xffff0000, v63
    v_lshlrev_b32 v64, 16, v65
    v_and_b32 v65, 0xffff0000, v65
    v_lshlrev_b32 v66, 16, v67
    v_and_b32 v67, 0xffff0000, v67
    v_pk_mul_f32 v[60:61], v[60:61], s[48:49] op_sel:[0,1] op_sel_hi:[1,1]
    v_pk_mul_f32 v[62:63], v[62:63], s[48:49] op_sel:[0,1] op_sel_hi:[1,1]
    v_pk_mul_f32 v[64:65], v[64:65], s[48:49] op_sel:[0,1] op_sel_hi:[1,1]
    v_pk_mul_f32 v[66:67], v[66:67], s[48:49] op_sel:[0,1] op_sel_hi:[1,1]
    v_cvt_pk_bf16_f32 v32, v60, v61
    v_cvt_pk_bf16_f32 v33, v62, v63
    v_cvt_pk_bf16_f32 v34, v64, v65
    v_cvt_pk_bf16_f32 v35, v66, v67
    v_lshrrev_b32 v30, 3, v1
    v_lshlrev_b32 v30, 18, v30
    v_and_b32 v93, 7, v1
    v_lshl_add_u32 v30, v93, 4, v30
    s_lshr_b32 s44, s43, 3
    buffer_store_dwordx4 v[32:35], v30, s[16:19], s44 offen offset:0 sc1
    v_pk_add_f32 v[68:69], v[68:69], s[50:51] op_sel_hi:[1,0] neg_lo:[0,1] neg_hi:[0,1]
    v_pk_add_f32 v[70:71], v[70:71], s[50:51] op_sel_hi:[1,0] neg_lo:[0,1] neg_hi:[0,1]
    v_pk_add_f32 v[72:73], v[72:73], s[50:51] op_sel_hi:[1,0] neg_lo:[0,1] neg_hi:[0,1]
    v_pk_add_f32 v[74:75], v[74:75], s[50:51] op_sel_hi:[1,0] neg_lo:[0,1] neg_hi:[0,1]
    v_cvt_pk_bf16_f32 v69, v68, v69
    v_cvt_pk_bf16_f32 v71, v70, v71
    v_cvt_pk_bf16_f32 v73, v72, v73
    v_cvt_pk_bf16_f32 v75, v74, v75
    v_add_f32 v116, 1.0, v116
    v_lshlrev_b32 v68, 16, v69
    v_and_b32 v69, 0xffff0000, v69
    v_lshlrev_b32 v70, 16, v71
    v_and_b32 v71, 0xffff0000, v71
    v_lshlrev_b32 v72, 16, v73
    v_and_b32 v73, 0xffff0000, v73
    v_lshlrev_b32 v74, 16, v75
    v_and_b32 v75, 0xffff0000, v75
    v_rcp_f32 v116, v116
    v_pk_mul_f32 v[68:69], v[68:69], s[50:51] op_sel:[0,1] op_sel_hi:[1,1]
    v_pk_mul_f32 v[70:71], v[70:71], s[50:51] op_sel:[0,1] op_sel_hi:[1,1]
    v_pk_mul_f32 v[72:73], v[72:73], s[50:51] op_sel:[0,1] op_sel_hi:[1,1]
    v_pk_mul_f32 v[74:75], v[74:75], s[50:51] op_sel:[0,1] op_sel_hi:[1,1]
    v_cvt_pk_bf16_f32 v36, v68, v69
    v_cvt_pk_bf16_f32 v37, v70, v71
    v_cvt_pk_bf16_f32 v38, v72, v73
    v_cvt_pk_bf16_f32 v39, v74, v75
    buffer_store_dwordx4 v[36:39], v30, s[16:19], s44 offen offset:128 sc1
    v_pk_add_f32 v[76:77], v[76:77], s[0:1] op_sel_hi:[1,0] neg_lo:[0,1] neg_hi:[0,1]
    v_pk_add_f32 v[78:79], v[78:79], s[0:1] op_sel_hi:[1,0] neg_lo:[0,1] neg_hi:[0,1]
    v_pk_add_f32 v[80:81], v[80:81], s[0:1] op_sel_hi:[1,0] neg_lo:[0,1] neg_hi:[0,1]
    v_pk_add_f32 v[82:83], v[82:83], s[0:1] op_sel_hi:[1,0] neg_lo:[0,1] neg_hi:[0,1]
    v_cvt_pk_bf16_f32 v77, v76, v77
    v_cvt_pk_bf16_f32 v79, v78, v79
    v_cvt_pk_bf16_f32 v81, v80, v81
    v_cvt_pk_bf16_f32 v83, v82, v83
    v_lshlrev_b32 v76, 16, v77
    v_and_b32 v77, 0xffff0000, v77
    v_lshlrev_b32 v78, 16, v79
    v_and_b32 v79, 0xffff0000, v79
    v_lshlrev_b32 v80, 16, v81
    v_and_b32 v81, 0xffff0000, v81
    v_lshlrev_b32 v82, 16, v83
    v_and_b32 v83, 0xffff0000, v83
    v_pk_mul_f32 v[76:77], v[76:77], s[0:1] op_sel:[0,1] op_sel_hi:[1,1]
    v_pk_mul_f32 v[78:79], v[78:79], s[0:1] op_sel:[0,1] op_sel_hi:[1,1]
    v_pk_mul_f32 v[80:81], v[80:81], s[0:1] op_sel:[0,1] op_sel_hi:[1,1]
    v_pk_mul_f32 v[82:83], v[82:83], s[0:1] op_sel:[0,1] op_sel_hi:[1,1]
    v_cvt_pk_bf16_f32 v40, v76, v77
    v_cvt_pk_bf16_f32 v41, v78, v79
    v_cvt_pk_bf16_f32 v42, v80, v81
    v_cvt_pk_bf16_f32 v43, v82, v83
    buffer_store_dwordx4 v[40:43], v30, s[16:19], s44 offen offset:256 sc1
    v_pk_add_f32 v[84:85], v[84:85], s[82:83] op_sel_hi:[1,0] neg_lo:[0,1] neg_hi:[0,1]
    v_pk_add_f32 v[86:87], v[86:87], s[82:83] op_sel_hi:[1,0] neg_lo:[0,1] neg_hi:[0,1]
    v_pk_add_f32 v[88:89], v[88:89], s[82:83] op_sel_hi:[1,0] neg_lo:[0,1] neg_hi:[0,1]
    v_pk_add_f32 v[90:91], v[90:91], s[82:83] op_sel_hi:[1,0] neg_lo:[0,1] neg_hi:[0,1]
    v_cvt_pk_bf16_f32 v85, v84, v85
    v_cvt_pk_bf16_f32 v87, v86, v87
    v_cvt_pk_bf16_f32 v89, v88, v89
    v_cvt_pk_bf16_f32 v91, v90, v91
    v_lshlrev_b32 v84, 16, v85
    v_and_b32 v85, 0xffff0000, v85
    v_lshlrev_b32 v86, 16, v87
    v_and_b32 v87, 0xffff0000, v87
    v_lshlrev_b32 v88, 16, v89
    v_and_b32 v89, 0xffff0000, v89
    v_lshlrev_b32 v90, 16, v91
    v_and_b32 v91, 0xffff0000, v91
    v_pk_mul_f32 v[84:85], v[84:85], s[82:83] op_sel:[0,1] op_sel_hi:[1,1]
    v_pk_mul_f32 v[86:87], v[86:87], s[82:83] op_sel:[0,1] op_sel_hi:[1,1]
    v_pk_mul_f32 v[88:89], v[88:89], s[82:83] op_sel:[0,1] op_sel_hi:[1,1]
    v_pk_mul_f32 v[90:91], v[90:91], s[82:83] op_sel:[0,1] op_sel_hi:[1,1]
    v_cvt_pk_bf16_f32 v44, v84, v85
    v_cvt_pk_bf16_f32 v45, v86, v87
    v_cvt_pk_bf16_f32 v46, v88, v89
    v_cvt_pk_bf16_f32 v47, v90, v91
    buffer_store_dwordx4 v[44:47], v30, s[16:19], s44 offen offset:384 sc1
    v_cvt_pk_bf16_f32 v116, v116, v116
    v_lshlrev_b32 v116, 16, v116
    v_lshrrev_b32 v93, 2, v1
    s_lshl_b32 s44, s45, 7
    s_mov_b32 exec_lo, 0x00010001
    s_mov_b32 exec_hi, 0x00010001
    buffer_store_dword v116, v93, s[20:23], s44 offen sc1
    s_mov_b64 exec, -1
    s_add_u32 m0, s42, 0
    s_add_u32 s59, s57, 0
    buffer_load_dwordx4 v4, s[24:27], s59 offen lds
    s_add_u32 m0, s42, 1024
    s_add_u32 s59, s57, 22016
    buffer_load_dwordx4 v4, s[24:27], s59 offen lds
    s_add_u32 m0, s42, 2048
    s_add_u32 s59, s57, 44032
    buffer_load_dwordx4 v4, s[24:27], s59 offen lds
    s_add_u32 m0, s42, 3072
    s_add_u32 s59, s57, 66048
    buffer_load_dwordx4 v4, s[24:27], s59 offen lds
    s_add_u32 m0, s42, 4096
    s_add_u32 s59, s57, 88064
    buffer_load_dwordx4 v4, s[24:27], s59 offen lds
    s_add_u32 m0, s42, 5120
    s_add_u32 s59, s57, 110080
    buffer_load_dwordx4 v4, s[24:27], s59 offen lds
    s_add_u32 m0, s42, 6144
    s_add_u32 s59, s57, 132096
    buffer_load_dwordx4 v4, s[24:27], s59 offen lds
    s_add_u32 m0, s42, 7168
    s_add_u32 s59, s57, 154112
    buffer_load_dwordx4 v4, s[24:27], s59 offen lds
    s_add_u32 m0, s42, 8192
    s_add_u32 s59, s57, 176128
    buffer_load_dwordx4 v4, s[24:27], s59 offen lds
    s_add_u32 m0, s42, 9216
    s_add_u32 s59, s57, 198144
    buffer_load_dwordx4 v4, s[24:27], s59 offen lds
    s_add_u32 m0, s42, 10240
    s_add_u32 s59, s57, 220160
    buffer_load_dwordx4 v4, s[24:27], s59 offen lds
    s_add_u32 m0, s42, 11264
    s_add_u32 s59, s57, 242176
    buffer_load_dwordx4 v4, s[24:27], s59 offen lds
    s_add_u32 m0, s42, 12288
    s_add_u32 s59, s57, 264192
    buffer_load_dwordx4 v4, s[24:27], s59 offen lds
    s_add_u32 m0, s42, 13312
    s_add_u32 s59, s57, 286208
    buffer_load_dwordx4 v4, s[24:27], s59 offen lds
    s_add_u32 m0, s42, 14336
    s_add_u32 s59, s57, 308224
    buffer_load_dwordx4 v4, s[24:27], s59 offen lds
    s_add_u32 m0, s42, 15360
    s_add_u32 s59, s57, 330240
    buffer_load_dwordx4 v4, s[24:27], s59 offen lds
    s_waitcnt vmcnt(16)
    s_branch L_lnj_3
L_ln3_2:
    s_lshr_b32 s43, s41, 2
    s_sub_u32 s43, s55, s43
    s_lshl_b32 s43, s43, 7
    s_and_b32 s44, s40, 1
    s_mul_i32 s44, s44, 2818048
    s_add_u32 s43, s43, s44
    s_min_u32 s44, s41, 19
    s_mul_i32 s44, s44, 9
    v_mul_u32_u24 v17, 37, v1
    v_lshrrev_b32 v17, 8, v17
    v_mul_u32_u24 v18, 7, v17
    v_sub_u32 v18, v1, v18
    v_add_u32 v17, s44, v17
    v_add_u32 v14, 0, v17
    v_min_u32 v14, 1023, v14
    v_bfe_u32 v15, v14, 6, 1
    v_lshlrev_b32 v15, 9, v15
    v_and_or_b32 v15, v14, 63, v15
    v_lshrrev_b32 v14, 7, v14
    v_lshl_or_b32 v14, v14, 6, v15
    v_mul_u32_u24 v14, 2752, v14
    v_lshl_add_u32 v14, v18, 7, v14
    buffer_load_dword v5, v14, s[24:27], s43 offen
    v_add_u32 v14, 180, v17
    v_min_u32 v14, 1023, v14
    v_bfe_u32 v15, v14, 6, 1
    v_lshlrev_b32 v15, 9, v15
    v_and_or_b32 v15, v14, 63, v15
    v_lshrrev_b32 v14, 7, v14
    v_lshl_or_b32 v14, v14, 6, v15
    v_mul_u32_u24 v14, 2752, v14
    v_lshl_add_u32 v14, v18, 7, v14
    buffer_load_dword v5, v14, s[24:27], s43 offen
    v_add_u32 v14, 360, v17
    v_min_u32 v14, 1023, v14
    v_bfe_u32 v15, v14, 6, 1
    v_lshlrev_b32 v15, 9, v15
    v_and_or_b32 v15, v14, 63, v15
    v_lshrrev_b32 v14, 7, v14
    v_lshl_or_b32 v14, v14, 6, v15
    v_mul_u32_u24 v14, 2752, v14
    v_lshl_add_u32 v14, v18, 7, v14
    buffer_load_dword v5, v14, s[24:27], s43 offen
    v_add_u32 v14, 540, v17
    v_min_u32 v14, 1023, v14
    v_bfe_u32 v15, v14, 6, 1
    v_lshlrev_b32 v15, 9, v15
    v_and_or_b32 v15, v14, 63, v15
    v_lshrrev_b32 v14, 7, v14
    v_lshl_or_b32 v14, v14, 6, v15
    v_mul_u32_u24 v14, 2752, v14
    v_lshl_add_u32 v14, v18, 7, v14
    buffer_load_dword v5, v14, s[24:27], s43 offen
    v_add_u32 v14, 720, v17
    v_min_u32 v14, 1023, v14
    v_bfe_u32 v15, v14, 6, 1
    v_lshlrev_b32 v15, 9, v15
    v_and_or_b32 v15, v14, 63, v15
    v_lshrrev_b32 v14, 7, v14
    v_lshl_or_b32 v14, v14, 6, v15
    v_mul_u32_u24 v14, 2752, v14
    v_lshl_add_u32 v14, v18, 7, v14
    buffer_load_dword v5, v14, s[24:27], s43 offen
    v_add_u32 v14, 900, v17
    v_min_u32 v14, 1023, v14
    v_bfe_u32 v15, v14, 6, 1
    v_lshlrev_b32 v15, 9, v15
    v_and_or_b32 v15, v14, 63, v15
    v_lshrrev_b32 v14, 7, v14
    v_lshl_or_b32 v14, v14, 6, v15
    v_mul_u32_u24 v14, 2752, v14
    v_lshl_add_u32 v14, v18, 7, v14
    buffer_load_dword v5, v14, s[24:27], s43 offen
    s_waitcnt vmcnt(6)
    s_add_u32 m0, s42, 0
    s_add_u32 s59, s57, 0
    buffer_load_dwordx4 v4, s[24:27], s59 offen lds
    s_add_u32 m0, s42, 1024
    s_add_u32 s59, s57, 22016
    buffer_load_dwordx4 v4, s[24:27], s59 offen lds
    s_add_u32 m0, s42, 2048
    s_add_u32 s59, s57, 44032
    buffer_load_dwordx4 v4, s[24:27], s59 offen lds
    s_add_u32 m0, s42, 3072
    s_add_u32 s59, s57, 66048
    buffer_load_dwordx4 v4, s[24:27], s59 offen lds
    s_add_u32 m0, s42, 4096
    s_add_u32 s59, s57, 88064
    buffer_load_dwordx4 v4, s[24:27], s59 offen lds
    s_add_u32 m0, s42, 5120
    s_add_u32 s59, s57, 110080
    buffer_load_dwordx4 v4, s[24:27], s59 offen lds
    s_add_u32 m0, s42, 6144
    s_add_u32 s59, s57, 132096
    buffer_load_dwordx4 v4, s[24:27], s59 offen lds
    s_add_u32 m0, s42, 7168
    s_add_u32 s59, s57, 154112
    buffer_load_dwordx4 v4, s[24:27], s59 offen lds
    s_add_u32 m0, s42, 8192
    s_add_u32 s59, s57, 176128
    buffer_load_dwordx4 v4, s[24:27], s59 offen lds
    s_add_u32 m0, s42, 9216
    s_add_u32 s59, s57, 198144
    buffer_load_dwordx4 v4, s[24:27], s59 offen lds
    s_add_u32 m0, s42, 10240
    s_add_u32 s59, s57, 220160
    buffer_load_dwordx4 v4, s[24:27], s59 offen lds
    s_add_u32 m0, s42, 11264
    s_add_u32 s59, s57, 242176
    buffer_load_dwordx4 v4, s[24:27], s59 offen lds
    s_add_u32 m0, s42, 12288
    s_add_u32 s59, s57, 264192
    buffer_load_dwordx4 v4, s[24:27], s59 offen lds
    s_add_u32 m0, s42, 13312
    s_add_u32 s59, s57, 286208
    buffer_load_dwordx4 v4, s[24:27], s59 offen lds
    s_add_u32 m0, s42, 14336
    s_add_u32 s59, s57, 308224
    buffer_load_dwordx4 v4, s[24:27], s59 offen lds
    s_add_u32 m0, s42, 15360
    s_add_u32 s59, s57, 330240
    buffer_load_dwordx4 v4, s[24:27], s59 offen lds
L_lnj_3:
    s_mov_b32 s60, 20000
L_np_4:
    v_readfirstlane_b32 s100, v28
    v_readfirstlane_b32 s101, v29
    s_cmp_lg_u32 s100, 0
    s_cbranch_scc1 L_npd_5
    buffer_load_dwordx2 v[28:29], off, s[4:7], 0 sc1
    s_waitcnt vmcnt(0)
    s_sub_u32 s60, s60, 1
    s_cmp_lg_u32 s60, 0
    s_cbranch_scc1 L_np_4
L_npd_5:
    s_add_u32 s4, s98, 3670016
    s_addc_u32 s5, s99, 0
    s_and_b32 s5, s5, 0xffff
    s_mov_b32 s6, 65536
    s_mov_b32 s7, 0x00020000
    s_barrier
    s_cmp_lg_u32 s3, 0
    s_cbranch_scc1 L_wf_6
    s_mov_b64 exec, 1
    s_lshl_b32 s60, s54, 5
    v_mov_b32 v14, s100
    v_mov_b32 v15, s101
    buffer_store_dwordx2 v[14:15], off, s[4:7], s60 sc1
    s_mov_b64 exec, -1
L_wf_6:
    s_add_u32 m0, s42, 16384
    s_add_u32 s59, s57, 352256
    buffer_load_dwordx4 v4, s[24:27], s59 offen lds
    s_add_u32 m0, s42, 17408
    s_add_u32 s59, s57, 374272
    buffer_load_dwordx4 v4, s[24:27], s59 offen lds
    s_add_u32 m0, s42, 18432
    s_add_u32 s59, s57, 396288
    buffer_load_dwordx4 v4, s[24:27], s59 offen lds
    s_add_u32 m0, s42, 19456
    s_add_u32 s59, s57, 418304
    buffer_load_dwordx4 v4, s[24:27], s59 offen lds
    s_add_u32 m0, s42, 20480
    s_add_u32 s59, s57, 440320
    buffer_load_dwordx4 v4, s[24:27], s59 offen lds
    s_add_u32 m0, s42, 21504
    s_add_u32 s59, s57, 462336
    buffer_load_dwordx4 v4, s[24:27], s59 offen lds
    s_add_u32 m0, s42, 22528
    s_add_u32 s59, s57, 484352
    buffer_load_dwordx4 v4, s[24:27], s59 offen lds
    s_add_u32 m0, s42, 23552
    s_add_u32 s59, s57, 506368
    buffer_load_dwordx4 v4, s[24:27], s59 offen lds
    s_add_u32 m0, s42, 24576
    s_add_u32 s59, s57, 528384
    buffer_load_dwordx4 v4, s[24:27], s59 offen lds
    s_add_u32 m0, s42, 25600
    s_add_u32 s59, s57, 550400
    buffer_load_dwordx4 v4, s[24:27], s59 offen lds
    s_add_u32 m0, s42, 26624
    s_add_u32 s59, s57, 572416
    buffer_load_dwordx4 v4, s[24:27], s59 offen lds
    s_add_u32 m0, s42, 27648
    s_add_u32 s59, s57, 594432
    buffer_load_dwordx4 v4, s[24:27], s59 offen lds
    s_add_u32 m0, s42, 28672
    s_add_u32 s59, s57, 616448
    buffer_load_dwordx4 v4, s[24:27], s59 offen lds
    s_add_u32 m0, s42, 29696
    s_add_u32 s59, s57, 638464
    buffer_load_dwordx4 v4, s[24:27], s59 offen lds
    s_add_u32 m0, s42, 30720
    s_add_u32 s59, s57, 660480
    buffer_load_dwordx4 v4, s[24:27], s59 offen lds
    s_add_u32 m0, s42, 31744
    s_add_u32 s59, s57, 682496
    buffer_load_dwordx4 v4, s[24:27], s59 offen lds
    s_add_u32 m0, s42, 32768
    s_add_u32 s59, s57, 704512
    buffer_load_dwordx4 v4, s[24:27], s59 offen lds
    s_add_u32 m0, s42, 33792
    s_add_u32 s59, s57, 726528
    buffer_load_dwordx4 v4, s[24:27], s59 offen lds
    s_add_u32 m0, s42, 34816
    s_add_u32 s59, s57, 748544
    buffer_load_dwordx4 v4, s[24:27], s59 offen lds
    s_add_u32 m0, s42, 35840
    s_add_u32 s59, s57, 770560
    buffer_load_dwordx4 v4, s[24:27], s59 offen lds
    s_add_u32 m0, s42, 36864
    s_add_u32 s59, s57, 792576
    buffer_load_dwordx4 v4, s[24:27], s59 offen lds
    s_add_u32 m0, s42, 37888
    s_add_u32 s59, s57, 814592
    buffer_load_dwordx4 v4, s[24:27], s59 offen lds
    s_add_u32 m0, s42, 38912
    s_add_u32 s59, s57, 836608
    buffer_load_dwordx4 v4, s[24:27], s59 offen lds
    s_add_u32 m0, s42, 39936
    s_add_u32 s59, s57, 858624
    buffer_load_dwordx4 v4, s[24:27], s59 offen lds
    s_mul_i32 s54, s56, 22
    s_add_u32 s54, s54, s55
    s_lshl_b32 s54, s54, 2
    s_add_u32 s54, s54, s3
    s_mov_b32 s28, s74
    s_and_b32 s29, s75, 0xffff
    s_mov_b32 s30, 524288
    s_mov_b32 s31, 0x00020000
    s_mov_b32 s36, s76
    s_and_b32 s37, s77, 0xffff
    s_mov_b32 s38, 524288
    s_mov_b32 s39, 0x00020000
    s_lshl_b32 s58, s3, 8
    s_lshl_b32 s43, s53, 16
    s_add_u32 s58, s58, s43
    s_mov_b32 s50, 0x05040100
    s_mov_b32 s51, 0x07060302
    v_lshrrev_b32 v14, 3, v1
    v_mul_u32_u24 v14, 1024, v14
    v_and_b32 v15, 7, v1
    v_lshrrev_b32 v16, 4, v1
    v_xor_b32 v15, v15, v16
    v_lshlrev_b32 v15, 4, v15
    v_add_u32 v2, v14, v15
    v_xor_b32 v15, 64, v15
    v_add_u32 v3, v14, v15
    v_and_b32 v14, 31, v1
    v_lshrrev_b32 v15, 1, v14
    v_and_b32 v15, 7, v15
    v_lshrrev_b32 v16, 5, v1
    v_xor_b32 v15, v15, v16
    v_lshlrev_b32 v15, 4, v15
    v_lshl_add_u32 v14, v14, 7, v15
    v_add_u32 v6, s42, v14
    v_xor_b32 v7, 32, v6
    v_xor_b32 v8, 64, v6
    v_xor_b32 v9, 96, v6
    s_mov_b32 s32, s88
    s_and_b32 s33, s89, 0xffff
    s_mov_b32 s34, 5636096
    s_mov_b32 s35, 0x00020000
    s_mul_i32 s61, s3, 6
    s_cmp_eq_u32 s3, 3
    s_cselect_b32 s61, 17, s61
    s_lshl_b32 s61, s61, 18
    s_lshl_b32 s43, s52, 7
    s_add_u32 s61, s61, s43
    v_lshrrev_b32 v14, 3, v1
    v_mul_u32_u24 v14, 4096, v14
    v_and_b32 v15, 7, v1
    v_lshrrev_b32 v16, 2, v1
    v_and_b32 v16, 4, v16
    v_xor_b32 v15, v15, v16
    v_lshl_add_u32 v12, v15, 4, v14
    s_cmp_ge_u32 s3, 2
    s_cselect_b32 s63, 0x40000000, 0
    s_add_u32 s63, s63, s61
    s_mov_b32 s12, s86
    s_and_b32 s13, s87, 0xffff
    s_mov_b32 s14, 2752
    s_mov_b32 s15, 0x00020000
    v_lshrrev_b32 v19, 5, v1
    v_lshlrev_b32 v19, 3, v19
    s_lshl_b32 s44, s55, 1
    s_lshr_b32 s43, s3, 1
    s_add_u32 s44, s44, s43
    s_lshl_b32 s44, s44, 6
    buffer_load_dwordx2 v[20:21], v19, s[12:15], s44 offen offset:0
    buffer_load_dwordx2 v[22:23], v19, s[12:15], s44 offen offset:16
    buffer_load_dwordx2 v[24:25], v19, s[12:15], s44 offen offset:32
    buffer_load_dwordx2 v[26:27], v19, s[12:15], s44 offen offset:48
    s_add_u32 s20, s98, 4194304
    s_addc_u32 s21, s99, 0
    s_and_b32 s21, s21, 0xffff
    s_mov_b32 s22, 1441792
    s_mov_b32 s23, 0x00020000
    s_lshl_b32 s62, s3, 16
    s_lshl_b32 s44, s56, 18
    s_add_u32 s62, s62, s44
    v_lshrrev_b32 v14, 3, v1
    v_mul_u32_u24 v14, 128, v14
    v_and_b32 v15, 7, v1
    v_lshrrev_b32 v16, 2, v1
    v_and_b32 v16, 4, v16
    v_xor_b32 v15, v15, v16
    v_lshl_add_u32 v13, v15, 4, v14
    s_waitcnt vmcnt(36)
    ds_read_b64_tr_b16 a[0:1], v10 offset:0
    ds_read_b64_tr_b16 a[2:3], v10 offset:512
    ds_read_b64_tr_b16 a[4:5], v11 offset:0
    ds_read_b64_tr_b16 a[6:7], v11 offset:512
    ds_read_b64_tr_b16 a[8:9], v10 offset:2048
    ds_read_b64_tr_b16 a[10:11], v10 offset:2560
    ds_read_b64_tr_b16 a[12:13], v11 offset:2048
    ds_read_b64_tr_b16 a[14:15], v11 offset:2560
    ds_read_b64_tr_b16 a[16:17], v10 offset:4096
    ds_read_b64_tr_b16 a[18:19], v10 offset:4608
    ds_read_b64_tr_b16 a[20:21], v11 offset:4096
    ds_read_b64_tr_b16 a[22:23], v11 offset:4608
    ds_read_b64_tr_b16 a[24:25], v10 offset:6144
    ds_read_b64_tr_b16 a[26:27], v10 offset:6656
    ds_read_b64_tr_b16 a[28:29], v11 offset:6144
    ds_read_b64_tr_b16 a[30:31], v11 offset:6656
    s_waitcnt lgkmcnt(0)
    s_add_u32 m0, s42, 0
    s_add_u32 s59, s57, 880640
    buffer_load_dwordx4 v4, s[24:27], s59 offen lds
    s_add_u32 m0, s42, 1024
    s_add_u32 s59, s57, 902656
    buffer_load_dwordx4 v4, s[24:27], s59 offen lds
    s_add_u32 m0, s42, 2048
    s_add_u32 s59, s57, 924672
    buffer_load_dwordx4 v4, s[24:27], s59 offen lds
    s_add_u32 m0, s42, 3072
    s_add_u32 s59, s57, 946688
    buffer_load_dwordx4 v4, s[24:27], s59 offen lds
    s_add_u32 m0, s42, 4096
    s_add_u32 s59, s57, 968704
    buffer_load_dwordx4 v4, s[24:27], s59 offen lds
    s_add_u32 m0, s42, 5120
    s_add_u32 s59, s57, 990720
    buffer_load_dwordx4 v4, s[24:27], s59 offen lds
    s_add_u32 m0, s42, 6144
    s_add_u32 s59, s57, 1012736
    buffer_load_dwordx4 v4, s[24:27], s59 offen lds
    s_add_u32 m0, s42, 7168
    s_add_u32 s59, s57, 1034752
    buffer_load_dwordx4 v4, s[24:27], s59 offen lds
    s_waitcnt vmcnt(36)
    ds_read_b64_tr_b16 a[32:33], v10 offset:8192
    ds_read_b64_tr_b16 a[34:35], v10 offset:8704
    ds_read_b64_tr_b16 a[36:37], v11 offset:8192
    ds_read_b64_tr_b16 a[38:39], v11 offset:8704
    ds_read_b64_tr_b16 a[40:41], v10 offset:10240
    ds_read_b64_tr_b16 a[42:43], v10 offset:10752
    ds_read_b64_tr_b16 a[44:45], v11 offset:10240
    ds_read_b64_tr_b16 a[46:47], v11 offset:10752
    ds_read_b64_tr_b16 a[48:49], v10 offset:12288
    ds_read_b64_tr_b16 a[50:51], v10 offset:12800
    ds_read_b64_tr_b16 a[52:53], v11 offset:12288
    ds_read_b64_tr_b16 a[54:55], v11 offset:12800
    ds_read_b64_tr_b16 a[56:57], v10 offset:14336
    ds_read_b64_tr_b16 a[58:59], v10 offset:14848
    ds_read_b64_tr_b16 a[60:61], v11 offset:14336
    ds_read_b64_tr_b16 a[62:63], v11 offset:14848
    s_waitcnt lgkmcnt(0)
    s_add_u32 m0, s42, 8192
    s_add_u32 s59, s57, 1056768
    buffer_load_dwordx4 v4, s[24:27], s59 offen lds
    s_add_u32 m0, s42, 9216
    s_add_u32 s59, s57, 1078784
    buffer_load_dwordx4 v4, s[24:27], s59 offen lds
    s_add_u32 m0, s42, 10240
    s_add_u32 s59, s57, 1100800
    buffer_load_dwordx4 v4, s[24:27], s59 offen lds
    s_add_u32 m0, s42, 11264
    s_add_u32 s59, s57, 1122816
    buffer_load_dwordx4 v4, s[24:27], s59 offen lds
    s_add_u32 m0, s42, 12288
    s_add_u32 s59, s57, 1144832
    buffer_load_dwordx4 v4, s[24:27], s59 offen lds
    s_add_u32 m0, s42, 13312
    s_add_u32 s59, s57, 1166848
    buffer_load_dwordx4 v4, s[24:27], s59 offen lds
    s_add_u32 m0, s42, 14336
    s_add_u32 s59, s57, 1188864
    buffer_load_dwordx4 v4, s[24:27], s59 offen lds
    s_add_u32 m0, s42, 15360
    s_add_u32 s59, s57, 1210880
    buffer_load_dwordx4 v4, s[24:27], s59 offen lds
    s_waitcnt vmcnt(36)
    ds_read_b64_tr_b16 a[64:65], v10 offset:16384
    ds_read_b64_tr_b16 a[66:67], v10 offset:16896
    ds_read_b64_tr_b16 a[68:69], v11 offset:16384
    ds_read_b64_tr_b16 a[70:71], v11 offset:16896
    ds_read_b64_tr_b16 a[72:73], v10 offset:18432
    ds_read_b64_tr_b16 a[74:75], v10 offset:18944
    ds_read_b64_tr_b16 a[76:77], v11 offset:18432
    ds_read_b64_tr_b16 a[78:79], v11 offset:18944
    ds_read_b64_tr_b16 a[80:81], v10 offset:20480
    ds_read_b64_tr_b16 a[82:83], v10 offset:20992
    ds_read_b64_tr_b16 a[84:85], v11 offset:20480
    ds_read_b64_tr_b16 a[86:87], v11 offset:20992
    ds_read_b64_tr_b16 a[88:89], v10 offset:22528
    ds_read_b64_tr_b16 a[90:91], v10 offset:23040
    ds_read_b64_tr_b16 a[92:93], v11 offset:22528
    ds_read_b64_tr_b16 a[94:95], v11 offset:23040
    s_waitcnt lgkmcnt(0)
    s_add_u32 m0, s42, 16384
    s_add_u32 s59, s57, 1232896
    buffer_load_dwordx4 v4, s[24:27], s59 offen lds
    s_add_u32 m0, s42, 17408
    s_add_u32 s59, s57, 1254912
    buffer_load_dwordx4 v4, s[24:27], s59 offen lds
    s_add_u32 m0, s42, 18432
    s_add_u32 s59, s57, 1276928
    buffer_load_dwordx4 v4, s[24:27], s59 offen lds
    s_add_u32 m0, s42, 19456
    s_add_u32 s59, s57, 1298944
    buffer_load_dwordx4 v4, s[24:27], s59 offen lds
    s_add_u32 m0, s42, 20480
    s_add_u32 s59, s57, 1320960
    buffer_load_dwordx4 v4, s[24:27], s59 offen lds
    s_add_u32 m0, s42, 21504
    s_add_u32 s59, s57, 1342976
    buffer_load_dwordx4 v4, s[24:27], s59 offen lds
    s_add_u32 m0, s42, 22528
    s_add_u32 s59, s57, 1364992
    buffer_load_dwordx4 v4, s[24:27], s59 offen lds
    s_add_u32 m0, s42, 23552
    s_add_u32 s59, s57, 1387008
    buffer_load_dwordx4 v4, s[24:27], s59 offen lds
    s_mul_i32 s43, s3, 43
    s_add_u32 s44, s3, 1
    s_lshr_b32 s44, s44, 1
    s_min_u32 s44, s44, 1
    s_sub_u32 s43, s43, s44
    s_lshl_b32 s43, s43, 5
    v_lshl_add_u32 v14, v1, 5, s43
    s_mov_b32 exec_hi, 0xfff
    buffer_load_dwordx2 v[18:19], v14, s[4:7], 0 offen sc1
    s_mov_b64 exec, -1
    s_waitcnt vmcnt(37)
    ds_read_b64_tr_b16 a[96:97], v10 offset:24576
    ds_read_b64_tr_b16 a[98:99], v10 offset:25088
    ds_read_b64_tr_b16 a[100:101], v11 offset:24576
    ds_read_b64_tr_b16 a[102:103], v11 offset:25088
    ds_read_b64_tr_b16 a[104:105], v10 offset:26624
    ds_read_b64_tr_b16 a[106:107], v10 offset:27136
    ds_read_b64_tr_b16 a[108:109], v11 offset:26624
    ds_read_b64_tr_b16 a[110:111], v11 offset:27136
    ds_read_b64_tr_b16 a[112:113], v10 offset:28672
    ds_read_b64_tr_b16 a[114:115], v10 offset:29184
    ds_read_b64_tr_b16 a[116:117], v11 offset:28672
    ds_read_b64_tr_b16 a[118:119], v11 offset:29184
    ds_read_b64_tr_b16 a[120:121], v10 offset:30720
    ds_read_b64_tr_b16 a[122:123], v10 offset:31232
    ds_read_b64_tr_b16 a[124:125], v11 offset:30720
    ds_read_b64_tr_b16 a[126:127], v11 offset:31232
    s_waitcnt lgkmcnt(0)
    s_waitcnt vmcnt(0)
    s_mul_i32 s43, s3, 43
    s_add_u32 s44, s3, 1
    s_lshr_b32 s44, s44, 1
    s_min_u32 s44, s44, 1
    s_sub_u32 s43, s43, s44
    s_lshl_b32 s43, s43, 5
    v_lshl_add_u32 v14, v1, 5, s43
    s_mov_b32 exec_hi, 0xfff
    s_mov_b32 s60, 20000
    s_branch L_pollc_8
L_poll_7:
    buffer_load_dwordx2 v[18:19], v14, s[4:7], 0 offen sc1
    s_waitcnt vmcnt(0)
L_pollc_8:
    v_cmp_ne_u64 vcc, s[100:101], v[18:19]
    s_cbranch_vccz L_polld_9
    s_sleep 4
    s_sub_u32 s60, s60, 1
    s_cmp_lg_u32 s60, 0
    s_cbranch_scc1 L_poll_7
L_polld_9:
    s_mov_b64 exec, -1
    s_add_u32 m0, s42, 24576
    s_add_u32 s59, s62, 0
    buffer_load_dwordx4 v13, s[16:19], s59 offen lds
    s_add_u32 m0, s42, 25600
    s_add_u32 s59, s62, 1024
    buffer_load_dwordx4 v13, s[16:19], s59 offen lds
    s_add_u32 m0, s42, 26624
    s_add_u32 s59, s62, 2048
    buffer_load_dwordx4 v13, s[16:19], s59 offen lds
    s_add_u32 m0, s42, 27648
    s_add_u32 s59, s62, 3072
    buffer_load_dwordx4 v13, s[16:19], s59 offen lds
    s_add_u32 m0, s42, 28672
    s_add_u32 s59, s62, 4096
    buffer_load_dwordx4 v13, s[16:19], s59 offen lds
    s_add_u32 m0, s42, 29696
    s_add_u32 s59, s62, 5120
    buffer_load_dwordx4 v13, s[16:19], s59 offen lds
    s_add_u32 m0, s42, 30720
    s_add_u32 s59, s62, 6144
    buffer_load_dwordx4 v13, s[16:19], s59 offen lds
    s_add_u32 m0, s42, 31744
    s_add_u32 s59, s62, 7168
    buffer_load_dwordx4 v13, s[16:19], s59 offen lds
    ds_read_b64_tr_b16 a[128:129], v10 offset:32768
    ds_read_b64_tr_b16 a[130:131], v10 offset:33280
    ds_read_b64_tr_b16 a[132:133], v11 offset:32768
    ds_read_b64_tr_b16 a[134:135], v11 offset:33280
    ds_read_b64_tr_b16 a[136:137], v10 offset:34816
    ds_read_b64_tr_b16 a[138:139], v10 offset:35328
    ds_read_b64_tr_b16 a[140:141], v11 offset:34816
    ds_read_b64_tr_b16 a[142:143], v11 offset:35328
    ds_read_b64_tr_b16 a[144:145], v10 offset:36864
    ds_read_b64_tr_b16 a[146:147], v10 offset:37376
    ds_read_b64_tr_b16 a[148:149], v11 offset:36864
    ds_read_b64_tr_b16 a[150:151], v11 offset:37376
    ds_read_b64_tr_b16 a[152:153], v10 offset:38912
    ds_read_b64_tr_b16 a[154:155], v10 offset:39424
    ds_read_b64_tr_b16 a[156:157], v11 offset:38912
    ds_read_b64_tr_b16 a[158:159], v11 offset:39424
    s_waitcnt lgkmcnt(0)
    s_add_u32 m0, s42, 32768
    s_add_u32 s59, s62, 8192
    buffer_load_dwordx4 v13, s[16:19], s59 offen lds
    s_add_u32 m0, s42, 33792
    s_add_u32 s59, s62, 9216
    buffer_load_dwordx4 v13, s[16:19], s59 offen lds
    s_add_u32 m0, s42, 34816
    s_add_u32 s59, s62, 10240
    buffer_load_dwordx4 v13, s[16:19], s59 offen lds
    s_add_u32 m0, s42, 35840
    s_add_u32 s59, s62, 11264
    buffer_load_dwordx4 v13, s[16:19], s59 offen lds
    s_add_u32 m0, s42, 36864
    s_add_u32 s59, s62, 12288
    buffer_load_dwordx4 v13, s[16:19], s59 offen lds
    s_add_u32 m0, s42, 37888
    s_add_u32 s59, s62, 13312
    buffer_load_dwordx4 v13, s[16:19], s59 offen lds
    s_add_u32 m0, s42, 38912
    s_add_u32 s59, s62, 14336
    buffer_load_dwordx4 v13, s[16:19], s59 offen lds
    s_add_u32 m0, s42, 39936
    s_add_u32 s59, s62, 15360
    buffer_load_dwordx4 v13, s[16:19], s59 offen lds
    ds_read_b64_tr_b16 a[160:161], v10 offset:0
    ds_read_b64_tr_b16 a[162:163], v10 offset:512
    ds_read_b64_tr_b16 a[164:165], v11 offset:0
    ds_read_b64_tr_b16 a[166:167], v11 offset:512
    ds_read_b64_tr_b16 a[168:169], v10 offset:2048
    ds_read_b64_tr_b16 a[170:171], v10 offset:2560
    ds_read_b64_tr_b16 a[172:173], v11 offset:2048
    ds_read_b64_tr_b16 a[174:175], v11 offset:2560
    ds_read_b64_tr_b16 a[176:177], v10 offset:4096
    ds_read_b64_tr_b16 a[178:179], v10 offset:4608
    ds_read_b64_tr_b16 a[180:181], v11 offset:4096
    ds_read_b64_tr_b16 a[182:183], v11 offset:4608
    ds_read_b64_tr_b16 a[184:185], v10 offset:6144
    ds_read_b64_tr_b16 a[186:187], v10 offset:6656
    ds_read_b64_tr_b16 a[188:189], v11 offset:6144
    ds_read_b64_tr_b16 a[190:191], v11 offset:6656
    s_waitcnt lgkmcnt(0)
    s_add_u32 m0, s42, 0
    s_add_u32 s59, s62, 16384
    buffer_load_dwordx4 v13, s[16:19], s59 offen lds
    s_add_u32 m0, s42, 1024
    s_add_u32 s59, s62, 17408
    buffer_load_dwordx4 v13, s[16:19], s59 offen lds
    s_add_u32 m0, s42, 2048
    s_add_u32 s59, s62, 18432
    buffer_load_dwordx4 v13, s[16:19], s59 offen lds
    s_add_u32 m0, s42, 3072
    s_add_u32 s59, s62, 19456
    buffer_load_dwordx4 v13, s[16:19], s59 offen lds
    s_add_u32 m0, s42, 4096
    s_add_u32 s59, s62, 20480
    buffer_load_dwordx4 v13, s[16:19], s59 offen lds
    s_add_u32 m0, s42, 5120
    s_add_u32 s59, s62, 21504
    buffer_load_dwordx4 v13, s[16:19], s59 offen lds
    s_add_u32 m0, s42, 6144
    s_add_u32 s59, s62, 22528
    buffer_load_dwordx4 v13, s[16:19], s59 offen lds
    s_add_u32 m0, s42, 7168
    s_add_u32 s59, s62, 23552
    buffer_load_dwordx4 v13, s[16:19], s59 offen lds
    ds_read_b64_tr_b16 a[192:193], v10 offset:8192
    ds_read_b64_tr_b16 a[194:195], v10 offset:8704
    ds_read_b64_tr_b16 a[196:197], v11 offset:8192
    ds_read_b64_tr_b16 a[198:199], v11 offset:8704
    ds_read_b64_tr_b16 a[200:201], v10 offset:10240
    ds_read_b64_tr_b16 a[202:203], v10 offset:10752
    ds_read_b64_tr_b16 a[204:205], v11 offset:10240
    ds_read_b64_tr_b16 a[206:207], v11 offset:10752
    ds_read_b64_tr_b16 a[208:209], v10 offset:12288
    ds_read_b64_tr_b16 a[210:211], v10 offset:12800
    ds_read_b64_tr_b16 a[212:213], v11 offset:12288
    ds_read_b64_tr_b16 a[214:215], v11 offset:12800
    ds_read_b64_tr_b16 a[216:217], v10 offset:14336
    ds_read_b64_tr_b16 a[218:219], v10 offset:14848
    ds_read_b64_tr_b16 a[220:221], v11 offset:14336
    ds_read_b64_tr_b16 a[222:223], v11 offset:14848
    s_waitcnt lgkmcnt(0)
    s_add_u32 m0, s42, 8192
    s_add_u32 s59, s62, 24576
    buffer_load_dwordx4 v13, s[16:19], s59 offen lds
    s_add_u32 m0, s42, 9216
    s_add_u32 s59, s62, 25600
    buffer_load_dwordx4 v13, s[16:19], s59 offen lds
    s_add_u32 m0, s42, 10240
    s_add_u32 s59, s62, 26624
    buffer_load_dwordx4 v13, s[16:19], s59 offen lds
    s_add_u32 m0, s42, 11264
    s_add_u32 s59, s62, 27648
    buffer_load_dwordx4 v13, s[16:19], s59 offen lds
    s_add_u32 m0, s42, 12288
    s_add_u32 s59, s62, 28672
    buffer_load_dwordx4 v13, s[16:19], s59 offen lds
    s_add_u32 m0, s42, 13312
    s_add_u32 s59, s62, 29696
    buffer_load_dwordx4 v13, s[16:19], s59 offen lds
    s_add_u32 m0, s42, 14336
    s_add_u32 s59, s62, 30720
    buffer_load_dwordx4 v13, s[16:19], s59 offen lds
    s_add_u32 m0, s42, 15360
    s_add_u32 s59, s62, 31744
    buffer_load_dwordx4 v13, s[16:19], s59 offen lds
    ds_read_b64_tr_b16 a[224:225], v10 offset:16384
    ds_read_b64_tr_b16 a[226:227], v10 offset:16896
    ds_read_b64_tr_b16 a[228:229], v11 offset:16384
    ds_read_b64_tr_b16 a[230:231], v11 offset:16896
    ds_read_b64_tr_b16 a[232:233], v10 offset:18432
    ds_read_b64_tr_b16 a[234:235], v10 offset:18944
    ds_read_b64_tr_b16 a[236:237], v11 offset:18432
    ds_read_b64_tr_b16 a[238:239], v11 offset:18944
    ds_read_b64_tr_b16 a[240:241], v10 offset:20480
    ds_read_b64_tr_b16 a[242:243], v10 offset:20992
    ds_read_b64_tr_b16 a[244:245], v11 offset:20480
    ds_read_b64_tr_b16 a[246:247], v11 offset:20992
    ds_read_b64_tr_b16 a[248:249], v10 offset:22528
    ds_read_b64_tr_b16 a[250:251], v10 offset:23040
    ds_read_b64_tr_b16 a[252:253], v11 offset:22528
    ds_read_b64_tr_b16 a[254:255], v11 offset:23040
    s_waitcnt lgkmcnt(0)
    s_add_u32 m0, s42, 16384
    s_add_u32 s59, s62, 32768
    buffer_load_dwordx4 v13, s[16:19], s59 offen lds
    s_add_u32 m0, s42, 17408
    s_add_u32 s59, s62, 33792
    buffer_load_dwordx4 v13, s[16:19], s59 offen lds
    s_add_u32 m0, s42, 18432
    s_add_u32 s59, s62, 34816
    buffer_load_dwordx4 v13, s[16:19], s59 offen lds
    s_add_u32 m0, s42, 19456
    s_add_u32 s59, s62, 35840
    buffer_load_dwordx4 v13, s[16:19], s59 offen lds
    s_add_u32 m0, s42, 20480
    s_add_u32 s59, s62, 36864
    buffer_load_dwordx4 v13, s[16:19], s59 offen lds
    s_add_u32 m0, s42, 21504
    s_add_u32 s59, s62, 37888
    buffer_load_dwordx4 v13, s[16:19], s59 offen lds
    s_add_u32 m0, s42, 22528
    s_add_u32 s59, s62, 38912
    buffer_load_dwordx4 v13, s[16:19], s59 offen lds
    s_add_u32 m0, s42, 23552
    s_add_u32 s59, s62, 39936
    buffer_load_dwordx4 v13, s[16:19], s59 offen lds
    s_waitcnt vmcnt(32)
    ds_read_b64_tr_b16 v[32:33], v10 offset:24576
    ds_read_b64_tr_b16 v[34:35], v10 offset:25088
    ds_read_b64_tr_b16 v[36:37], v11 offset:24576
    ds_read_b64_tr_b16 v[38:39], v11 offset:25088
    ds_read_b64_tr_b16 v[40:41], v10 offset:26624
    ds_read_b64_tr_b16 v[42:43], v10 offset:27136
    ds_read_b64_tr_b16 v[44:45], v11 offset:26624
    ds_read_b64_tr_b16 v[46:47], v11 offset:27136
    s_waitcnt lgkmcnt(4)
    v_mfma_f32_32x32x16_bf16 v[64:79], a[0:3], v[32:35], 0
    ds_read_b64_tr_b16 v[48:49], v10 offset:28672
    v_mfma_f32_32x32x16_bf16 v[80:95], a[0:3], v[36:39], 0
    ds_read_b64_tr_b16 v[50:51], v10 offset:29184
    v_mfma_f32_32x32x16_bf16 v[96:111], a[4:7], v[32:35], 0
    ds_read_b64_tr_b16 v[52:53], v11 offset:28672
    v_mfma_f32_32x32x16_bf16 v[112:127], a[4:7], v[36:39], 0
    ds_read_b64_tr_b16 v[54:55], v11 offset:29184
    s_waitcnt lgkmcnt(4)
    v_mfma_f32_32x32x16_bf16 v[64:79], a[8:11], v[40:43], v[64:79]
    ds_read_b64_tr_b16 v[56:57], v10 offset:30720
    v_mfma_f32_32x32x16_bf16 v[80:95], a[8:11], v[44:47], v[80:95]
    ds_read_b64_tr_b16 v[58:59], v10 offset:31232
    v_mfma_f32_32x32x16_bf16 v[96:111], a[12:15], v[40:43], v[96:111]
    ds_read_b64_tr_b16 v[60:61], v11 offset:30720
    v_mfma_f32_32x32x16_bf16 v[112:127], a[12:15], v[44:47], v[112:127]
    ds_read_b64_tr_b16 v[62:63], v11 offset:31232
    s_waitcnt vmcnt(24)
    s_waitcnt lgkmcnt(4)
    v_mfma_f32_32x32x16_bf16 v[64:79], a[16:19], v[48:51], v[64:79]
    ds_read_b64_tr_b16 v[32:33], v10 offset:32768
    v_mfma_f32_32x32x16_bf16 v[80:95], a[16:19], v[52:55], v[80:95]
    ds_read_b64_tr_b16 v[34:35], v10 offset:33280
    v_mfma_f32_32x32x16_bf16 v[96:111], a[20:23], v[48:51], v[96:111]
    ds_read_b64_tr_b16 v[36:37], v11 offset:32768
    v_mfma_f32_32x32x16_bf16 v[112:127], a[20:23], v[52:55], v[112:127]
    ds_read_b64_tr_b16 v[38:39], v11 offset:33280
    s_waitcnt lgkmcnt(4)
    v_mfma_f32_32x32x16_bf16 v[64:79], a[24:27], v[56:59], v[64:79]
    ds_read_b64_tr_b16 v[40:41], v10 offset:34816
    v_mfma_f32_32x32x16_bf16 v[80:95], a[24:27], v[60:63], v[80:95]
    ds_read_b64_tr_b16 v[42:43], v10 offset:35328
    v_mfma_f32_32x32x16_bf16 v[96:111], a[28:31], v[56:59], v[96:111]
    ds_read_b64_tr_b16 v[44:45], v11 offset:34816
    v_mfma_f32_32x32x16_bf16 v[112:127], a[28:31], v[60:63], v[112:127]
    ds_read_b64_tr_b16 v[46:47], v11 offset:35328
    s_waitcnt lgkmcnt(4)
    v_mfma_f32_32x32x16_bf16 v[64:79], a[32:35], v[32:35], v[64:79]
    ds_read_b64_tr_b16 v[48:49], v10 offset:36864
    v_mfma_f32_32x32x16_bf16 v[80:95], a[32:35], v[36:39], v[80:95]
    ds_read_b64_tr_b16 v[50:51], v10 offset:37376
    s_add_u32 m0, s42, 24576
    s_add_u32 s59, s62, 40960
    buffer_load_dwordx4 v13, s[16:19], s59 offen lds
    v_mfma_f32_32x32x16_bf16 v[96:111], a[36:39], v[32:35], v[96:111]
    ds_read_b64_tr_b16 v[52:53], v11 offset:36864
    v_mfma_f32_32x32x16_bf16 v[112:127], a[36:39], v[36:39], v[112:127]
    ds_read_b64_tr_b16 v[54:55], v11 offset:37376
    s_add_u32 m0, s42, 25600
    s_add_u32 s59, s62, 41984
    buffer_load_dwordx4 v13, s[16:19], s59 offen lds
    s_waitcnt lgkmcnt(4)
    v_mfma_f32_32x32x16_bf16 v[64:79], a[40:43], v[40:43], v[64:79]
    ds_read_b64_tr_b16 v[56:57], v10 offset:38912
    v_mfma_f32_32x32x16_bf16 v[80:95], a[40:43], v[44:47], v[80:95]
    ds_read_b64_tr_b16 v[58:59], v10 offset:39424
    s_add_u32 m0, s42, 26624
    s_add_u32 s59, s62, 43008
    buffer_load_dwordx4 v13, s[16:19], s59 offen lds
    v_mfma_f32_32x32x16_bf16 v[96:111], a[44:47], v[40:43], v[96:111]
    ds_read_b64_tr_b16 v[60:61], v11 offset:38912
    v_mfma_f32_32x32x16_bf16 v[112:127], a[44:47], v[44:47], v[112:127]
    ds_read_b64_tr_b16 v[62:63], v11 offset:39424
    s_add_u32 m0, s42, 27648
    s_add_u32 s59, s62, 44032
    buffer_load_dwordx4 v13, s[16:19], s59 offen lds
    s_waitcnt vmcnt(20)
    s_waitcnt lgkmcnt(4)
    v_mfma_f32_32x32x16_bf16 v[64:79], a[48:51], v[48:51], v[64:79]
    ds_read_b64_tr_b16 v[32:33], v10 offset:0
    v_mfma_f32_32x32x16_bf16 v[80:95], a[48:51], v[52:55], v[80:95]
    ds_read_b64_tr_b16 v[34:35], v10 offset:512
    s_add_u32 m0, s42, 28672
    s_add_u32 s59, s62, 45056
    buffer_load_dwordx4 v13, s[16:19], s59 offen lds
    v_mfma_f32_32x32x16_bf16 v[96:111], a[52:55], v[48:51], v[96:111]
    ds_read_b64_tr_b16 v[36:37], v11 offset:0
    v_mfma_f32_32x32x16_bf16 v[112:127], a[52:55], v[52:55], v[112:127]
    ds_read_b64_tr_b16 v[38:39], v11 offset:512
    s_add_u32 m0, s42, 29696
    s_add_u32 s59, s62, 46080
    buffer_load_dwordx4 v13, s[16:19], s59 offen lds
    s_waitcnt lgkmcnt(4)
    v_mfma_f32_32x32x16_bf16 v[64:79], a[56:59], v[56:59], v[64:79]
    ds_read_b64_tr_b16 v[40:41], v10 offset:2048
    v_mfma_f32_32x32x16_bf16 v[80:95], a[56:59], v[60:63], v[80:95]
    ds_read_b64_tr_b16 v[42:43], v10 offset:2560
    s_add_u32 m0, s42, 30720
    s_add_u32 s59, s62, 47104
    buffer_load_dwordx4 v13, s[16:19], s59 offen lds
    v_mfma_f32_32x32x16_bf16 v[96:111], a[60:63], v[56:59], v[96:111]
    ds_read_b64_tr_b16 v[44:45], v11 offset:2048
    v_mfma_f32_32x32x16_bf16 v[112:127], a[60:63], v[60:63], v[112:127]
    ds_read_b64_tr_b16 v[46:47], v11 offset:2560
    s_add_u32 m0, s42, 31744
    s_add_u32 s59, s62, 48128
    buffer_load_dwordx4 v13, s[16:19], s59 offen lds
    s_waitcnt lgkmcnt(4)
    v_mfma_f32_32x32x16_bf16 v[64:79], a[64:67], v[32:35], v[64:79]
    ds_read_b64_tr_b16 v[48:49], v10 offset:4096
    v_mfma_f32_32x32x16_bf16 v[80:95], a[64:67], v[36:39], v[80:95]
    ds_read_b64_tr_b16 v[50:51], v10 offset:4608
    s_add_u32 m0, s42, 32768
    s_add_u32 s59, s62, 49152
    buffer_load_dwordx4 v13, s[16:19], s59 offen lds
    v_mfma_f32_32x32x16_bf16 v[96:111], a[68:71], v[32:35], v[96:111]
    ds_read_b64_tr_b16 v[52:53], v11 offset:4096
    v_mfma_f32_32x32x16_bf16 v[112:127], a[68:71], v[36:39], v[112:127]
    ds_read_b64_tr_b16 v[54:55], v11 offset:4608
    s_add_u32 m0, s42, 33792
    s_add_u32 s59, s62, 50176
    buffer_load_dwordx4 v13, s[16:19], s59 offen lds
    s_waitcnt lgkmcnt(4)
    v_mfma_f32_32x32x16_bf16 v[64:79], a[72:75], v[40:43], v[64:79]
    ds_read_b64_tr_b16 v[56:57], v10 offset:6144
    v_mfma_f32_32x32x16_bf16 v[80:95], a[72:75], v[44:47], v[80:95]
    ds_read_b64_tr_b16 v[58:59], v10 offset:6656
    s_add_u32 m0, s42, 34816
    s_add_u32 s59, s62, 51200
    buffer_load_dwordx4 v13, s[16:19], s59 offen lds
    v_mfma_f32_32x32x16_bf16 v[96:111], a[76:79], v[40:43], v[96:111]
    ds_read_b64_tr_b16 v[60:61], v11 offset:6144
    v_mfma_f32_32x32x16_bf16 v[112:127], a[76:79], v[44:47], v[112:127]
    ds_read_b64_tr_b16 v[62:63], v11 offset:6656
    s_add_u32 m0, s42, 35840
    s_add_u32 s59, s62, 52224
    buffer_load_dwordx4 v13, s[16:19], s59 offen lds
    s_waitcnt vmcnt(20)
    s_waitcnt lgkmcnt(4)
    v_mfma_f32_32x32x16_bf16 v[64:79], a[80:83], v[48:51], v[64:79]
    ds_read_b64_tr_b16 v[32:33], v10 offset:8192
    v_mfma_f32_32x32x16_bf16 v[80:95], a[80:83], v[52:55], v[80:95]
    ds_read_b64_tr_b16 v[34:35], v10 offset:8704
    s_add_u32 m0, s42, 36864
    s_add_u32 s59, s62, 53248
    buffer_load_dwordx4 v13, s[16:19], s59 offen lds
    v_mfma_f32_32x32x16_bf16 v[96:111], a[84:87], v[48:51], v[96:111]
    ds_read_b64_tr_b16 v[36:37], v11 offset:8192
    v_mfma_f32_32x32x16_bf16 v[112:127], a[84:87], v[52:55], v[112:127]
    ds_read_b64_tr_b16 v[38:39], v11 offset:8704
    s_add_u32 m0, s42, 37888
    s_add_u32 s59, s62, 54272
    buffer_load_dwordx4 v13, s[16:19], s59 offen lds
    s_waitcnt lgkmcnt(4)
    v_mfma_f32_32x32x16_bf16 v[64:79], a[88:91], v[56:59], v[64:79]
    ds_read_b64_tr_b16 v[40:41], v10 offset:10240
    v_mfma_f32_32x32x16_bf16 v[80:95], a[88:91], v[60:63], v[80:95]
    ds_read_b64_tr_b16 v[42:43], v10 offset:10752
    s_add_u32 m0, s42, 38912
    s_add_u32 s59, s62, 55296
    buffer_load_dwordx4 v13, s[16:19], s59 offen lds
    v_mfma_f32_32x32x16_bf16 v[96:111], a[92:95], v[56:59], v[96:111]
    ds_read_b64_tr_b16 v[44:45], v11 offset:10240
    v_mfma_f32_32x32x16_bf16 v[112:127], a[92:95], v[60:63], v[112:127]
    ds_read_b64_tr_b16 v[46:47], v11 offset:10752
    s_add_u32 m0, s42, 39936
    s_add_u32 s59, s62, 56320
    buffer_load_dwordx4 v13, s[16:19], s59 offen lds
    s_waitcnt lgkmcnt(4)
    v_mfma_f32_32x32x16_bf16 v[64:79], a[96:99], v[32:35], v[64:79]
    ds_read_b64_tr_b16 v[48:49], v10 offset:12288
    v_mfma_f32_32x32x16_bf16 v[80:95], a[96:99], v[36:39], v[80:95]
    ds_read_b64_tr_b16 v[50:51], v10 offset:12800
    s_add_u32 m0, s42, 0
    s_add_u32 s59, s62, 57344
    buffer_load_dwordx4 v13, s[16:19], s59 offen lds
    v_mfma_f32_32x32x16_bf16 v[96:111], a[100:103], v[32:35], v[96:111]
    ds_read_b64_tr_b16 v[52:53], v11 offset:12288
    v_mfma_f32_32x32x16_bf16 v[112:127], a[100:103], v[36:39], v[112:127]
    ds_read_b64_tr_b16 v[54:55], v11 offset:12800
    s_add_u32 m0, s42, 1024
    s_add_u32 s59, s62, 58368
    buffer_load_dwordx4 v13, s[16:19], s59 offen lds
    s_waitcnt lgkmcnt(4)
    v_mfma_f32_32x32x16_bf16 v[64:79], a[104:107], v[40:43], v[64:79]
    ds_read_b64_tr_b16 v[56:57], v10 offset:14336
    v_mfma_f32_32x32x16_bf16 v[80:95], a[104:107], v[44:47], v[80:95]
    ds_read_b64_tr_b16 v[58:59], v10 offset:14848
    s_add_u32 m0, s42, 2048
    s_add_u32 s59, s62, 59392
    buffer_load_dwordx4 v13, s[16:19], s59 offen lds
    v_mfma_f32_32x32x16_bf16 v[96:111], a[108:111], v[40:43], v[96:111]
    ds_read_b64_tr_b16 v[60:61], v11 offset:14336
    v_mfma_f32_32x32x16_bf16 v[112:127], a[108:111], v[44:47], v[112:127]
    ds_read_b64_tr_b16 v[62:63], v11 offset:14848
    s_add_u32 m0, s42, 3072
    s_add_u32 s59, s62, 60416
    buffer_load_dwordx4 v13, s[16:19], s59 offen lds
    s_waitcnt vmcnt(20)
    s_waitcnt lgkmcnt(4)
    v_mfma_f32_32x32x16_bf16 v[64:79], a[112:115], v[48:51], v[64:79]
    ds_read_b64_tr_b16 v[32:33], v10 offset:16384
    v_mfma_f32_32x32x16_bf16 v[80:95], a[112:115], v[52:55], v[80:95]
    ds_read_b64_tr_b16 v[34:35], v10 offset:16896
    s_add_u32 m0, s42, 4096
    s_add_u32 s59, s62, 61440
    buffer_load_dwordx4 v13, s[16:19], s59 offen lds
    v_mfma_f32_32x32x16_bf16 v[96:111], a[116:119], v[48:51], v[96:111]
    ds_read_b64_tr_b16 v[36:37], v11 offset:16384
    v_mfma_f32_32x32x16_bf16 v[112:127], a[116:119], v[52:55], v[112:127]
    ds_read_b64_tr_b16 v[38:39], v11 offset:16896
    s_add_u32 m0, s42, 5120
    s_add_u32 s59, s62, 62464
    buffer_load_dwordx4 v13, s[16:19], s59 offen lds
    s_waitcnt lgkmcnt(4)
    v_mfma_f32_32x32x16_bf16 v[64:79], a[120:123], v[56:59], v[64:79]
    ds_read_b64_tr_b16 v[40:41], v10 offset:18432
    v_mfma_f32_32x32x16_bf16 v[80:95], a[120:123], v[60:63], v[80:95]
    ds_read_b64_tr_b16 v[42:43], v10 offset:18944
    s_add_u32 m0, s42, 6144
    s_add_u32 s59, s62, 63488
    buffer_load_dwordx4 v13, s[16:19], s59 offen lds
    v_mfma_f32_32x32x16_bf16 v[96:111], a[124:127], v[56:59], v[96:111]
    ds_read_b64_tr_b16 v[44:45], v11 offset:18432
    v_mfma_f32_32x32x16_bf16 v[112:127], a[124:127], v[60:63], v[112:127]
    ds_read_b64_tr_b16 v[46:47], v11 offset:18944
    s_add_u32 m0, s42, 7168
    s_add_u32 s59, s62, 64512
    buffer_load_dwordx4 v13, s[16:19], s59 offen lds
    s_waitcnt lgkmcnt(4)
    v_mfma_f32_32x32x16_bf16 v[64:79], a[128:131], v[32:35], v[64:79]
    ds_read_b64_tr_b16 v[48:49], v10 offset:20480
    v_mfma_f32_32x32x16_bf16 v[80:95], a[128:131], v[36:39], v[80:95]
    ds_read_b64_tr_b16 v[50:51], v10 offset:20992
    s_add_u32 m0, s42, 8192
    s_add_u32 s59, s61, 0
    buffer_load_dwordx4 v12, s[32:35], s59 offen lds
    v_mfma_f32_32x32x16_bf16 v[96:111], a[132:135], v[32:35], v[96:111]
    ds_read_b64_tr_b16 v[52:53], v11 offset:20480
    v_mfma_f32_32x32x16_bf16 v[112:127], a[132:135], v[36:39], v[112:127]
    ds_read_b64_tr_b16 v[54:55], v11 offset:20992
    s_add_u32 m0, s42, 9216
    s_add_u32 s59, s61, 32768
    buffer_load_dwordx4 v12, s[32:35], s59 offen lds
    s_waitcnt lgkmcnt(4)
    v_mfma_f32_32x32x16_bf16 v[64:79], a[136:139], v[40:43], v[64:79]
    ds_read_b64_tr_b16 v[56:57], v10 offset:22528
    v_mfma_f32_32x32x16_bf16 v[80:95], a[136:139], v[44:47], v[80:95]
    ds_read_b64_tr_b16 v[58:59], v10 offset:23040
    s_add_u32 m0, s42, 10240
    s_add_u32 s59, s61, 65536
    buffer_load_dwordx4 v12, s[32:35], s59 offen lds
    v_mfma_f32_32x32x16_bf16 v[96:111], a[140:143], v[40:43], v[96:111]
    ds_read_b64_tr_b16 v[60:61], v11 offset:22528
    v_mfma_f32_32x32x16_bf16 v[112:127], a[140:143], v[44:47], v[112:127]
    ds_read_b64_tr_b16 v[62:63], v11 offset:23040
    s_add_u32 m0, s42, 11264
    s_add_u32 s59, s61, 98304
    buffer_load_dwordx4 v12, s[32:35], s59 offen lds
    s_waitcnt vmcnt(20)
    s_waitcnt lgkmcnt(4)
    v_mfma_f32_32x32x16_bf16 v[64:79], a[144:147], v[48:51], v[64:79]
    ds_read_b64_tr_b16 v[32:33], v10 offset:24576
    v_mfma_f32_32x32x16_bf16 v[80:95], a[144:147], v[52:55], v[80:95]
    ds_read_b64_tr_b16 v[34:35], v10 offset:25088
    s_add_u32 m0, s42, 12288
    s_add_u32 s59, s61, 131072
    buffer_load_dwordx4 v12, s[32:35], s59 offen lds
    v_mfma_f32_32x32x16_bf16 v[96:111], a[148:151], v[48:51], v[96:111]
    ds_read_b64_tr_b16 v[36:37], v11 offset:24576
    v_mfma_f32_32x32x16_bf16 v[112:127], a[148:151], v[52:55], v[112:127]
    ds_read_b64_tr_b16 v[38:39], v11 offset:25088
    s_add_u32 m0, s42, 13312
    s_add_u32 s59, s61, 163840
    buffer_load_dwordx4 v12, s[32:35], s59 offen lds
    s_waitcnt lgkmcnt(4)
    v_mfma_f32_32x32x16_bf16 v[64:79], a[152:155], v[56:59], v[64:79]
    ds_read_b64_tr_b16 v[40:41], v10 offset:26624
    v_mfma_f32_32x32x16_bf16 v[80:95], a[152:155], v[60:63], v[80:95]
    ds_read_b64_tr_b16 v[42:43], v10 offset:27136
    s_add_u32 m0, s42, 14336
    s_add_u32 s59, s61, 196608
    buffer_load_dwordx4 v12, s[32:35], s59 offen lds
    v_mfma_f32_32x32x16_bf16 v[96:111], a[156:159], v[56:59], v[96:111]
    ds_read_b64_tr_b16 v[44:45], v11 offset:26624
    v_mfma_f32_32x32x16_bf16 v[112:127], a[156:159], v[60:63], v[112:127]
    ds_read_b64_tr_b16 v[46:47], v11 offset:27136
    s_add_u32 m0, s42, 15360
    s_add_u32 s59, s61, 229376
    buffer_load_dwordx4 v12, s[32:35], s59 offen lds
    s_waitcnt lgkmcnt(4)
    v_mfma_f32_32x32x16_bf16 v[64:79], a[160:163], v[32:35], v[64:79]
    ds_read_b64_tr_b16 v[48:49], v10 offset:28672
    v_mfma_f32_32x32x16_bf16 v[80:95], a[160:163], v[36:39], v[80:95]
    ds_read_b64_tr_b16 v[50:51], v10 offset:29184
    s_add_u32 m0, s42, 16384
    s_add_u32 s59, s61, 262144
    buffer_load_dwordx4 v12, s[32:35], s59 offen lds
    v_mfma_f32_32x32x16_bf16 v[96:111], a[164:167], v[32:35], v[96:111]
    ds_read_b64_tr_b16 v[52:53], v11 offset:28672
    v_mfma_f32_32x32x16_bf16 v[112:127], a[164:167], v[36:39], v[112:127]
    ds_read_b64_tr_b16 v[54:55], v11 offset:29184
    s_add_u32 m0, s42, 17408
    s_add_u32 s59, s61, 294912
    buffer_load_dwordx4 v12, s[32:35], s59 offen lds
    s_waitcnt lgkmcnt(4)
    v_mfma_f32_32x32x16_bf16 v[64:79], a[168:171], v[40:43], v[64:79]
    ds_read_b64_tr_b16 v[56:57], v10 offset:30720
    v_mfma_f32_32x32x16_bf16 v[80:95], a[168:171], v[44:47], v[80:95]
    ds_read_b64_tr_b16 v[58:59], v10 offset:31232
    s_add_u32 m0, s42, 18432
    s_add_u32 s59, s61, 327680
    buffer_load_dwordx4 v12, s[32:35], s59 offen lds
    v_mfma_f32_32x32x16_bf16 v[96:111], a[172:175], v[40:43], v[96:111]
    ds_read_b64_tr_b16 v[60:61], v11 offset:30720
    v_mfma_f32_32x32x16_bf16 v[112:127], a[172:175], v[44:47], v[112:127]
    ds_read_b64_tr_b16 v[62:63], v11 offset:31232
    s_add_u32 m0, s42, 19456
    s_add_u32 s59, s61, 360448
    buffer_load_dwordx4 v12, s[32:35], s59 offen lds
    s_waitcnt vmcnt(20)
    s_waitcnt lgkmcnt(4)
    v_mfma_f32_32x32x16_bf16 v[64:79], a[176:179], v[48:51], v[64:79]
    ds_read_b64_tr_b16 v[32:33], v10 offset:32768
    v_mfma_f32_32x32x16_bf16 v[80:95], a[176:179], v[52:55], v[80:95]
    ds_read_b64_tr_b16 v[34:35], v10 offset:33280
    s_add_u32 m0, s42, 20480
    s_add_u32 s59, s61, 393216
    buffer_load_dwordx4 v12, s[32:35], s59 offen lds
    v_mfma_f32_32x32x16_bf16 v[96:111], a[180:183], v[48:51], v[96:111]
    ds_read_b64_tr_b16 v[36:37], v11 offset:32768
    v_mfma_f32_32x32x16_bf16 v[112:127], a[180:183], v[52:55], v[112:127]
    ds_read_b64_tr_b16 v[38:39], v11 offset:33280
    s_add_u32 m0, s42, 21504
    s_add_u32 s59, s61, 425984
    buffer_load_dwordx4 v12, s[32:35], s59 offen lds
    s_waitcnt lgkmcnt(4)
    v_mfma_f32_32x32x16_bf16 v[64:79], a[184:187], v[56:59], v[64:79]
    ds_read_b64_tr_b16 v[40:41], v10 offset:34816
    v_mfma_f32_32x32x16_bf16 v[80:95], a[184:187], v[60:63], v[80:95]
    ds_read_b64_tr_b16 v[42:43], v10 offset:35328
    s_add_u32 m0, s42, 22528
    s_add_u32 s59, s61, 458752
    buffer_load_dwordx4 v12, s[32:35], s59 offen lds
    v_mfma_f32_32x32x16_bf16 v[96:111], a[188:191], v[56:59], v[96:111]
    ds_read_b64_tr_b16 v[44:45], v11 offset:34816
    v_mfma_f32_32x32x16_bf16 v[112:127], a[188:191], v[60:63], v[112:127]
    ds_read_b64_tr_b16 v[46:47], v11 offset:35328
    s_add_u32 m0, s42, 23552
    s_add_u32 s59, s61, 491520
    buffer_load_dwordx4 v12, s[32:35], s59 offen lds
    s_waitcnt lgkmcnt(4)
    v_mfma_f32_32x32x16_bf16 v[64:79], a[192:195], v[32:35], v[64:79]
    ds_read_b64_tr_b16 v[48:49], v10 offset:36864
    v_mfma_f32_32x32x16_bf16 v[80:95], a[192:195], v[36:39], v[80:95]
    ds_read_b64_tr_b16 v[50:51], v10 offset:37376
    s_add_u32 m0, s42, 24576
    s_add_u32 s59, s61, 524288
    buffer_load_dwordx4 v12, s[32:35], s59 offen lds
    v_mfma_f32_32x32x16_bf16 v[96:111], a[196:199], v[32:35], v[96:111]
    ds_read_b64_tr_b16 v[52:53], v11 offset:36864
    v_mfma_f32_32x32x16_bf16 v[112:127], a[196:199], v[36:39], v[112:127]
    ds_read_b64_tr_b16 v[54:55], v11 offset:37376
    s_add_u32 m0, s42, 25600
    s_add_u32 s59, s61, 557056
    buffer_load_dwordx4 v12, s[32:35], s59 offen lds
    s_waitcnt lgkmcnt(4)
    v_mfma_f32_32x32x16_bf16 v[64:79], a[200:203], v[40:43], v[64:79]
    ds_read_b64_tr_b16 v[56:57], v10 offset:38912
    v_mfma_f32_32x32x16_bf16 v[80:95], a[200:203], v[44:47], v[80:95]
    ds_read_b64_tr_b16 v[58:59], v10 offset:39424
    s_add_u32 m0, s42, 26624
    s_add_u32 s59, s61, 589824
    buffer_load_dwordx4 v12, s[32:35], s59 offen lds
    v_mfma_f32_32x32x16_bf16 v[96:111], a[204:207], v[40:43], v[96:111]
    ds_read_b64_tr_b16 v[60:61], v11 offset:38912
    v_mfma_f32_32x32x16_bf16 v[112:127], a[204:207], v[44:47], v[112:127]
    ds_read_b64_tr_b16 v[62:63], v11 offset:39424
    s_add_u32 m0, s42, 27648
    s_add_u32 s59, s61, 622592
    buffer_load_dwordx4 v12, s[32:35], s59 offen lds
    s_waitcnt vmcnt(20)
    s_waitcnt lgkmcnt(4)
    v_mfma_f32_32x32x16_bf16 v[64:79], a[208:211], v[48:51], v[64:79]
    ds_read_b64_tr_b16 v[32:33], v10 offset:0
    v_mfma_f32_32x32x16_bf16 v[80:95], a[208:211], v[52:55], v[80:95]
    ds_read_b64_tr_b16 v[34:35], v10 offset:512
    s_add_u32 m0, s42, 28672
    s_add_u32 s59, s61, 655360
    buffer_load_dwordx4 v12, s[32:35], s59 offen lds
    v_mfma_f32_32x32x16_bf16 v[96:111], a[212:215], v[48:51], v[96:111]
    ds_read_b64_tr_b16 v[36:37], v11 offset:0
    v_mfma_f32_32x32x16_bf16 v[112:127], a[212:215], v[52:55], v[112:127]
    ds_read_b64_tr_b16 v[38:39], v11 offset:512
    s_add_u32 m0, s42, 29696
    s_add_u32 s59, s61, 688128
    buffer_load_dwordx4 v12, s[32:35], s59 offen lds
    s_waitcnt lgkmcnt(4)
    v_mfma_f32_32x32x16_bf16 v[64:79], a[216:219], v[56:59], v[64:79]
    ds_read_b64_tr_b16 v[40:41], v10 offset:2048
    v_mfma_f32_32x32x16_bf16 v[80:95], a[216:219], v[60:63], v[80:95]
    ds_read_b64_tr_b16 v[42:43], v10 offset:2560
    s_add_u32 m0, s42, 30720
    s_add_u32 s59, s61, 720896
    buffer_load_dwordx4 v12, s[32:35], s59 offen lds
    v_mfma_f32_32x32x16_bf16 v[96:111], a[220:223], v[56:59], v[96:111]
    ds_read_b64_tr_b16 v[44:45], v11 offset:2048
    v_mfma_f32_32x32x16_bf16 v[112:127], a[220:223], v[60:63], v[112:127]
    ds_read_b64_tr_b16 v[46:47], v11 offset:2560
    s_add_u32 m0, s42, 31744
    s_add_u32 s59, s61, 753664
    buffer_load_dwordx4 v12, s[32:35], s59 offen lds
    s_waitcnt lgkmcnt(4)
    v_mfma_f32_32x32x16_bf16 v[64:79], a[224:227], v[32:35], v[64:79]
    ds_read_b64_tr_b16 v[48:49], v10 offset:4096
    v_mfma_f32_32x32x16_bf16 v[80:95], a[224:227], v[36:39], v[80:95]
    ds_read_b64_tr_b16 v[50:51], v10 offset:4608
    v_mfma_f32_32x32x16_bf16 v[96:111], a[228:231], v[32:35], v[96:111]
    ds_read_b64_tr_b16 v[52:53], v11 offset:4096
    v_mfma_f32_32x32x16_bf16 v[112:127], a[228:231], v[36:39], v[112:127]
    ds_read_b64_tr_b16 v[54:55], v11 offset:4608
    s_waitcnt lgkmcnt(4)
    v_mfma_f32_32x32x16_bf16 v[64:79], a[232:235], v[40:43], v[64:79]
    ds_read_b64_tr_b16 v[56:57], v10 offset:6144
    v_mfma_f32_32x32x16_bf16 v[80:95], a[232:235], v[44:47], v[80:95]
    ds_read_b64_tr_b16 v[58:59], v10 offset:6656
    v_mfma_f32_32x32x16_bf16 v[96:111], a[236:239], v[40:43], v[96:111]
    ds_read_b64_tr_b16 v[60:61], v11 offset:6144
    v_mfma_f32_32x32x16_bf16 v[112:127], a[236:239], v[44:47], v[112:127]
    ds_read_b64_tr_b16 v[62:63], v11 offset:6656
    s_waitcnt lgkmcnt(4)
    v_mfma_f32_32x32x16_bf16 v[64:79], a[240:243], v[48:51], v[64:79]
    v_mfma_f32_32x32x16_bf16 v[80:95], a[240:243], v[52:55], v[80:95]
    v_mfma_f32_32x32x16_bf16 v[96:111], a[244:247], v[48:51], v[96:111]
    v_mfma_f32_32x32x16_bf16 v[112:127], a[244:247], v[52:55], v[112:127]
    s_waitcnt lgkmcnt(0)
    v_mfma_f32_32x32x16_bf16 v[64:79], a[248:251], v[56:59], v[64:79]
    v_mfma_f32_32x32x16_bf16 v[80:95], a[248:251], v[60:63], v[80:95]
    v_mfma_f32_32x32x16_bf16 v[96:111], a[252:255], v[56:59], v[96:111]
    v_mfma_f32_32x32x16_bf16 v[112:127], a[252:255], v[60:63], v[112:127]
    v_lshl_add_u32 v40, v1, 4, s42
    s_cmp_ge_u32 s3, 2
    s_cselect_b32 s43, 0, 4
    s_lshl_b32 s43, s43, 1
    s_and_b32 s44, s3, 1
    s_add_u32 s43, s43, s44
    s_lshl_b32 s43, s43, 12
    s_add_u32 s44, s3, 1
    s_and_b32 s44, s44, 3
    s_mul_i32 s44, s44, 40960
    s_add_u32 s44, s44, s43
    v_lshl_add_u32 v41, v1, 4, s44
    s_add_u32 s44, s3, 2
    s_and_b32 s44, s44, 3
    s_mul_i32 s44, s44, 40960
    s_add_u32 s44, s44, s43
    v_lshl_add_u32 v42, v1, 4, s44
    s_add_u32 s44, s3, 3
    s_and_b32 s44, s44, 3
    s_mul_i32 s44, s44, 40960
    s_add_u32 s44, s44, s43
    v_lshl_add_u32 v43, v1, 4, s44
    s_nop 7
    s_cmp_eq_u32 s3, 0
    s_cbranch_scc1 L_xw_10
    ds_write_b128 v40, v[64:67] offset:32768
    ds_write_b128 v40, v[68:71] offset:33792
    ds_write_b128 v40, v[72:75] offset:34816
    ds_write_b128 v40, v[76:79] offset:35840
L_xw_10:
    s_cmp_eq_u32 s3, 1
    s_cbranch_scc1 L_xw_11
    ds_write_b128 v40, v[80:83] offset:36864
    ds_write_b128 v40, v[84:87] offset:37888
    ds_write_b128 v40, v[88:91] offset:38912
    ds_write_b128 v40, v[92:95] offset:39936
L_xw_11:
    s_cmp_eq_u32 s3, 2
    s_cbranch_scc1 L_xw_12
    ds_write_b128 v40, v[96:99] offset:0
    ds_write_b128 v40, v[100:103] offset:1024
    ds_write_b128 v40, v[104:107] offset:2048
    ds_write_b128 v40, v[108:111] offset:3072
L_xw_12:
    s_cmp_eq_u32 s3, 3
    s_cbranch_scc1 L_xw_13
    ds_write_b128 v40, v[112:115] offset:4096
    ds_write_b128 v40, v[116:119] offset:5120
    ds_write_b128 v40, v[120:123] offset:6144
    ds_write_b128 v40, v[124:127] offset:7168
L_xw_13:
    s_cmp_eq_u32 s3, 1
    s_cbranch_scc1 L_ow_16
    s_cmp_eq_u32 s3, 2
    s_cbranch_scc1 L_ow_17
    s_cmp_eq_u32 s3, 3
    s_cbranch_scc1 L_ow_18
L_ow_15:
    v_mov_b32 v128, v64
    v_mov_b32 v129, v65
    v_mov_b32 v130, v66
    v_mov_b32 v131, v67
    v_mov_b32 v132, v68
    v_mov_b32 v133, v69
    v_mov_b32 v134, v70
    v_mov_b32 v135, v71
    v_mov_b32 v136, v72
    v_mov_b32 v137, v73
    v_mov_b32 v138, v74
    v_mov_b32 v139, v75
    v_mov_b32 v140, v76
    v_mov_b32 v141, v77
    v_mov_b32 v142, v78
    v_mov_b32 v143, v79
    s_branch L_oe_14
L_ow_16:
    v_mov_b32 v128, v80
    v_mov_b32 v129, v81
    v_mov_b32 v130, v82
    v_mov_b32 v131, v83
    v_mov_b32 v132, v84
    v_mov_b32 v133, v85
    v_mov_b32 v134, v86
    v_mov_b32 v135, v87
    v_mov_b32 v136, v88
    v_mov_b32 v137, v89
    v_mov_b32 v138, v90
    v_mov_b32 v139, v91
    v_mov_b32 v140, v92
    v_mov_b32 v141, v93
    v_mov_b32 v142, v94
    v_mov_b32 v143, v95
    s_branch L_oe_14
L_ow_17:
    v_mov_b32 v128, v96
    v_mov_b32 v129, v97
    v_mov_b32 v130, v98
    v_mov_b32 v131, v99
    v_mov_b32 v132, v100
    v_mov_b32 v133, v101
    v_mov_b32 v134, v102
    v_mov_b32 v135, v103
    v_mov_b32 v136, v104
    v_mov_b32 v137, v105
    v_mov_b32 v138, v106
    v_mov_b32 v139, v107
    v_mov_b32 v140, v108
    v_mov_b32 v141, v109
    v_mov_b32 v142, v110
    v_mov_b32 v143, v111
    s_branch L_oe_14
L_ow_18:
    v_mov_b32 v128, v112
    v_mov_b32 v129, v113
    v_mov_b32 v130, v114
    v_mov_b32 v131, v115
    v_mov_b32 v132, v116
    v_mov_b32 v133, v117
    v_mov_b32 v134, v118
    v_mov_b32 v135, v119
    v_mov_b32 v136, v120
    v_mov_b32 v137, v121
    v_mov_b32 v138, v122
    v_mov_b32 v139, v123
    v_mov_b32 v140, v124
    v_mov_b32 v141, v125
    v_mov_b32 v142, v126
    v_mov_b32 v143, v127
L_oe_14:
    s_waitcnt vmcnt(16)
    ds_read_b64_tr_b16 a[0:1], v10 offset:8192
    ds_read_b64_tr_b16 a[2:3], v10 offset:8704
    ds_read_b64_tr_b16 a[4:5], v11 offset:8192
    ds_read_b64_tr_b16 a[6:7], v11 offset:8704
    ds_read_b64_tr_b16 a[8:9], v10 offset:10240
    ds_read_b64_tr_b16 a[10:11], v10 offset:10752
    ds_read_b64_tr_b16 a[12:13], v11 offset:10240
    ds_read_b64_tr_b16 a[14:15], v11 offset:10752
    ds_read_b64_tr_b16 a[16:17], v10 offset:12288
    ds_read_b64_tr_b16 a[18:19], v10 offset:12800
    ds_read_b64_tr_b16 a[20:21], v11 offset:12288
    ds_read_b64_tr_b16 a[22:23], v11 offset:12800
    ds_read_b64_tr_b16 a[24:25], v10 offset:14336
    ds_read_b64_tr_b16 a[26:27], v10 offset:14848
    ds_read_b64_tr_b16 a[28:29], v11 offset:14336
    ds_read_b64_tr_b16 a[30:31], v11 offset:14848
    s_waitcnt lgkmcnt(0)
    s_add_u32 m0, s42, 8192
    s_add_u32 s59, s58, 0
    buffer_load_dwordx4 v2, s[28:31], s59 offen lds
    s_add_u32 m0, s42, 9216
    s_add_u32 s59, s58, 8192
    buffer_load_dwordx4 v3, s[28:31], s59 offen lds
    s_add_u32 m0, s42, 10240
    s_add_u32 s59, s58, 16384
    buffer_load_dwordx4 v2, s[28:31], s59 offen lds
    s_add_u32 m0, s42, 11264
    s_add_u32 s59, s58, 24576
    buffer_load_dwordx4 v3, s[28:31], s59 offen lds
    s_add_u32 m0, s42, 12288
    s_add_u32 s59, s58, 32768
    buffer_load_dwordx4 v2, s[28:31], s59 offen lds
    s_add_u32 m0, s42, 13312
    s_add_u32 s59, s58, 40960
    buffer_load_dwordx4 v3, s[28:31], s59 offen lds
    s_add_u32 m0, s42, 14336
    s_add_u32 s59, s58, 49152
    buffer_load_dwordx4 v2, s[28:31], s59 offen lds
    s_add_u32 m0, s42, 15360
    s_add_u32 s59, s58, 57344
    buffer_load_dwordx4 v3, s[28:31], s59 offen lds
    s_waitcnt lgkmcnt(0)
    s_barrier
    ds_read_b128 v[144:147], v41 offset:0
    ds_read_b128 v[148:151], v41 offset:1024
    ds_read_b128 v[152:155], v41 offset:2048
    ds_read_b128 v[156:159], v41 offset:3072
    ds_read_b128 v[160:163], v42 offset:0
    ds_read_b128 v[164:167], v42 offset:1024
    ds_read_b128 v[168:171], v42 offset:2048
    ds_read_b128 v[172:175], v42 offset:3072
    ds_read_b128 v[176:179], v43 offset:0
    ds_read_b128 v[180:183], v43 offset:1024
    ds_read_b128 v[184:187], v43 offset:2048
    ds_read_b128 v[188:191], v43 offset:3072
    s_waitcnt lgkmcnt(0)
    v_add_f32 v128, v128, v144
    v_add_f32 v160, v160, v176
    v_add_f32 v129, v129, v145
    v_add_f32 v161, v161, v177
    v_add_f32 v130, v130, v146
    v_add_f32 v162, v162, v178
    v_add_f32 v131, v131, v147
    v_add_f32 v163, v163, v179
    v_add_f32 v132, v132, v148
    v_add_f32 v164, v164, v180
    v_add_f32 v133, v133, v149
    v_add_f32 v165, v165, v181
    v_add_f32 v134, v134, v150
    v_add_f32 v166, v166, v182
    v_add_f32 v135, v135, v151
    v_add_f32 v167, v167, v183
    v_add_f32 v136, v136, v152
    v_add_f32 v168, v168, v184
    v_add_f32 v137, v137, v153
    v_add_f32 v169, v169, v185
    v_add_f32 v138, v138, v154
    v_add_f32 v170, v170, v186
    v_add_f32 v139, v139, v155
    v_add_f32 v171, v171, v187
    v_add_f32 v140, v140, v156
    v_add_f32 v172, v172, v188
    v_add_f32 v141, v141, v157
    v_add_f32 v173, v173, v189
    v_add_f32 v142, v142, v158
    v_add_f32 v174, v174, v190
    v_add_f32 v143, v143, v159
    v_add_f32 v175, v175, v191
    v_add_f32 v64, v128, v160
    v_add_f32 v65, v129, v161
    v_add_f32 v66, v130, v162
    v_add_f32 v67, v131, v163
    v_add_f32 v68, v132, v164
    v_add_f32 v69, v133, v165
    v_add_f32 v70, v134, v166
    v_add_f32 v71, v135, v167
    v_add_f32 v72, v136, v168
    v_add_f32 v73, v137, v169
    v_add_f32 v74, v138, v170
    v_add_f32 v75, v139, v171
    v_add_f32 v76, v140, v172
    v_add_f32 v77, v141, v173
    v_add_f32 v78, v142, v174
    v_add_f32 v79, v143, v175
    s_waitcnt vmcnt(16)
    ds_read_b64_tr_b16 a[32:33], v10 offset:16384
    ds_read_b64_tr_b16 a[34:35], v10 offset:16896
    ds_read_b64_tr_b16 a[36:37], v11 offset:16384
    ds_read_b64_tr_b16 a[38:39], v11 offset:16896
    ds_read_b64_tr_b16 a[40:41], v10 offset:18432
    ds_read_b64_tr_b16 a[42:43], v10 offset:18944
    ds_read_b64_tr_b16 a[44:45], v11 offset:18432
    ds_read_b64_tr_b16 a[46:47], v11 offset:18944
    ds_read_b64_tr_b16 a[48:49], v10 offset:20480
    ds_read_b64_tr_b16 a[50:51], v10 offset:20992
    ds_read_b64_tr_b16 a[52:53], v11 offset:20480
    ds_read_b64_tr_b16 a[54:55], v11 offset:20992
    ds_read_b64_tr_b16 a[56:57], v10 offset:22528
    ds_read_b64_tr_b16 a[58:59], v10 offset:23040
    ds_read_b64_tr_b16 a[60:61], v11 offset:22528
    ds_read_b64_tr_b16 a[62:63], v11 offset:23040
    s_waitcnt lgkmcnt(0)
    s_add_u32 m0, s42, 16384
    s_add_u32 s59, s58, 0
    buffer_load_dwordx4 v2, s[36:39], s59 offen lds
    s_add_u32 m0, s42, 17408
    s_add_u32 s59, s58, 8192
    buffer_load_dwordx4 v3, s[36:39], s59 offen lds
    s_add_u32 m0, s42, 18432
    s_add_u32 s59, s58, 16384
    buffer_load_dwordx4 v2, s[36:39], s59 offen lds
    s_add_u32 m0, s42, 19456
    s_add_u32 s59, s58, 24576
    buffer_load_dwordx4 v3, s[36:39], s59 offen lds
    s_add_u32 m0, s42, 20480
    s_add_u32 s59, s58, 32768
    buffer_load_dwordx4 v2, s[36:39], s59 offen lds
    s_add_u32 m0, s42, 21504
    s_add_u32 s59, s58, 40960
    buffer_load_dwordx4 v3, s[36:39], s59 offen lds
    s_add_u32 m0, s42, 22528
    s_add_u32 s59, s58, 49152
    buffer_load_dwordx4 v2, s[36:39], s59 offen lds
    s_add_u32 m0, s42, 23552
    s_add_u32 s59, s58, 57344
    buffer_load_dwordx4 v3, s[36:39], s59 offen lds
    v_cvt_pk_bf16_f32 v80, v64, v65
    v_lshlrev_b32 v81, 16, v80
    v_and_b32 v80, 0xffff0000, v80
    v_lshlrev_b32 v82, 16, v20
    v_and_b32 v83, 0xffff0000, v20
    v_add_f32 v81, v81, v82
    v_add_f32 v80, v80, v83
    v_cvt_pk_bf16_f32 v80, v81, v80
    v_lshlrev_b32 v64, 16, v80
    v_and_b32 v65, 0xffff0000, v80
    v_cvt_pk_bf16_f32 v80, v66, v67
    v_lshlrev_b32 v81, 16, v80
    v_and_b32 v80, 0xffff0000, v80
    v_lshlrev_b32 v82, 16, v21
    v_and_b32 v83, 0xffff0000, v21
    v_add_f32 v81, v81, v82
    v_add_f32 v80, v80, v83
    v_cvt_pk_bf16_f32 v80, v81, v80
    v_lshlrev_b32 v66, 16, v80
    v_and_b32 v67, 0xffff0000, v80
    v_cvt_pk_bf16_f32 v80, v68, v69
    v_lshlrev_b32 v81, 16, v80
    v_and_b32 v80, 0xffff0000, v80
    v_lshlrev_b32 v82, 16, v22
    v_and_b32 v83, 0xffff0000, v22
    v_add_f32 v81, v81, v82
    v_add_f32 v80, v80, v83
    v_cvt_pk_bf16_f32 v80, v81, v80
    v_lshlrev_b32 v68, 16, v80
    v_and_b32 v69, 0xffff0000, v80
    v_cvt_pk_bf16_f32 v80, v70, v71
    v_lshlrev_b32 v81, 16, v80
    v_and_b32 v80, 0xffff0000, v80
    v_lshlrev_b32 v82, 16, v23
    v_and_b32 v83, 0xffff0000, v23
    v_add_f32 v81, v81, v82
    v_add_f32 v80, v80, v83
    v_cvt_pk_bf16_f32 v80, v81, v80
    v_lshlrev_b32 v70, 16, v80
    v_and_b32 v71, 0xffff0000, v80
    v_cvt_pk_bf16_f32 v80, v72, v73
    v_lshlrev_b32 v81, 16, v80
    v_and_b32 v80, 0xffff0000, v80
    v_lshlrev_b32 v82, 16, v24
    v_and_b32 v83, 0xffff0000, v24
    v_add_f32 v81, v81, v82
    v_add_f32 v80, v80, v83
    v_cvt_pk_bf16_f32 v80, v81, v80
    v_lshlrev_b32 v72, 16, v80
    v_and_b32 v73, 0xffff0000, v80
    v_cvt_pk_bf16_f32 v80, v74, v75
    v_lshlrev_b32 v81, 16, v80
    v_and_b32 v80, 0xffff0000, v80
    v_lshlrev_b32 v82, 16, v25
    v_and_b32 v83, 0xffff0000, v25
    v_add_f32 v81, v81, v82
    v_add_f32 v80, v80, v83
    v_cvt_pk_bf16_f32 v80, v81, v80
    v_lshlrev_b32 v74, 16, v80
    v_and_b32 v75, 0xffff0000, v80
    v_cvt_pk_bf16_f32 v80, v76, v77
    v_lshlrev_b32 v81, 16, v80
    v_and_b32 v80, 0xffff0000, v80
    v_lshlrev_b32 v82, 16, v26
    v_and_b32 v83, 0xffff0000, v26
    v_add_f32 v81, v81, v82
    v_add_f32 v80, v80, v83
    v_cvt_pk_bf16_f32 v80, v81, v80
    v_lshlrev_b32 v76, 16, v80
    v_and_b32 v77, 0xffff0000, v80
    v_cvt_pk_bf16_f32 v80, v78, v79
    v_lshlrev_b32 v81, 16, v80
    v_and_b32 v80, 0xffff0000, v80
    v_lshlrev_b32 v82, 16, v27
    v_and_b32 v83, 0xffff0000, v27
    v_add_f32 v81, v81, v82
    v_add_f32 v80, v80, v83
    v_cvt_pk_bf16_f32 v80, v81, v80
    v_lshlrev_b32 v78, 16, v80
    v_and_b32 v79, 0xffff0000, v80
    s_mov_b32 s43, 0xc0135761
    s_mov_b32 s44, 0xbdd2d3e8
    v_mov_b32 v100, s43
    v_mul_f32 v80, v64, v64
    v_fma_f32 v80, v80, s44, v100
    v_mul_f32 v80, v80, v64
    v_exp_f32 v80, v80
    v_mul_f32 v81, v65, v65
    v_fma_f32 v81, v81, s44, v100
    v_mul_f32 v81, v81, v65
    v_exp_f32 v81, v81
    v_mul_f32 v82, v66, v66
    v_fma_f32 v82, v82, s44, v100
    v_mul_f32 v82, v82, v66
    v_exp_f32 v82, v82
    v_mul_f32 v83, v67, v67
    v_fma_f32 v83, v83, s44, v100
    v_mul_f32 v83, v83, v67
    v_exp_f32 v83, v83
    v_mul_f32 v84, v68, v68
    v_fma_f32 v84, v84, s44, v100
    v_mul_f32 v84, v84, v68
    v_exp_f32 v84, v84
    v_mul_f32 v85, v69, v69
    v_fma_f32 v85, v85, s44, v100
    v_mul_f32 v85, v85, v69
    v_exp_f32 v85, v85
    v_mul_f32 v86, v70, v70
    v_fma_f32 v86, v86, s44, v100
    v_mul_f32 v86, v86, v70
    v_exp_f32 v86, v86
    v_mul_f32 v87, v71, v71
    v_fma_f32 v87, v87, s44, v100
    v_mul_f32 v87, v87, v71
    v_exp_f32 v87, v87
    v_mul_f32 v88, v72, v72
    v_fma_f32 v88, v88, s44, v100
    v_mul_f32 v88, v88, v72
    v_exp_f32 v88, v88
    v_mul_f32 v89, v73, v73
    v_fma_f32 v89, v89, s44, v100
    v_mul_f32 v89, v89, v73
    v_exp_f32 v89, v89
    v_mul_f32 v90, v74, v74
    v_fma_f32 v90, v90, s44, v100
    v_mul_f32 v90, v90, v74
    v_exp_f32 v90, v90
    v_mul_f32 v91, v75, v75
    v_fma_f32 v91, v91, s44, v100
    v_mul_f32 v91, v91, v75
    v_exp_f32 v91, v91
    v_mul_f32 v92, v76, v76
    v_fma_f32 v92, v92, s44, v100
    v_mul_f32 v92, v92, v76
    v_exp_f32 v92, v92
    v_mul_f32 v93, v77, v77
    v_fma_f32 v93, v93, s44, v100
    v_mul_f32 v93, v93, v77
    v_exp_f32 v93, v93
    v_mul_f32 v94, v78, v78
    v_fma_f32 v94, v94, s44, v100
    v_mul_f32 v94, v94, v78
    v_exp_f32 v94, v94
    v_mul_f32 v95, v79, v79
    v_fma_f32 v95, v95, s44, v100
    v_mul_f32 v95, v95, v79
    v_exp_f32 v95, v95
    v_add_f32 v80, 1.0, v80
    v_rcp_f32 v80, v80
    v_add_f32 v81, 1.0, v81
    v_rcp_f32 v81, v81
    v_add_f32 v82, 1.0, v82
    v_rcp_f32 v82, v82
    v_add_f32 v83, 1.0, v83
    v_rcp_f32 v83, v83
    v_add_f32 v84, 1.0, v84
    v_rcp_f32 v84, v84
    v_add_f32 v85, 1.0, v85
    v_rcp_f32 v85, v85
    v_add_f32 v86, 1.0, v86
    v_rcp_f32 v86, v86
    v_add_f32 v87, 1.0, v87
    v_rcp_f32 v87, v87
    v_add_f32 v88, 1.0, v88
    v_rcp_f32 v88, v88
    v_add_f32 v89, 1.0, v89
    v_rcp_f32 v89, v89
    v_add_f32 v90, 1.0, v90
    v_rcp_f32 v90, v90
    v_add_f32 v91, 1.0, v91
    v_rcp_f32 v91, v91
    v_add_f32 v92, 1.0, v92
    v_rcp_f32 v92, v92
    v_add_f32 v93, 1.0, v93
    v_rcp_f32 v93, v93
    v_add_f32 v94, 1.0, v94
    v_rcp_f32 v94, v94
    v_add_f32 v95, 1.0, v95
    v_rcp_f32 v95, v95
    s_nop 0
    v_mul_f32 v64, v64, v80
    v_mul_f32 v65, v65, v81
    v_mul_f32 v66, v66, v82
    v_mul_f32 v67, v67, v83
    v_mul_f32 v68, v68, v84
    v_mul_f32 v69, v69, v85
    v_mul_f32 v70, v70, v86
    v_mul_f32 v71, v71, v87
    v_mul_f32 v72, v72, v88
    v_mul_f32 v73, v73, v89
    v_mul_f32 v74, v74, v90
    v_mul_f32 v75, v75, v91
    v_mul_f32 v76, v76, v92
    v_mul_f32 v77, v77, v93
    v_mul_f32 v78, v78, v94
    v_mul_f32 v79, v79, v95
    v_cvt_pk_bf16_f32 v80, v64, v65
    v_cvt_pk_bf16_f32 v81, v66, v67
    v_cvt_pk_bf16_f32 v82, v68, v69
    v_cvt_pk_bf16_f32 v83, v70, v71
    v_cvt_pk_bf16_f32 v84, v72, v73
    v_cvt_pk_bf16_f32 v85, v74, v75
    v_cvt_pk_bf16_f32 v86, v76, v77
    v_cvt_pk_bf16_f32 v87, v78, v79
    s_waitcnt vmcnt(16)
    ds_read_b64_tr_b16 a[64:65], v10 offset:24576
    ds_read_b64_tr_b16 a[66:67], v10 offset:25088
    ds_read_b64_tr_b16 a[68:69], v11 offset:24576
    ds_read_b64_tr_b16 a[70:71], v11 offset:25088
    ds_read_b64_tr_b16 a[72:73], v10 offset:26624
    ds_read_b64_tr_b16 a[74:75], v10 offset:27136
    ds_read_b64_tr_b16 a[76:77], v11 offset:26624
    ds_read_b64_tr_b16 a[78:79], v11 offset:27136
    ds_read_b64_tr_b16 a[80:81], v10 offset:28672
    ds_read_b64_tr_b16 a[82:83], v10 offset:29184
    ds_read_b64_tr_b16 a[84:85], v11 offset:28672
    ds_read_b64_tr_b16 a[86:87], v11 offset:29184
    ds_read_b64_tr_b16 a[88:89], v10 offset:30720
    ds_read_b64_tr_b16 a[90:91], v10 offset:31232
    ds_read_b64_tr_b16 a[92:93], v11 offset:30720
    ds_read_b64_tr_b16 a[94:95], v11 offset:31232
    s_waitcnt lgkmcnt(0)
    s_add_u32 m0, s42, 24576
    s_add_u32 s59, s58, 128
    buffer_load_dwordx4 v2, s[28:31], s59 offen lds
    s_add_u32 m0, s42, 25600
    s_add_u32 s59, s58, 8320
    buffer_load_dwordx4 v3, s[28:31], s59 offen lds
    s_add_u32 m0, s42, 26624
    s_add_u32 s59, s58, 16512
    buffer_load_dwordx4 v2, s[28:31], s59 offen lds
    s_add_u32 m0, s42, 27648
    s_add_u32 s59, s58, 24704
    buffer_load_dwordx4 v3, s[28:31], s59 offen lds
    s_add_u32 m0, s42, 28672
    s_add_u32 s59, s58, 32896
    buffer_load_dwordx4 v2, s[28:31], s59 offen lds
    s_add_u32 m0, s42, 29696
    s_add_u32 s59, s58, 41088
    buffer_load_dwordx4 v3, s[28:31], s59 offen lds
    s_add_u32 m0, s42, 30720
    s_add_u32 s59, s58, 49280
    buffer_load_dwordx4 v2, s[28:31], s59 offen lds
    s_add_u32 m0, s42, 31744
    s_add_u32 s59, s58, 57472
    buffer_load_dwordx4 v3, s[28:31], s59 offen lds
    s_lshr_b32 s43, s52, 1
    s_lshl_b32 s43, s43, 2
    s_add_u32 s43, s43, s3
    s_lshl_b32 s43, s43, 7
    s_add_u32 s43, s43, 32768
    v_lshl_add_u32 v14, v1, 5, s43
    s_mov_b64 exec, 15
    buffer_load_dwordx2 v[18:19], v14, s[4:7], 0 offen sc1
    s_mov_b64 exec, -1
    s_lshl_b32 s43, s55, 1
    s_lshr_b32 s44, s3, 1
    s_add_u32 s43, s43, s44
    s_cmp_ge_u32 s43, 43
    s_cselect_b32 s44, 0, -1
    v_and_b32 v80, s44, v80
    v_and_b32 v81, s44, v81
    v_and_b32 v82, s44, v82
    v_and_b32 v83, s44, v83
    v_and_b32 v84, s44, v84
    v_and_b32 v85, s44, v85
    v_and_b32 v86, s44, v86
    v_and_b32 v87, s44, v87
    s_and_b32 s44, s43, 1
    s_lshl_b32 s44, s44, 12
    s_mul_i32 s43, s56, 22
    s_add_u32 s43, s43, s55
    s_lshl_b32 s43, s43, 13
    s_add_u32 s43, s43, s44
    v_lshrrev_b32 v17, 5, v1
    v_lshl_add_u32 v17, v17, 4, s43
    v_permlane32_swap_b32 v80, v82
    v_permlane32_swap_b32 v81, v83
    v_permlane32_swap_b32 v84, v86
    v_permlane32_swap_b32 v85, v87
    v_bfe_u32 v15, v1, 4, 1
    v_lshl_add_u32 v17, v15, 5, v17
    v_permlane16_swap_b32 v80, v84
    v_permlane16_swap_b32 v81, v85
    v_permlane16_swap_b32 v82, v86
    v_permlane16_swap_b32 v83, v87
    s_lshl_b32 s43, s56, 1
    s_and_b32 s44, s3, 1
    s_mov_b32 s43, s44
    s_lshl_b32 s43, s43, 5
    v_and_b32 v14, 15, v1
    v_add_u32 v14, s43, v14
    v_mul_u32_u24 v14, 64, v14
    v_add_u32 v14, v14, v17
    buffer_store_dwordx4 v[80:83], v14, s[20:23], 0 offen sc1
    buffer_store_dwordx4 v[84:87], v14, s[20:23], 0 offen offset:1024 sc1
    s_barrier
    s_add_u32 m0, s42, 32768
    s_add_u32 s59, s58, 128
    buffer_load_dwordx4 v2, s[36:39], s59 offen lds
    s_add_u32 m0, s42, 33792
    s_add_u32 s59, s58, 8320
    buffer_load_dwordx4 v3, s[36:39], s59 offen lds
    s_add_u32 m0, s42, 34816
    s_add_u32 s59, s58, 16512
    buffer_load_dwordx4 v2, s[36:39], s59 offen lds
    s_add_u32 m0, s42, 35840
    s_add_u32 s59, s58, 24704
    buffer_load_dwordx4 v3, s[36:39], s59 offen lds
    s_add_u32 m0, s42, 36864
    s_add_u32 s59, s58, 32896
    buffer_load_dwordx4 v2, s[36:39], s59 offen lds
    s_add_u32 m0, s42, 37888
    s_add_u32 s59, s58, 41088
    buffer_load_dwordx4 v3, s[36:39], s59 offen lds
    s_add_u32 m0, s42, 38912
    s_add_u32 s59, s58, 49280
    buffer_load_dwordx4 v2, s[36:39], s59 offen lds
    s_add_u32 m0, s42, 39936
    s_add_u32 s59, s58, 57472
    buffer_load_dwordx4 v3, s[36:39], s59 offen lds
    s_waitcnt vmcnt(19)
    ds_read_b128 v[32:35], v6 offset:8192
    ds_read_b128 v[36:39], v6 offset:12288
    ds_read_b128 v[40:43], v6 offset:16384
    ds_read_b128 v[44:47], v6 offset:20480
    ds_read_b128 v[48:51], v7 offset:8192
    ds_read_b128 v[52:55], v7 offset:12288
    ds_read_b128 v[56:59], v7 offset:16384
    ds_read_b128 v[60:63], v7 offset:20480
    s_waitcnt lgkmcnt(4)
    v_perm_b32 v128, v40, v32, s50
    v_perm_b32 v129, v40, v32, s51
    v_perm_b32 v130, v41, v33, s50
    v_perm_b32 v131, v41, v33, s51
    v_perm_b32 v136, v42, v34, s50
    v_perm_b32 v137, v42, v34, s51
    v_perm_b32 v138, v43, v35, s50
    v_perm_b32 v139, v43, v35, s51
    v_perm_b32 v132, v44, v36, s50
    v_perm_b32 v133, v44, v36, s51
    v_perm_b32 v134, v45, v37, s50
    v_perm_b32 v135, v45, v37, s51
    v_perm_b32 v140, v46, v38, s50
    v_perm_b32 v141, v46, v38, s51
    v_perm_b32 v142, v47, v39, s50
    v_perm_b32 v143, v47, v39, s51
    s_waitcnt lgkmcnt(0)
    v_perm_b32 v144, v56, v48, s50
    v_perm_b32 v145, v56, v48, s51
    v_perm_b32 v146, v57, v49, s50
    v_perm_b32 v147, v57, v49, s51
    v_perm_b32 v152, v58, v50, s50
    v_perm_b32 v153, v58, v50, s51
    v_perm_b32 v154, v59, v51, s50
    v_perm_b32 v155, v59, v51, s51
    v_perm_b32 v148, v60, v52, s50
    v_perm_b32 v149, v60, v52, s51
    v_perm_b32 v150, v61, v53, s50
    v_perm_b32 v151, v61, v53, s51
    v_perm_b32 v156, v62, v54, s50
    v_perm_b32 v157, v62, v54, s51
    v_perm_b32 v158, v63, v55, s50
    v_perm_b32 v159, v63, v55, s51
    ds_read_b128 v[32:35], v8 offset:8192
    ds_read_b128 v[36:39], v8 offset:12288
    ds_read_b128 v[40:43], v8 offset:16384
    ds_read_b128 v[44:47], v8 offset:20480
    ds_read_b128 v[48:51], v9 offset:8192
    ds_read_b128 v[52:55], v9 offset:12288
    ds_read_b128 v[56:59], v9 offset:16384
    ds_read_b128 v[60:63], v9 offset:20480
    s_waitcnt lgkmcnt(4)
    v_perm_b32 v160, v40, v32, s50
    v_perm_b32 v161, v40, v32, s51
    v_perm_b32 v162, v41, v33, s50
    v_perm_b32 v163, v41, v33, s51
    v_perm_b32 v168, v42, v34, s50
    v_perm_b32 v169, v42, v34, s51
    v_perm_b32 v170, v43, v35, s50
    v_perm_b32 v171, v43, v35, s51
    v_perm_b32 v164, v44, v36, s50
    v_perm_b32 v165, v44, v36, s51
    v_perm_b32 v166, v45, v37, s50
    v_perm_b32 v167, v45, v37, s51
    v_perm_b32 v172, v46, v38, s50
    v_perm_b32 v173, v46, v38, s51
    v_perm_b32 v174, v47, v39, s50
    v_perm_b32 v175, v47, v39, s51
    s_waitcnt lgkmcnt(0)
    v_perm_b32 v176, v56, v48, s50
    v_perm_b32 v177, v56, v48, s51
    v_perm_b32 v178, v57, v49, s50
    v_perm_b32 v179, v57, v49, s51
    v_perm_b32 v184, v58, v50, s50
    v_perm_b32 v185, v58, v50, s51
    v_perm_b32 v186, v59, v51, s50
    v_perm_b32 v187, v59, v51, s51
    v_perm_b32 v180, v60, v52, s50
    v_perm_b32 v181, v60, v52, s51
    v_perm_b32 v182, v61, v53, s50
    v_perm_b32 v183, v61, v53, s51
    v_perm_b32 v188, v62, v54, s50
    v_perm_b32 v189, v62, v54, s51
    v_perm_b32 v190, v63, v55, s50
    v_perm_b32 v191, v63, v55, s51
    s_waitcnt vmcnt(8)
    s_mov_b64 exec, 1
    s_lshl_b32 s60, s54, 5
    s_add_u32 s60, s60, 8192
    v_mov_b32 v14, s100
    v_mov_b32 v15, s101
    buffer_store_dwordx2 v[14:15], off, s[4:7], s60 sc1
    s_mov_b64 exec, -1
    s_add_u32 s8, s98, 8388608
    s_addc_u32 s9, s99, 0
    s_and_b32 s9, s9, 0xffff
    s_mov_b32 s10, 4194304
    s_mov_b32 s11, 0x00020000
    s_add_u32 s12, s98, 4194304
    s_addc_u32 s13, s99, 0
    s_and_b32 s13, s13, 0xffff
    s_mov_b32 s14, 1441792
    s_mov_b32 s15, 0x00020000
    s_lshl_b32 s57, s52, 17
    s_lshl_b32 s43, s3, 9
    s_add_u32 s57, s57, s43
    s_mul_i32 s83, s3, 6
    s_cmp_eq_u32 s3, 3
    s_cselect_b32 s83, 17, s83
    s_lshl_b32 s83, s83, 13
    s_mul_i32 s43, s53, 180224
    s_add_u32 s83, s83, s43
    s_cmp_ge_u32 s3, 2
    s_cselect_b32 s82, 0x40000000, 0
    s_add_u32 s82, s82, s83
    v_lshrrev_b32 v14, 3, v1
    v_mul_u32_u24 v14, 2048, v14
    v_and_b32 v15, 7, v1
    v_lshrrev_b32 v16, 4, v1
    v_xor_b32 v15, v15, v16
    v_lshlrev_b32 v15, 4, v15
    v_add_u32 v28, v14, v15
    v_xor_b32 v15, 64, v15
    v_add_u32 v29, v14, v15
    v_and_b32 v14, 31, v1
    v_lshrrev_b32 v15, 1, v14
    v_and_b32 v15, 7, v15
    v_lshrrev_b32 v16, 5, v1
    v_lshlrev_b32 v16, 1, v16
    v_xor_b32 v15, v15, v16
    v_lshlrev_b32 v15, 4, v15
    v_lshl_add_u32 v14, v14, 7, v15
    v_add_u32 v24, s42, v14
    v_xor_b32 v25, 16, v24
    v_xor_b32 v26, 64, v24
    v_xor_b32 v27, 80, v24
    s_lshr_b32 s43, s52, 1
    s_lshl_b32 s43, s43, 2
    s_add_u32 s43, s43, s3
    s_lshl_b32 s43, s43, 7
    s_add_u32 s43, s43, 32768
    v_lshl_add_u32 v14, v1, 5, s43
    s_mov_b64 exec, 15
    s_mov_b32 s60, 20000
    s_branch L_pollc_20
L_poll_19:
    buffer_load_dwordx2 v[18:19], v14, s[4:7], 0 offen sc1
    s_waitcnt vmcnt(0)
L_pollc_20:
    v_cmp_ne_u64 vcc, s[100:101], v[18:19]
    s_cbranch_vccz L_polld_21
    s_sleep 4
    s_sub_u32 s60, s60, 1
    s_cmp_lg_u32 s60, 0
    s_cbranch_scc1 L_poll_19
L_polld_21:
    s_mov_b64 exec, -1
    s_add_u32 m0, s42, 0
    s_add_u32 s59, s57, 0
    buffer_load_dwordx4 v28, s[8:11], s59 offen lds
    s_add_u32 m0, s42, 1024
    s_add_u32 s59, s57, 16384
    buffer_load_dwordx4 v29, s[8:11], s59 offen lds
    s_add_u32 m0, s42, 2048
    s_add_u32 s59, s57, 32768
    buffer_load_dwordx4 v28, s[8:11], s59 offen lds
    s_add_u32 m0, s42, 3072
    s_add_u32 s59, s57, 49152
    buffer_load_dwordx4 v29, s[8:11], s59 offen lds
    s_add_u32 m0, s42, 4096
    s_add_u32 s59, s57, 65536
    buffer_load_dwordx4 v28, s[8:11], s59 offen lds
    s_add_u32 m0, s42, 5120
    s_add_u32 s59, s57, 81920
    buffer_load_dwordx4 v29, s[8:11], s59 offen lds
    s_add_u32 m0, s42, 6144
    s_add_u32 s59, s57, 98304
    buffer_load_dwordx4 v28, s[8:11], s59 offen lds
    s_add_u32 m0, s42, 7168
    s_add_u32 s59, s57, 114688
    buffer_load_dwordx4 v29, s[8:11], s59 offen lds
    s_add_u32 m0, s42, 8192
    s_add_u32 s59, s61, 786432
    buffer_load_dwordx4 v12, s[32:35], s59 offen lds
    s_add_u32 m0, s42, 9216
    s_add_u32 s59, s61, 819200
    buffer_load_dwordx4 v12, s[32:35], s59 offen lds
    s_add_u32 m0, s42, 10240
    s_add_u32 s59, s61, 851968
    buffer_load_dwordx4 v12, s[32:35], s59 offen lds
    s_add_u32 m0, s42, 11264
    s_add_u32 s59, s61, 884736
    buffer_load_dwordx4 v12, s[32:35], s59 offen lds
    s_add_u32 m0, s42, 12288
    s_add_u32 s59, s61, 917504
    buffer_load_dwordx4 v12, s[32:35], s59 offen lds
    s_add_u32 m0, s42, 13312
    s_add_u32 s59, s61, 950272
    buffer_load_dwordx4 v12, s[32:35], s59 offen lds
    s_add_u32 m0, s42, 14336
    s_add_u32 s59, s61, 983040
    buffer_load_dwordx4 v12, s[32:35], s59 offen lds
    s_add_u32 m0, s42, 15360
    s_add_u32 s59, s61, 1015808
    buffer_load_dwordx4 v12, s[32:35], s59 offen lds
    s_add_u32 m0, s42, 16384
    s_add_u32 s59, s57, 128
    buffer_load_dwordx4 v28, s[8:11], s59 offen lds
    s_add_u32 m0, s42, 17408
    s_add_u32 s59, s57, 16512
    buffer_load_dwordx4 v29, s[8:11], s59 offen lds
    s_add_u32 m0, s42, 18432
    s_add_u32 s59, s57, 32896
    buffer_load_dwordx4 v28, s[8:11], s59 offen lds
    s_add_u32 m0, s42, 19456
    s_add_u32 s59, s57, 49280
    buffer_load_dwordx4 v29, s[8:11], s59 offen lds
    s_add_u32 m0, s42, 20480
    s_add_u32 s59, s57, 65664
    buffer_load_dwordx4 v28, s[8:11], s59 offen lds
    s_add_u32 m0, s42, 21504
    s_add_u32 s59, s57, 82048
    buffer_load_dwordx4 v29, s[8:11], s59 offen lds
    s_add_u32 m0, s42, 22528
    s_add_u32 s59, s57, 98432
    buffer_load_dwordx4 v28, s[8:11], s59 offen lds
    s_add_u32 m0, s42, 23552
    s_add_u32 s59, s57, 114816
    buffer_load_dwordx4 v29, s[8:11], s59 offen lds
    s_waitcnt vmcnt(25)
    ds_read_b128 v[32:35], v6 offset:24576
    ds_read_b128 v[36:39], v6 offset:28672
    ds_read_b128 v[40:43], v6 offset:32768
    ds_read_b128 v[44:47], v6 offset:36864
    ds_read_b128 v[48:51], v7 offset:24576
    ds_read_b128 v[52:55], v7 offset:28672
    ds_read_b128 v[56:59], v7 offset:32768
    ds_read_b128 v[60:63], v7 offset:36864
    s_waitcnt lgkmcnt(4)
    v_perm_b32 v192, v40, v32, s50
    v_perm_b32 v193, v40, v32, s51
    v_perm_b32 v194, v41, v33, s50
    v_perm_b32 v195, v41, v33, s51
    v_perm_b32 v200, v42, v34, s50
    v_perm_b32 v201, v42, v34, s51
    v_perm_b32 v202, v43, v35, s50
    v_perm_b32 v203, v43, v35, s51
    v_perm_b32 v196, v44, v36, s50
    v_perm_b32 v197, v44, v36, s51
    v_perm_b32 v198, v45, v37, s50
    v_perm_b32 v199, v45, v37, s51
    v_perm_b32 v204, v46, v38, s50
    v_perm_b32 v205, v46, v38, s51
    v_perm_b32 v206, v47, v39, s50
    v_perm_b32 v207, v47, v39, s51
    s_waitcnt lgkmcnt(0)
    v_perm_b32 v208, v56, v48, s50
    v_perm_b32 v209, v56, v48, s51
    v_perm_b32 v210, v57, v49, s50
    v_perm_b32 v211, v57, v49, s51
    v_perm_b32 v216, v58, v50, s50
    v_perm_b32 v217, v58, v50, s51
    v_perm_b32 v218, v59, v51, s50
    v_perm_b32 v219, v59, v51, s51
    v_perm_b32 v212, v60, v52, s50
    v_perm_b32 v213, v60, v52, s51
    v_perm_b32 v214, v61, v53, s50
    v_perm_b32 v215, v61, v53, s51
    v_perm_b32 v220, v62, v54, s50
    v_perm_b32 v221, v62, v54, s51
    v_perm_b32 v222, v63, v55, s50
    v_perm_b32 v223, v63, v55, s51
    ds_read_b128 v[32:35], v8 offset:24576
    ds_read_b128 v[36:39], v8 offset:28672
    ds_read_b128 v[40:43], v8 offset:32768
    ds_read_b128 v[44:47], v8 offset:36864
    ds_read_b128 v[48:51], v9 offset:24576
    ds_read_b128 v[52:55], v9 offset:28672
    ds_read_b128 v[56:59], v9 offset:32768
    ds_read_b128 v[60:63], v9 offset:36864
    s_waitcnt lgkmcnt(4)
    v_perm_b32 v224, v40, v32, s50
    v_perm_b32 v225, v40, v32, s51
    v_perm_b32 v226, v41, v33, s50
    v_perm_b32 v227, v41, v33, s51
    v_perm_b32 v232, v42, v34, s50
    v_perm_b32 v233, v42, v34, s51
    v_perm_b32 v234, v43, v35, s50
    v_perm_b32 v235, v43, v35, s51
    v_perm_b32 v228, v44, v36, s50
    v_perm_b32 v229, v44, v36, s51
    v_perm_b32 v230, v45, v37, s50
    v_perm_b32 v231, v45, v37, s51
    v_perm_b32 v236, v46, v38, s50
    v_perm_b32 v237, v46, v38, s51
    v_perm_b32 v238, v47, v39, s50
    v_perm_b32 v239, v47, v39, s51
    s_waitcnt lgkmcnt(0)
    v_perm_b32 v240, v56, v48, s50
    v_perm_b32 v241, v56, v48, s51
    v_perm_b32 v242, v57, v49, s50
    v_perm_b32 v243, v57, v49, s51
    v_perm_b32 v248, v58, v50, s50
    v_perm_b32 v249, v58, v50, s51
    v_perm_b32 v250, v59, v51, s50
    v_perm_b32 v251, v59, v51, s51
    v_perm_b32 v244, v60, v52, s50
    v_perm_b32 v245, v60, v52, s51
    v_perm_b32 v246, v61, v53, s50
    v_perm_b32 v247, v61, v53, s51
    v_perm_b32 v252, v62, v54, s50
    v_perm_b32 v253, v62, v54, s51
    v_perm_b32 v254, v63, v55, s50
    v_perm_b32 v255, v63, v55, s51
    s_add_u32 m0, s42, 24576
    s_add_u32 s59, s61, 1048576
    buffer_load_dwordx4 v12, s[32:35], s59 offen lds
    s_add_u32 m0, s42, 25600
    s_add_u32 s59, s61, 1081344
    buffer_load_dwordx4 v12, s[32:35], s59 offen lds
    s_add_u32 m0, s42, 26624
    s_add_u32 s59, s61, 1114112
    buffer_load_dwordx4 v12, s[32:35], s59 offen lds
    s_add_u32 m0, s42, 27648
    s_add_u32 s59, s61, 1146880
    buffer_load_dwordx4 v12, s[32:35], s59 offen lds
    s_add_u32 m0, s42, 28672
    s_add_u32 s59, s61, 1179648
    buffer_load_dwordx4 v12, s[32:35], s59 offen lds
    s_add_u32 m0, s42, 29696
    s_add_u32 s59, s61, 1212416
    buffer_load_dwordx4 v12, s[32:35], s59 offen lds
    s_add_u32 m0, s42, 30720
    s_add_u32 s59, s61, 1245184
    buffer_load_dwordx4 v12, s[32:35], s59 offen lds
    s_add_u32 m0, s42, 31744
    s_add_u32 s59, s61, 1277952
    buffer_load_dwordx4 v12, s[32:35], s59 offen lds
    s_add_u32 m0, s42, 32768
    s_add_u32 s59, s57, 256
    buffer_load_dwordx4 v28, s[8:11], s59 offen lds
    s_add_u32 m0, s42, 33792
    s_add_u32 s59, s57, 16640
    buffer_load_dwordx4 v29, s[8:11], s59 offen lds
    s_add_u32 m0, s42, 34816
    s_add_u32 s59, s57, 33024
    buffer_load_dwordx4 v28, s[8:11], s59 offen lds
    s_add_u32 m0, s42, 35840
    s_add_u32 s59, s57, 49408
    buffer_load_dwordx4 v29, s[8:11], s59 offen lds
    s_add_u32 m0, s42, 36864
    s_add_u32 s59, s57, 65792
    buffer_load_dwordx4 v28, s[8:11], s59 offen lds
    s_add_u32 m0, s42, 37888
    s_add_u32 s59, s57, 82176
    buffer_load_dwordx4 v29, s[8:11], s59 offen lds
    s_add_u32 m0, s42, 38912
    s_add_u32 s59, s57, 98560
    buffer_load_dwordx4 v28, s[8:11], s59 offen lds
    s_add_u32 m0, s42, 39936
    s_add_u32 s59, s57, 114944
    buffer_load_dwordx4 v29, s[8:11], s59 offen lds
    s_waitcnt vmcnt(32)
    ds_read_b128 v[32:35], v24 offset:0
    ds_read_b128 v[36:39], v24 offset:4096
    ds_read_b128 v[40:43], v25 offset:0
    ds_read_b128 v[44:47], v25 offset:4096
    s_waitcnt lgkmcnt(2)
    v_mfma_f32_32x32x16_bf16 a[192:207], v[128:131], v[32:35], 0
    ds_read_b128 v[48:51], v26 offset:0
    v_mfma_f32_32x32x16_bf16 a[208:223], v[128:131], v[36:39], 0
    v_mfma_f32_32x32x16_bf16 a[224:239], v[132:135], v[32:35], 0
    ds_read_b128 v[52:55], v26 offset:4096
    v_mfma_f32_32x32x16_bf16 a[240:255], v[132:135], v[36:39], 0
    s_waitcnt lgkmcnt(2)
    s_mul_i32 s44, s3, 6
    s_cmp_eq_u32 s3, 3
    s_cselect_b32 s44, 17, s44
    s_mul_i32 s43, s53, 22
    s_add_u32 s43, s43, s44
    s_lshl_b32 s43, s43, 7
    s_add_u32 s43, s43, 8192
    v_lshl_add_u32 v14, v1, 5, s43
    s_cmp_ge_u32 s3, 2
    s_cselect_b32 s44, 20, 24
    s_bfm_b32 exec_lo, s44, 0
    s_mov_b32 exec_hi, 0
    buffer_load_dwordx2 v[18:19], v14, s[4:7], 0 offen sc1
    s_mov_b64 exec, -1
    v_mfma_f32_32x32x16_bf16 a[192:207], v[136:139], v[40:43], a[192:207]
    ds_read_b128 v[56:59], v27 offset:0
    v_mfma_f32_32x32x16_bf16 a[208:223], v[136:139], v[44:47], a[208:223]
    v_mfma_f32_32x32x16_bf16 a[224:239], v[140:143], v[40:43], a[224:239]
    ds_read_b128 v[60:63], v27 offset:4096
    v_mfma_f32_32x32x16_bf16 a[240:255], v[140:143], v[44:47], a[240:255]
    s_waitcnt vmcnt(17)
    s_waitcnt lgkmcnt(2)
    v_mfma_f32_32x32x16_bf16 a[192:207], v[144:147], v[48:51], a[192:207]
    ds_read_b128 v[32:35], v24 offset:16384
    v_mfma_f32_32x32x16_bf16 a[208:223], v[144:147], v[52:55], a[208:223]
    v_mfma_f32_32x32x16_bf16 a[224:239], v[148:151], v[48:51], a[224:239]
    ds_read_b128 v[36:39], v24 offset:20480
    v_mfma_f32_32x32x16_bf16 a[240:255], v[148:151], v[52:55], a[240:255]
    s_waitcnt lgkmcnt(2)
    v_mfma_f32_32x32x16_bf16 a[192:207], v[152:155], v[56:59], a[192:207]
    ds_read_b128 v[40:43], v25 offset:16384
    v_mfma_f32_32x32x16_bf16 a[208:223], v[152:155], v[60:63], a[208:223]
    v_mfma_f32_32x32x16_bf16 a[224:239], v[156:159], v[56:59], a[224:239]
    ds_read_b128 v[44:47], v25 offset:20480
    v_mfma_f32_32x32x16_bf16 a[240:255], v[156:159], v[60:63], a[240:255]
    s_waitcnt lgkmcnt(2)
    v_mfma_f32_32x32x16_bf16 a[192:207], v[160:163], v[32:35], a[192:207]
    ds_read_b128 v[48:51], v26 offset:16384
    v_mfma_f32_32x32x16_bf16 a[208:223], v[160:163], v[36:39], a[208:223]
    s_add_u32 m0, s42, 0
    s_add_u32 s59, s63, 1310720
    buffer_load_dwordx4 v12, s[32:35], s59 offen lds
    v_mfma_f32_32x32x16_bf16 a[224:239], v[164:167], v[32:35], a[224:239]
    ds_read_b128 v[52:55], v26 offset:20480
    v_mfma_f32_32x32x16_bf16 a[240:255], v[164:167], v[36:39], a[240:255]
    s_add_u32 m0, s42, 1024
    s_add_u32 s59, s63, 1343488
    buffer_load_dwordx4 v12, s[32:35], s59 offen lds
    s_waitcnt lgkmcnt(2)
    ds_read_b64_tr_b16 a[96:97], v10 offset:8192
    ds_read_b64_tr_b16 a[98:99], v10 offset:8704
    ds_read_b64_tr_b16 a[100:101], v11 offset:8192
    ds_read_b64_tr_b16 a[102:103], v11 offset:8704
    ds_read_b64_tr_b16 a[104:105], v10 offset:10240
    ds_read_b64_tr_b16 a[106:107], v10 offset:10752
    ds_read_b64_tr_b16 a[108:109], v11 offset:10240
    ds_read_b64_tr_b16 a[110:111], v11 offset:10752
    ds_read_b64_tr_b16 a[112:113], v10 offset:12288
    ds_read_b64_tr_b16 a[114:115], v10 offset:12800
    ds_read_b64_tr_b16 a[116:117], v11 offset:12288
    ds_read_b64_tr_b16 a[118:119], v11 offset:12800
    ds_read_b64_tr_b16 a[120:121], v10 offset:14336
    ds_read_b64_tr_b16 a[122:123], v10 offset:14848
    ds_read_b64_tr_b16 a[124:125], v11 offset:14336
    ds_read_b64_tr_b16 a[126:127], v11 offset:14848
    v_mfma_f32_32x32x16_bf16 a[192:207], v[168:171], v[40:43], a[192:207]
    ds_read_b128 v[56:59], v27 offset:16384
    v_mfma_f32_32x32x16_bf16 a[208:223], v[168:171], v[44:47], a[208:223]
    s_add_u32 m0, s42, 2048
    s_add_u32 s59, s63, 1376256
    buffer_load_dwordx4 v12, s[32:35], s59 offen lds
    v_mfma_f32_32x32x16_bf16 a[224:239], v[172:175], v[40:43], a[224:239]
    ds_read_b128 v[60:63], v27 offset:20480
    v_mfma_f32_32x32x16_bf16 a[240:255], v[172:175], v[44:47], a[240:255]
    s_add_u32 m0, s42, 3072
    s_add_u32 s59, s63, 1409024
    buffer_load_dwordx4 v12, s[32:35], s59 offen lds
    s_waitcnt vmcnt(5)
    s_waitcnt lgkmcnt(2)
    v_mfma_f32_32x32x16_bf16 a[192:207], v[176:179], v[48:51], a[192:207]
    ds_read_b128 v[32:35], v24 offset:32768
    v_mfma_f32_32x32x16_bf16 a[208:223], v[176:179], v[52:55], a[208:223]
    s_add_u32 m0, s42, 4096
    s_add_u32 s59, s63, 1441792
    buffer_load_dwordx4 v12, s[32:35], s59 offen lds
    v_mfma_f32_32x32x16_bf16 a[224:239], v[180:183], v[48:51], a[224:239]
    ds_read_b128 v[36:39], v24 offset:36864
    v_mfma_f32_32x32x16_bf16 a[240:255], v[180:183], v[52:55], a[240:255]
    s_add_u32 m0, s42, 5120
    s_add_u32 s59, s63, 1474560
    buffer_load_dwordx4 v12, s[32:35], s59 offen lds
    s_waitcnt lgkmcnt(2)
    v_mfma_f32_32x32x16_bf16 a[192:207], v[184:187], v[56:59], a[192:207]
    ds_read_b128 v[40:43], v25 offset:32768
    v_mfma_f32_32x32x16_bf16 a[208:223], v[184:187], v[60:63], a[208:223]
    s_add_u32 m0, s42, 6144
    s_add_u32 s59, s63, 1507328
    buffer_load_dwordx4 v12, s[32:35], s59 offen lds
    v_mfma_f32_32x32x16_bf16 a[224:239], v[188:191], v[56:59], a[224:239]
    ds_read_b128 v[44:47], v25 offset:36864
    v_mfma_f32_32x32x16_bf16 a[240:255], v[188:191], v[60:63], a[240:255]
    s_add_u32 m0, s42, 7168
    s_add_u32 s59, s63, 1540096
    buffer_load_dwordx4 v12, s[32:35], s59 offen lds
    s_waitcnt lgkmcnt(2)
    s_add_u32 m0, s42, 16384
    s_add_u32 s59, s57, 384
    buffer_load_dwordx4 v28, s[8:11], s59 offen lds
    s_add_u32 m0, s42, 17408
    s_add_u32 s59, s57, 16768
    buffer_load_dwordx4 v29, s[8:11], s59 offen lds
    s_add_u32 m0, s42, 18432
    s_add_u32 s59, s57, 33152
    buffer_load_dwordx4 v28, s[8:11], s59 offen lds
    s_add_u32 m0, s42, 19456
    s_add_u32 s59, s57, 49536
    buffer_load_dwordx4 v29, s[8:11], s59 offen lds
    s_add_u32 m0, s42, 20480
    s_add_u32 s59, s57, 65920
    buffer_load_dwordx4 v28, s[8:11], s59 offen lds
    s_add_u32 m0, s42, 21504
    s_add_u32 s59, s57, 82304
    buffer_load_dwordx4 v29, s[8:11], s59 offen lds
    s_add_u32 m0, s42, 22528
    s_add_u32 s59, s57, 98688
    buffer_load_dwordx4 v28, s[8:11], s59 offen lds
    s_add_u32 m0, s42, 23552
    s_add_u32 s59, s57, 115072
    buffer_load_dwordx4 v29, s[8:11], s59 offen lds
    s_waitcnt vmcnt(16)
    s_mul_i32 s44, s3, 6
    s_cmp_eq_u32 s3, 3
    s_cselect_b32 s44, 17, s44
    s_mul_i32 s43, s53, 22
    s_add_u32 s43, s43, s44
    s_lshl_b32 s43, s43, 7
    s_add_u32 s43, s43, 8192
    v_lshl_add_u32 v14, v1, 5, s43
    s_cmp_ge_u32 s3, 2
    s_cselect_b32 s44, 20, 24
    s_bfm_b32 exec_lo, s44, 0
    s_mov_b32 exec_hi, 0
    s_mov_b32 s60, 20000
    s_branch L_pollc_23
L_poll_22:
    buffer_load_dwordx2 v[18:19], v14, s[4:7], 0 offen sc1
    s_waitcnt vmcnt(0)
L_pollc_23:
    v_cmp_ne_u64 vcc, s[100:101], v[18:19]
    s_cbranch_vccz L_polld_24
    s_sleep 4
    s_sub_u32 s60, s60, 1
    s_cmp_lg_u32 s60, 0
    s_cbranch_scc1 L_poll_22
L_polld_24:
    s_mov_b64 exec, -1
    v_lshrrev_b32 v14, 3, v1
    v_mul_u32_u24 v14, 64, v14
    v_and_b32 v15, 7, v1
    v_lshrrev_b32 v16, 4, v1
    v_xor_b32 v15, v15, v16
    v_and_b32 v16, 3, v15
    v_lshrrev_b32 v15, 2, v15
    v_lshlrev_b32 v15, 12, v15
    v_lshl_add_u32 v15, v16, 4, v15
    v_add_u32 v2, v14, v15
    v_xor_b32 v15, 4096, v15
    v_add_u32 v3, v14, v15
    v_mfma_f32_32x32x16_bf16 a[192:207], v[192:195], v[32:35], a[192:207]
    ds_read_b128 v[48:51], v26 offset:32768
    v_mfma_f32_32x32x16_bf16 a[208:223], v[192:195], v[36:39], a[208:223]
    s_add_u32 m0, s42, 8192
    s_add_u32 s59, s83, 0
    buffer_load_dwordx4 v2, s[12:15], s59 offen lds
    v_mfma_f32_32x32x16_bf16 a[224:239], v[196:199], v[32:35], a[224:239]
    ds_read_b128 v[52:55], v26 offset:36864
    v_mfma_f32_32x32x16_bf16 a[240:255], v[196:199], v[36:39], a[240:255]
    s_add_u32 m0, s42, 9216
    s_add_u32 s59, s83, 512
    buffer_load_dwordx4 v3, s[12:15], s59 offen lds
    s_waitcnt lgkmcnt(2)
    ds_read_b64_tr_b16 a[128:129], v10 offset:24576
    ds_read_b64_tr_b16 a[130:131], v10 offset:25088
    ds_read_b64_tr_b16 a[132:133], v11 offset:24576
    ds_read_b64_tr_b16 a[134:135], v11 offset:25088
    ds_read_b64_tr_b16 a[136:137], v10 offset:26624
    ds_read_b64_tr_b16 a[138:139], v10 offset:27136
    ds_read_b64_tr_b16 a[140:141], v11 offset:26624
    ds_read_b64_tr_b16 a[142:143], v11 offset:27136
    ds_read_b64_tr_b16 a[144:145], v10 offset:28672
    ds_read_b64_tr_b16 a[146:147], v10 offset:29184
    ds_read_b64_tr_b16 a[148:149], v11 offset:28672
    ds_read_b64_tr_b16 a[150:151], v11 offset:29184
    ds_read_b64_tr_b16 a[152:153], v10 offset:30720
    ds_read_b64_tr_b16 a[154:155], v10 offset:31232
    ds_read_b64_tr_b16 a[156:157], v11 offset:30720
    ds_read_b64_tr_b16 a[158:159], v11 offset:31232
    v_mfma_f32_32x32x16_bf16 a[192:207], v[200:203], v[40:43], a[192:207]
    ds_read_b128 v[56:59], v27 offset:32768
    v_mfma_f32_32x32x16_bf16 a[208:223], v[200:203], v[44:47], a[208:223]
    s_add_u32 m0, s42, 10240
    s_add_u32 s59, s83, 1024
    buffer_load_dwordx4 v2, s[12:15], s59 offen lds
    v_mfma_f32_32x32x16_bf16 a[224:239], v[204:207], v[40:43], a[224:239]
    ds_read_b128 v[60:63], v27 offset:36864
    v_mfma_f32_32x32x16_bf16 a[240:255], v[204:207], v[44:47], a[240:255]
    s_add_u32 m0, s42, 11264
    s_add_u32 s59, s83, 1536
    buffer_load_dwordx4 v3, s[12:15], s59 offen lds
    s_waitcnt vmcnt(4)
    s_waitcnt lgkmcnt(2)
    v_mfma_f32_32x32x16_bf16 a[192:207], v[208:211], v[48:51], a[192:207]
    ds_read_b128 v[32:35], v24 offset:16384
    v_mfma_f32_32x32x16_bf16 a[208:223], v[208:211], v[52:55], a[208:223]
    s_add_u32 m0, s42, 12288
    s_add_u32 s59, s83, 2048
    buffer_load_dwordx4 v2, s[12:15], s59 offen lds
    v_mfma_f32_32x32x16_bf16 a[224:239], v[212:215], v[48:51], a[224:239]
    ds_read_b128 v[36:39], v24 offset:20480
    v_mfma_f32_32x32x16_bf16 a[240:255], v[212:215], v[52:55], a[240:255]
    s_add_u32 m0, s42, 13312
    s_add_u32 s59, s83, 2560
    buffer_load_dwordx4 v3, s[12:15], s59 offen lds
    s_waitcnt lgkmcnt(2)
    v_mfma_f32_32x32x16_bf16 a[192:207], v[216:219], v[56:59], a[192:207]
    ds_read_b128 v[40:43], v25 offset:16384
    v_mfma_f32_32x32x16_bf16 a[208:223], v[216:219], v[60:63], a[208:223]
    s_add_u32 m0, s42, 14336
    s_add_u32 s59, s83, 3072
    buffer_load_dwordx4 v2, s[12:15], s59 offen lds
    v_mfma_f32_32x32x16_bf16 a[224:239], v[220:223], v[56:59], a[224:239]
    ds_read_b128 v[44:47], v25 offset:20480
    v_mfma_f32_32x32x16_bf16 a[240:255], v[220:223], v[60:63], a[240:255]
    s_add_u32 m0, s42, 15360
    s_add_u32 s59, s83, 3584
    buffer_load_dwordx4 v3, s[12:15], s59 offen lds
    s_waitcnt lgkmcnt(2)
    v_mfma_f32_32x32x16_bf16 a[192:207], v[224:227], v[32:35], a[192:207]
    ds_read_b128 v[48:51], v26 offset:16384
    s_add_u32 m0, s42, 32768
    s_add_u32 s59, s83, 8192
    buffer_load_dwordx4 v2, s[12:15], s59 offen lds
    v_mfma_f32_32x32x16_bf16 a[208:223], v[224:227], v[36:39], a[208:223]
    s_add_u32 m0, s42, 33792
    s_add_u32 s59, s83, 8704
    buffer_load_dwordx4 v3, s[12:15], s59 offen lds
    v_mfma_f32_32x32x16_bf16 a[224:239], v[228:231], v[32:35], a[224:239]
    ds_read_b128 v[52:55], v26 offset:20480
    s_add_u32 m0, s42, 34816
    s_add_u32 s59, s83, 9216
    buffer_load_dwordx4 v2, s[12:15], s59 offen lds
    v_mfma_f32_32x32x16_bf16 a[240:255], v[228:231], v[36:39], a[240:255]
    s_add_u32 m0, s42, 35840
    s_add_u32 s59, s83, 9728
    buffer_load_dwordx4 v3, s[12:15], s59 offen lds
    s_waitcnt lgkmcnt(2)
    s_cmp_ge_u32 s3, 2
    s_cbranch_scc1 L_xo_25
    ds_read_b64_tr_b16 a[160:161], v10 offset:0
    ds_read_b64_tr_b16 a[162:163], v10 offset:512
    ds_read_b64_tr_b16 a[164:165], v11 offset:0
    ds_read_b64_tr_b16 a[166:167], v11 offset:512
    ds_read_b64_tr_b16 a[168:169], v10 offset:2048
    ds_read_b64_tr_b16 a[170:171], v10 offset:2560
    ds_read_b64_tr_b16 a[172:173], v11 offset:2048
    ds_read_b64_tr_b16 a[174:175], v11 offset:2560
    ds_read_b64_tr_b16 a[176:177], v10 offset:4096
    ds_read_b64_tr_b16 a[178:179], v10 offset:4608
    ds_read_b64_tr_b16 a[180:181], v11 offset:4096
    ds_read_b64_tr_b16 a[182:183], v11 offset:4608
    ds_read_b64_tr_b16 a[184:185], v10 offset:6144
    ds_read_b64_tr_b16 a[186:187], v10 offset:6656
    ds_read_b64_tr_b16 a[188:189], v11 offset:6144
    ds_read_b64_tr_b16 a[190:191], v11 offset:6656
L_xo_25:
    v_mfma_f32_32x32x16_bf16 a[192:207], v[232:235], v[40:43], a[192:207]
    ds_read_b128 v[56:59], v27 offset:16384
    s_add_u32 m0, s42, 36864
    s_add_u32 s59, s83, 10240
    buffer_load_dwordx4 v2, s[12:15], s59 offen lds
    v_mfma_f32_32x32x16_bf16 a[208:223], v[232:235], v[44:47], a[208:223]
    s_add_u32 m0, s42, 37888
    s_add_u32 s59, s83, 10752
    buffer_load_dwordx4 v3, s[12:15], s59 offen lds
    v_mfma_f32_32x32x16_bf16 a[224:239], v[236:239], v[40:43], a[224:239]
    ds_read_b128 v[60:63], v27 offset:20480
    s_add_u32 m0, s42, 38912
    s_add_u32 s59, s83, 11264
    buffer_load_dwordx4 v2, s[12:15], s59 offen lds
    v_mfma_f32_32x32x16_bf16 a[240:255], v[236:239], v[44:47], a[240:255]
    s_add_u32 m0, s42, 39936
    s_add_u32 s59, s83, 11776
    buffer_load_dwordx4 v3, s[12:15], s59 offen lds
    s_waitcnt vmcnt(8)
    s_waitcnt lgkmcnt(2)
    v_mfma_f32_32x32x16_bf16 a[192:207], v[240:243], v[48:51], a[192:207]
    ds_read_b128 v[32:35], v6 offset:8192
    s_add_u32 m0, s42, 24576
    s_add_u32 s59, s83, 16384
    buffer_load_dwordx4 v2, s[12:15], s59 offen lds
    v_mfma_f32_32x32x16_bf16 a[208:223], v[240:243], v[52:55], a[208:223]
    s_add_u32 m0, s42, 25600
    s_add_u32 s59, s83, 16896
    buffer_load_dwordx4 v3, s[12:15], s59 offen lds
    v_mfma_f32_32x32x16_bf16 a[224:239], v[244:247], v[48:51], a[224:239]
    ds_read_b128 v[36:39], v6 offset:12288
    s_add_u32 m0, s42, 26624
    s_add_u32 s59, s83, 17408
    buffer_load_dwordx4 v2, s[12:15], s59 offen lds
    v_mfma_f32_32x32x16_bf16 a[240:255], v[244:247], v[52:55], a[240:255]
    s_add_u32 m0, s42, 27648
    s_add_u32 s59, s83, 17920
    buffer_load_dwordx4 v3, s[12:15], s59 offen lds
    s_waitcnt lgkmcnt(2)
    v_mfma_f32_32x32x16_bf16 a[192:207], v[248:251], v[56:59], a[192:207]
    ds_read_b128 v[40:43], v7 offset:8192
    s_add_u32 m0, s42, 28672
    s_add_u32 s59, s83, 18432
    buffer_load_dwordx4 v2, s[12:15], s59 offen lds
    v_mfma_f32_32x32x16_bf16 a[208:223], v[248:251], v[60:63], a[208:223]
    s_add_u32 m0, s42, 29696
    s_add_u32 s59, s83, 18944
    buffer_load_dwordx4 v3, s[12:15], s59 offen lds
    v_mfma_f32_32x32x16_bf16 a[224:239], v[252:255], v[56:59], a[224:239]
    ds_read_b128 v[44:47], v7 offset:12288
    s_add_u32 m0, s42, 30720
    s_add_u32 s59, s83, 19456
    buffer_load_dwordx4 v2, s[12:15], s59 offen lds
    v_mfma_f32_32x32x16_bf16 a[240:255], v[252:255], v[60:63], a[240:255]
    s_add_u32 m0, s42, 31744
    s_add_u32 s59, s83, 19968
    buffer_load_dwordx4 v3, s[12:15], s59 offen lds
    s_waitcnt lgkmcnt(2)
    v_mfma_f32_32x32x16_bf16 v[64:79], v[32:35], a[0:3], 0
    ds_read_b128 v[48:51], v8 offset:8192
    s_add_u32 m0, s42, 16384
    s_add_u32 s59, s83, 24576
    buffer_load_dwordx4 v2, s[12:15], s59 offen lds
    v_mfma_f32_32x32x16_bf16 v[80:95], v[32:35], a[4:7], 0
    s_add_u32 m0, s42, 17408
    s_add_u32 s59, s83, 25088
    buffer_load_dwordx4 v3, s[12:15], s59 offen lds
    v_mfma_f32_32x32x16_bf16 v[96:111], v[36:39], a[0:3], 0
    ds_read_b128 v[52:55], v8 offset:12288
    s_add_u32 m0, s42, 18432
    s_add_u32 s59, s83, 25600
    buffer_load_dwordx4 v2, s[12:15], s59 offen lds
    v_mfma_f32_32x32x16_bf16 v[112:127], v[36:39], a[4:7], 0
    s_add_u32 m0, s42, 19456
    s_add_u32 s59, s83, 26112
    buffer_load_dwordx4 v3, s[12:15], s59 offen lds
    s_waitcnt lgkmcnt(2)
    v_mfma_f32_32x32x16_bf16 v[64:79], v[40:43], a[8:11], v[64:79]
    ds_read_b128 v[56:59], v9 offset:8192
    s_add_u32 m0, s42, 20480
    s_add_u32 s59, s83, 26624
    buffer_load_dwordx4 v2, s[12:15], s59 offen lds
    v_mfma_f32_32x32x16_bf16 v[80:95], v[40:43], a[12:15], v[80:95]
    s_add_u32 m0, s42, 21504
    s_add_u32 s59, s83, 27136
    buffer_load_dwordx4 v3, s[12:15], s59 offen lds
    v_mfma_f32_32x32x16_bf16 v[96:111], v[44:47], a[8:11], v[96:111]
    ds_read_b128 v[60:63], v9 offset:12288
    s_add_u32 m0, s42, 22528
    s_add_u32 s59, s83, 27648
    buffer_load_dwordx4 v2, s[12:15], s59 offen lds
    v_mfma_f32_32x32x16_bf16 v[112:127], v[44:47], a[12:15], v[112:127]
    s_add_u32 m0, s42, 23552
    s_add_u32 s59, s83, 28160
    buffer_load_dwordx4 v3, s[12:15], s59 offen lds
    s_waitcnt vmcnt(16)
    s_waitcnt lgkmcnt(2)
    v_mfma_f32_32x32x16_bf16 v[64:79], v[48:51], a[16:19], v[64:79]
    ds_read_b128 v[32:35], v6 offset:32768
    s_add_u32 m0, s42, 0
    s_add_u32 s59, s83, 32768
    buffer_load_dwordx4 v2, s[12:15], s59 offen lds
    v_mfma_f32_32x32x16_bf16 v[80:95], v[48:51], a[20:23], v[80:95]
    s_add_u32 m0, s42, 1024
    s_add_u32 s59, s83, 33280
    buffer_load_dwordx4 v3, s[12:15], s59 offen lds
    v_mfma_f32_32x32x16_bf16 v[96:111], v[52:55], a[16:19], v[96:111]
    ds_read_b128 v[36:39], v6 offset:36864
    s_add_u32 m0, s42, 2048
    s_add_u32 s59, s83, 33792
    buffer_load_dwordx4 v2, s[12:15], s59 offen lds
    v_mfma_f32_32x32x16_bf16 v[112:127], v[52:55], a[20:23], v[112:127]
    s_add_u32 m0, s42, 3072
    s_add_u32 s59, s83, 34304
    buffer_load_dwordx4 v3, s[12:15], s59 offen lds
    s_waitcnt lgkmcnt(2)
    v_mfma_f32_32x32x16_bf16 v[64:79], v[56:59], a[24:27], v[64:79]
    ds_read_b128 v[40:43], v7 offset:32768
    s_add_u32 m0, s42, 4096
    s_add_u32 s59, s83, 34816
    buffer_load_dwordx4 v2, s[12:15], s59 offen lds
    v_mfma_f32_32x32x16_bf16 v[80:95], v[56:59], a[28:31], v[80:95]
    s_add_u32 m0, s42, 5120
    s_add_u32 s59, s83, 35328
    buffer_load_dwordx4 v3, s[12:15], s59 offen lds
    v_mfma_f32_32x32x16_bf16 v[96:111], v[60:63], a[24:27], v[96:111]
    ds_read_b128 v[44:47], v7 offset:36864
    s_add_u32 m0, s42, 6144
    s_add_u32 s59, s83, 35840
    buffer_load_dwordx4 v2, s[12:15], s59 offen lds
    v_mfma_f32_32x32x16_bf16 v[112:127], v[60:63], a[28:31], v[112:127]
    s_add_u32 m0, s42, 7168
    s_add_u32 s59, s83, 36352
    buffer_load_dwordx4 v3, s[12:15], s59 offen lds
    s_waitcnt lgkmcnt(2)
    v_mfma_f32_32x32x16_bf16 v[64:79], v[32:35], a[32:35], v[64:79]
    ds_read_b128 v[48:51], v8 offset:32768
    v_mfma_f32_32x32x16_bf16 v[80:95], v[32:35], a[36:39], v[80:95]
    s_add_u32 m0, s42, 8192
    s_add_u32 s59, s82, 40960
    buffer_load_dwordx4 v2, s[12:15], s59 offen lds
    v_mfma_f32_32x32x16_bf16 v[96:111], v[36:39], a[32:35], v[96:111]
    ds_read_b128 v[52:55], v8 offset:36864
    v_mfma_f32_32x32x16_bf16 v[112:127], v[36:39], a[36:39], v[112:127]
    s_add_u32 m0, s42, 9216
    s_add_u32 s59, s82, 41472
    buffer_load_dwordx4 v3, s[12:15], s59 offen lds
    s_waitcnt lgkmcnt(2)
    v_mfma_f32_32x32x16_bf16 v[64:79], v[40:43], a[40:43], v[64:79]
    ds_read_b128 v[56:59], v9 offset:32768
    v_mfma_f32_32x32x16_bf16 v[80:95], v[40:43], a[44:47], v[80:95]
    s_add_u32 m0, s42, 10240
    s_add_u32 s59, s82, 41984
    buffer_load_dwordx4 v2, s[12:15], s59 offen lds
    v_mfma_f32_32x32x16_bf16 v[96:111], v[44:47], a[40:43], v[96:111]
    ds_read_b128 v[60:63], v9 offset:36864
    v_mfma_f32_32x32x16_bf16 v[112:127], v[44:47], a[44:47], v[112:127]
    s_add_u32 m0, s42, 11264
    s_add_u32 s59, s82, 42496
    buffer_load_dwordx4 v3, s[12:15], s59 offen lds
    s_waitcnt vmcnt(20)
    s_waitcnt lgkmcnt(2)
    v_mfma_f32_32x32x16_bf16 v[64:79], v[48:51], a[48:51], v[64:79]
    ds_read_b128 v[32:35], v6 offset:24576
    v_mfma_f32_32x32x16_bf16 v[80:95], v[48:51], a[52:55], v[80:95]
    s_add_u32 m0, s42, 12288
    s_add_u32 s59, s82, 43008
    buffer_load_dwordx4 v2, s[12:15], s59 offen lds
    v_mfma_f32_32x32x16_bf16 v[96:111], v[52:55], a[48:51], v[96:111]
    ds_read_b128 v[36:39], v6 offset:28672
    v_mfma_f32_32x32x16_bf16 v[112:127], v[52:55], a[52:55], v[112:127]
    s_add_u32 m0, s42, 13312
    s_add_u32 s59, s82, 43520
    buffer_load_dwordx4 v3, s[12:15], s59 offen lds
    s_waitcnt lgkmcnt(2)
    v_mfma_f32_32x32x16_bf16 v[64:79], v[56:59], a[56:59], v[64:79]
    ds_read_b128 v[40:43], v7 offset:24576
    v_mfma_f32_32x32x16_bf16 v[80:95], v[56:59], a[60:63], v[80:95]
    s_add_u32 m0, s42, 14336
    s_add_u32 s59, s82, 44032
    buffer_load_dwordx4 v2, s[12:15], s59 offen lds
    v_mfma_f32_32x32x16_bf16 v[96:111], v[60:63], a[56:59], v[96:111]
    ds_read_b128 v[44:47], v7 offset:28672
    v_mfma_f32_32x32x16_bf16 v[112:127], v[60:63], a[60:63], v[112:127]
    s_add_u32 m0, s42, 15360
    s_add_u32 s59, s82, 44544
    buffer_load_dwordx4 v3, s[12:15], s59 offen lds
    s_waitcnt lgkmcnt(2)
    v_mfma_f32_32x32x16_bf16 v[64:79], v[32:35], a[64:67], v[64:79]
    ds_read_b128 v[48:51], v8 offset:24576
    v_mfma_f32_32x32x16_bf16 v[80:95], v[32:35], a[68:71], v[80:95]
    v_mfma_f32_32x32x16_bf16 v[96:111], v[36:39], a[64:67], v[96:111]
    ds_read_b128 v[52:55], v8 offset:28672
    v_mfma_f32_32x32x16_bf16 v[112:127], v[36:39], a[68:71], v[112:127]
    s_waitcnt lgkmcnt(2)
    s_mov_b32 s16, s64
    s_and_b32 s17, s65, 0xffff
    s_mov_b32 s18, 2097152
    s_mov_b32 s19, 0x00020000
    s_mov_b32 s20, s80
    s_and_b32 s21, s81, 0xffff
    s_mov_b32 s22, 1024
    s_mov_b32 s23, 0x00020000
    s_mov_b32 s24, s90
    s_and_b32 s25, s91, 0xffff
    s_mov_b32 s26, 4096
    s_mov_b32 s27, 0x00020000
    s_add_u32 s28, s98, 2097152
    s_addc_u32 s29, s99, 0
    s_and_b32 s29, s29, 0xffff
    s_mov_b32 s30, 98304
    s_mov_b32 s31, 0x00020000
    s_mov_b32 s32, s94
    s_and_b32 s33, s95, 0xffff
    s_mov_b32 s34, 4194304
    s_mov_b32 s35, 0x00020000
    v_and_b32 v20, 31, v1
    s_lshl_b32 s43, s52, 1
    s_and_b32 s44, s3, 1
    s_add_u32 s43, s43, s44
    s_lshl_b32 s43, s43, 5
    v_add_u32 v20, s43, v20
    v_lshrrev_b32 v21, 5, v1
    s_lshl_b32 s43, s53, 1
    s_lshr_b32 s44, s3, 1
    s_add_u32 s43, s43, s44
    s_lshl_b32 s43, s43, 5
    v_lshl_add_u32 v21, v21, 2, s43
    v_lshl_add_u32 v22, v20, 9, v21
    v_lshlrev_b32 v23, 1, v22
    buffer_load_dwordx2 v[192:193], v23, s[16:19], 0 offen offset:0
    buffer_load_dwordx2 v[194:195], v23, s[16:19], 0 offen offset:16
    buffer_load_dwordx2 v[196:197], v23, s[16:19], 0 offen offset:32
    buffer_load_dwordx2 v[198:199], v23, s[16:19], 0 offen offset:48
    v_lshlrev_b32 v23, 1, v21
    buffer_load_dwordx2 v[200:201], v23, s[20:23], 0 offen offset:0
    buffer_load_dwordx2 v[202:203], v23, s[20:23], 0 offen offset:16
    buffer_load_dwordx2 v[204:205], v23, s[20:23], 0 offen offset:32
    buffer_load_dwordx2 v[206:207], v23, s[20:23], 0 offen offset:48
    v_lshlrev_b32 v23, 1, v20
    buffer_load_ushort v208, v23, s[24:27], 0 offen
    v_lshrrev_b32 v23, 2, v20
    v_and_b32 v19, 3, v20
    v_lshlrev_b32 v19, 2, v19
    v_lshl_add_u32 v23, v23, 7, v19
    buffer_load_dword v209, v23, s[28:31], 0 offen sc1
    v_lshl_add_u32 v212, v1, 4, s42
    v_mfma_f32_32x32x16_bf16 v[64:79], v[40:43], a[72:75], v[64:79]
    ds_read_b128 v[56:59], v9 offset:24576
    v_mfma_f32_32x32x16_bf16 v[80:95], v[40:43], a[76:79], v[80:95]
    v_mfma_f32_32x32x16_bf16 v[96:111], v[44:47], a[72:75], v[96:111]
    ds_read_b128 v[60:63], v9 offset:28672
    v_mfma_f32_32x32x16_bf16 v[112:127], v[44:47], a[76:79], v[112:127]
    s_waitcnt vmcnt(26)
    s_waitcnt lgkmcnt(2)
    v_mfma_f32_32x32x16_bf16 v[64:79], v[48:51], a[80:83], v[64:79]
    ds_read_b128 v[32:35], v6 offset:16384
    v_mfma_f32_32x32x16_bf16 v[80:95], v[48:51], a[84:87], v[80:95]
    v_mfma_f32_32x32x16_bf16 v[96:111], v[52:55], a[80:83], v[96:111]
    ds_read_b128 v[36:39], v6 offset:20480
    v_mfma_f32_32x32x16_bf16 v[112:127], v[52:55], a[84:87], v[112:127]
    s_waitcnt lgkmcnt(2)
    v_mfma_f32_32x32x16_bf16 v[64:79], v[56:59], a[88:91], v[64:79]
    ds_read_b128 v[40:43], v7 offset:16384
    v_mfma_f32_32x32x16_bf16 v[80:95], v[56:59], a[92:95], v[80:95]
    v_mfma_f32_32x32x16_bf16 v[96:111], v[60:63], a[88:91], v[96:111]
    ds_read_b128 v[44:47], v7 offset:20480
    v_mfma_f32_32x32x16_bf16 v[112:127], v[60:63], a[92:95], v[112:127]
    s_waitcnt lgkmcnt(2)
    s_cmp_eq_u32 s3, 0
    s_cbranch_scc1 L_xw_26
    ds_write_b128 v212, a[192:195] offset:32768
    ds_write_b128 v212, a[196:199] offset:33792
    ds_write_b128 v212, a[200:203] offset:34816
    ds_write_b128 v212, a[204:207] offset:35840
L_xw_26:
    v_mfma_f32_32x32x16_bf16 v[64:79], v[32:35], a[96:99], v[64:79]
    ds_read_b128 v[48:51], v8 offset:16384
    v_mfma_f32_32x32x16_bf16 v[80:95], v[32:35], a[100:103], v[80:95]
    v_mfma_f32_32x32x16_bf16 v[96:111], v[36:39], a[96:99], v[96:111]
    ds_read_b128 v[52:55], v8 offset:20480
    v_mfma_f32_32x32x16_bf16 v[112:127], v[36:39], a[100:103], v[112:127]
    s_waitcnt lgkmcnt(2)
    s_cmp_eq_u32 s3, 1
    s_cbranch_scc1 L_xw_27
    ds_write_b128 v212, a[208:211] offset:36864
    ds_write_b128 v212, a[212:215] offset:37888
    ds_write_b128 v212, a[216:219] offset:38912
    ds_write_b128 v212, a[220:223] offset:39936
L_xw_27:
    v_mfma_f32_32x32x16_bf16 v[64:79], v[40:43], a[104:107], v[64:79]
    ds_read_b128 v[56:59], v9 offset:16384
    v_mfma_f32_32x32x16_bf16 v[80:95], v[40:43], a[108:111], v[80:95]
    v_mfma_f32_32x32x16_bf16 v[96:111], v[44:47], a[104:107], v[96:111]
    ds_read_b128 v[60:63], v9 offset:20480
    v_mfma_f32_32x32x16_bf16 v[112:127], v[44:47], a[108:111], v[112:127]
    s_waitcnt vmcnt(18)
    s_waitcnt lgkmcnt(2)
    s_cmp_eq_u32 s3, 2
    s_cbranch_scc1 L_xw_28
    ds_write_b128 v212, a[224:227] offset:24576
    ds_write_b128 v212, a[228:231] offset:25600
    ds_write_b128 v212, a[232:235] offset:26624
    ds_write_b128 v212, a[236:239] offset:27648
L_xw_28:
    v_mfma_f32_32x32x16_bf16 v[64:79], v[48:51], a[112:115], v[64:79]
    ds_read_b128 v[32:35], v6 offset:0
    v_mfma_f32_32x32x16_bf16 v[80:95], v[48:51], a[116:119], v[80:95]
    v_mfma_f32_32x32x16_bf16 v[96:111], v[52:55], a[112:115], v[96:111]
    ds_read_b128 v[36:39], v6 offset:4096
    v_mfma_f32_32x32x16_bf16 v[112:127], v[52:55], a[116:119], v[112:127]
    s_waitcnt lgkmcnt(2)
    s_cmp_eq_u32 s3, 3
    s_cbranch_scc1 L_xw_29
    ds_write_b128 v212, a[240:243] offset:28672
    ds_write_b128 v212, a[244:247] offset:29696
    ds_write_b128 v212, a[248:251] offset:30720
    ds_write_b128 v212, a[252:255] offset:31744
L_xw_29:
    v_mfma_f32_32x32x16_bf16 v[64:79], v[56:59], a[120:123], v[64:79]
    ds_read_b128 v[40:43], v7 offset:0
    v_mfma_f32_32x32x16_bf16 v[80:95], v[56:59], a[124:127], v[80:95]
    v_mfma_f32_32x32x16_bf16 v[96:111], v[60:63], a[120:123], v[96:111]
    ds_read_b128 v[44:47], v7 offset:4096
    v_mfma_f32_32x32x16_bf16 v[112:127], v[60:63], a[124:127], v[112:127]
    s_waitcnt lgkmcnt(2)
    s_cmp_ge_u32 s3, 2
    s_cselect_b32 s43, 3, 4
    s_lshl_b32 s43, s43, 1
    s_and_b32 s44, s3, 1
    s_add_u32 s43, s43, s44
    s_lshl_b32 s43, s43, 12
    s_add_u32 s44, s3, 1
    s_and_b32 s44, s44, 3
    s_mul_i32 s44, s44, 40960
    s_add_u32 s44, s44, s43
    v_lshl_add_u32 v213, v1, 4, s44
    s_add_u32 s44, s3, 2
    s_and_b32 s44, s44, 3
    s_mul_i32 s44, s44, 40960
    s_add_u32 s44, s44, s43
    v_lshl_add_u32 v214, v1, 4, s44
    s_add_u32 s44, s3, 3
    s_and_b32 s44, s44, 3
    s_mul_i32 s44, s44, 40960
    s_add_u32 s44, s44, s43
    v_lshl_add_u32 v215, v1, 4, s44
    v_mfma_f32_32x32x16_bf16 v[64:79], v[32:35], a[128:131], v[64:79]
    ds_read_b128 v[48:51], v8 offset:0
    v_mfma_f32_32x32x16_bf16 v[80:95], v[32:35], a[132:135], v[80:95]
    v_mfma_f32_32x32x16_bf16 v[96:111], v[36:39], a[128:131], v[96:111]
    ds_read_b128 v[52:55], v8 offset:4096
    v_mfma_f32_32x32x16_bf16 v[112:127], v[36:39], a[132:135], v[112:127]
    s_waitcnt lgkmcnt(2)
    s_cmp_eq_u32 s3, 1
    s_cbranch_scc1 L_ow_32
    s_cmp_eq_u32 s3, 2
    s_cbranch_scc1 L_ow_33
    s_cmp_eq_u32 s3, 3
    s_cbranch_scc1 L_ow_34
L_ow_31:
    v_accvgpr_read_b32 v224, a192
    v_accvgpr_read_b32 v225, a193
    v_accvgpr_read_b32 v226, a194
    v_accvgpr_read_b32 v227, a195
    v_accvgpr_read_b32 v228, a196
    v_accvgpr_read_b32 v229, a197
    v_accvgpr_read_b32 v230, a198
    v_accvgpr_read_b32 v231, a199
    v_accvgpr_read_b32 v232, a200
    v_accvgpr_read_b32 v233, a201
    v_accvgpr_read_b32 v234, a202
    v_accvgpr_read_b32 v235, a203
    v_accvgpr_read_b32 v236, a204
    v_accvgpr_read_b32 v237, a205
    v_accvgpr_read_b32 v238, a206
    v_accvgpr_read_b32 v239, a207
    s_branch L_oe_30
L_ow_32:
    v_accvgpr_read_b32 v224, a208
    v_accvgpr_read_b32 v225, a209
    v_accvgpr_read_b32 v226, a210
    v_accvgpr_read_b32 v227, a211
    v_accvgpr_read_b32 v228, a212
    v_accvgpr_read_b32 v229, a213
    v_accvgpr_read_b32 v230, a214
    v_accvgpr_read_b32 v231, a215
    v_accvgpr_read_b32 v232, a216
    v_accvgpr_read_b32 v233, a217
    v_accvgpr_read_b32 v234, a218
    v_accvgpr_read_b32 v235, a219
    v_accvgpr_read_b32 v236, a220
    v_accvgpr_read_b32 v237, a221
    v_accvgpr_read_b32 v238, a222
    v_accvgpr_read_b32 v239, a223
    s_branch L_oe_30
L_ow_33:
    v_accvgpr_read_b32 v224, a224
    v_accvgpr_read_b32 v225, a225
    v_accvgpr_read_b32 v226, a226
    v_accvgpr_read_b32 v227, a227
    v_accvgpr_read_b32 v228, a228
    v_accvgpr_read_b32 v229, a229
    v_accvgpr_read_b32 v230, a230
    v_accvgpr_read_b32 v231, a231
    v_accvgpr_read_b32 v232, a232
    v_accvgpr_read_b32 v233, a233
    v_accvgpr_read_b32 v234, a234
    v_accvgpr_read_b32 v235, a235
    v_accvgpr_read_b32 v236, a236
    v_accvgpr_read_b32 v237, a237
    v_accvgpr_read_b32 v238, a238
    v_accvgpr_read_b32 v239, a239
    s_branch L_oe_30
L_ow_34:
    v_accvgpr_read_b32 v224, a240
    v_accvgpr_read_b32 v225, a241
    v_accvgpr_read_b32 v226, a242
    v_accvgpr_read_b32 v227, a243
    v_accvgpr_read_b32 v228, a244
    v_accvgpr_read_b32 v229, a245
    v_accvgpr_read_b32 v230, a246
    v_accvgpr_read_b32 v231, a247
    v_accvgpr_read_b32 v232, a248
    v_accvgpr_read_b32 v233, a249
    v_accvgpr_read_b32 v234, a250
    v_accvgpr_read_b32 v235, a251
    v_accvgpr_read_b32 v236, a252
    v_accvgpr_read_b32 v237, a253
    v_accvgpr_read_b32 v238, a254
    v_accvgpr_read_b32 v239, a255
L_oe_30:
    v_mfma_f32_32x32x16_bf16 v[64:79], v[40:43], a[136:139], v[64:79]
    ds_read_b128 v[56:59], v9 offset:0
    v_mfma_f32_32x32x16_bf16 v[80:95], v[40:43], a[140:143], v[80:95]
    v_mfma_f32_32x32x16_bf16 v[96:111], v[44:47], a[136:139], v[96:111]
    ds_read_b128 v[60:63], v9 offset:4096
    v_mfma_f32_32x32x16_bf16 v[112:127], v[44:47], a[140:143], v[112:127]
    s_waitcnt vmcnt(10)
    s_waitcnt lgkmcnt(2)
    v_mfma_f32_32x32x16_bf16 v[64:79], v[48:51], a[144:147], v[64:79]
    ds_read_b128 v[32:35], v6 offset:8192
    v_mfma_f32_32x32x16_bf16 v[80:95], v[48:51], a[148:151], v[80:95]
    v_mfma_f32_32x32x16_bf16 v[96:111], v[52:55], a[144:147], v[96:111]
    ds_read_b128 v[36:39], v6 offset:12288
    v_mfma_f32_32x32x16_bf16 v[112:127], v[52:55], a[148:151], v[112:127]
    s_waitcnt lgkmcnt(2)
    v_mfma_f32_32x32x16_bf16 v[64:79], v[56:59], a[152:155], v[64:79]
    ds_read_b128 v[40:43], v7 offset:8192
    v_mfma_f32_32x32x16_bf16 v[80:95], v[56:59], a[156:159], v[80:95]
    v_mfma_f32_32x32x16_bf16 v[96:111], v[60:63], a[152:155], v[96:111]
    ds_read_b128 v[44:47], v7 offset:12288
    v_mfma_f32_32x32x16_bf16 v[112:127], v[60:63], a[156:159], v[112:127]
    s_cmp_ge_u32 s3, 2
    s_cbranch_scc1 L_sk_35
    s_waitcnt lgkmcnt(2)
    v_mfma_f32_32x32x16_bf16 v[64:79], v[32:35], a[160:163], v[64:79]
    ds_read_b128 v[48:51], v8 offset:8192
    v_mfma_f32_32x32x16_bf16 v[80:95], v[32:35], a[164:167], v[80:95]
    v_mfma_f32_32x32x16_bf16 v[96:111], v[36:39], a[160:163], v[96:111]
    ds_read_b128 v[52:55], v8 offset:12288
    v_mfma_f32_32x32x16_bf16 v[112:127], v[36:39], a[164:167], v[112:127]
    s_waitcnt lgkmcnt(2)
    v_mfma_f32_32x32x16_bf16 v[64:79], v[40:43], a[168:171], v[64:79]
    ds_read_b128 v[56:59], v9 offset:8192
    v_mfma_f32_32x32x16_bf16 v[80:95], v[40:43], a[172:175], v[80:95]
    v_mfma_f32_32x32x16_bf16 v[96:111], v[44:47], a[168:171], v[96:111]
    ds_read_b128 v[60:63], v9 offset:12288
    v_mfma_f32_32x32x16_bf16 v[112:127], v[44:47], a[172:175], v[112:127]
    s_waitcnt lgkmcnt(2)
    v_mfma_f32_32x32x16_bf16 v[64:79], v[48:51], a[176:179], v[64:79]
    v_mfma_f32_32x32x16_bf16 v[80:95], v[48:51], a[180:183], v[80:95]
    v_mfma_f32_32x32x16_bf16 v[96:111], v[52:55], a[176:179], v[96:111]
    v_mfma_f32_32x32x16_bf16 v[112:127], v[52:55], a[180:183], v[112:127]
    s_waitcnt lgkmcnt(0)
    v_mfma_f32_32x32x16_bf16 v[64:79], v[56:59], a[184:187], v[64:79]
    v_mfma_f32_32x32x16_bf16 v[80:95], v[56:59], a[188:191], v[80:95]
    v_mfma_f32_32x32x16_bf16 v[96:111], v[60:63], a[184:187], v[96:111]
    v_mfma_f32_32x32x16_bf16 v[112:127], v[60:63], a[188:191], v[112:127]
L_sk_35:
    s_waitcnt lgkmcnt(0)
    s_nop 7
    s_nop 7
    s_cmp_eq_u32 s3, 0
    s_cbranch_scc1 L_xw_36
    ds_write_b128 v212, v[64:67] offset:16384
    ds_write_b128 v212, v[68:71] offset:17408
    ds_write_b128 v212, v[72:75] offset:18432
    ds_write_b128 v212, v[76:79] offset:19456
L_xw_36:
    s_cmp_eq_u32 s3, 1
    s_cbranch_scc1 L_xw_37
    ds_write_b128 v212, v[80:83] offset:20480
    ds_write_b128 v212, v[84:87] offset:21504
    ds_write_b128 v212, v[88:91] offset:22528
    ds_write_b128 v212, v[92:95] offset:23552
L_xw_37:
    s_cmp_eq_u32 s3, 2
    s_cbranch_scc1 L_xw_38
    ds_write_b128 v212, v[96:99] offset:0
    ds_write_b128 v212, v[100:103] offset:1024
    ds_write_b128 v212, v[104:107] offset:2048
    ds_write_b128 v212, v[108:111] offset:3072
L_xw_38:
    s_cmp_eq_u32 s3, 3
    s_cbranch_scc1 L_xw_39
    ds_write_b128 v212, v[112:115] offset:4096
    ds_write_b128 v212, v[116:119] offset:5120
    ds_write_b128 v212, v[120:123] offset:6144
    ds_write_b128 v212, v[124:127] offset:7168
L_xw_39:
    s_cmp_ge_u32 s3, 2
    s_cselect_b32 s43, 0, 2
    s_lshl_b32 s43, s43, 1
    s_and_b32 s44, s3, 1
    s_add_u32 s43, s43, s44
    s_lshl_b32 s43, s43, 12
    s_add_u32 s44, s3, 1
    s_and_b32 s44, s44, 3
    s_mul_i32 s44, s44, 40960
    s_add_u32 s44, s44, s43
    v_lshl_add_u32 v216, v1, 4, s44
    s_add_u32 s44, s3, 2
    s_and_b32 s44, s44, 3
    s_mul_i32 s44, s44, 40960
    s_add_u32 s44, s44, s43
    v_lshl_add_u32 v217, v1, 4, s44
    s_add_u32 s44, s3, 3
    s_and_b32 s44, s44, 3
    s_mul_i32 s44, s44, 40960
    s_add_u32 s44, s44, s43
    v_lshl_add_u32 v218, v1, 4, s44
    s_cmp_eq_u32 s3, 1
    s_cbranch_scc1 L_ow_42
    s_cmp_eq_u32 s3, 2
    s_cbranch_scc1 L_ow_43
    s_cmp_eq_u32 s3, 3
    s_cbranch_scc1 L_ow_44
L_ow_41:
    v_mov_b32 v240, v64
    v_mov_b32 v241, v65
    v_mov_b32 v242, v66
    v_mov_b32 v243, v67
    v_mov_b32 v244, v68
    v_mov_b32 v245, v69
    v_mov_b32 v246, v70
    v_mov_b32 v247, v71
    v_mov_b32 v248, v72
    v_mov_b32 v249, v73
    v_mov_b32 v250, v74
    v_mov_b32 v251, v75
    v_mov_b32 v252, v76
    v_mov_b32 v253, v77
    v_mov_b32 v254, v78
    v_mov_b32 v255, v79
    s_branch L_oe_40
L_ow_42:
    v_mov_b32 v240, v80
    v_mov_b32 v241, v81
    v_mov_b32 v242, v82
    v_mov_b32 v243, v83
    v_mov_b32 v244, v84
    v_mov_b32 v245, v85
    v_mov_b32 v246, v86
    v_mov_b32 v247, v87
    v_mov_b32 v248, v88
    v_mov_b32 v249, v89
    v_mov_b32 v250, v90
    v_mov_b32 v251, v91
    v_mov_b32 v252, v92
    v_mov_b32 v253, v93
    v_mov_b32 v254, v94
    v_mov_b32 v255, v95
    s_branch L_oe_40
L_ow_43:
    v_mov_b32 v240, v96
    v_mov_b32 v241, v97
    v_mov_b32 v242, v98
    v_mov_b32 v243, v99
    v_mov_b32 v244, v100
    v_mov_b32 v245, v101
    v_mov_b32 v246, v102
    v_mov_b32 v247, v103
    v_mov_b32 v248, v104
    v_mov_b32 v249, v105
    v_mov_b32 v250, v106
    v_mov_b32 v251, v107
    v_mov_b32 v252, v108
    v_mov_b32 v253, v109
    v_mov_b32 v254, v110
    v_mov_b32 v255, v111
    s_branch L_oe_40
L_ow_44:
    v_mov_b32 v240, v112
    v_mov_b32 v241, v113
    v_mov_b32 v242, v114
    v_mov_b32 v243, v115
    v_mov_b32 v244, v116
    v_mov_b32 v245, v117
    v_mov_b32 v246, v118
    v_mov_b32 v247, v119
    v_mov_b32 v248, v120
    v_mov_b32 v249, v121
    v_mov_b32 v250, v122
    v_mov_b32 v251, v123
    v_mov_b32 v252, v124
    v_mov_b32 v253, v125
    v_mov_b32 v254, v126
    v_mov_b32 v255, v127
L_oe_40:
    s_waitcnt lgkmcnt(0)
    s_barrier
    ds_read_b128 v[128:131], v213 offset:0
    ds_read_b128 v[132:135], v213 offset:1024
    ds_read_b128 v[136:139], v213 offset:2048
    ds_read_b128 v[140:143], v213 offset:3072
    ds_read_b128 v[144:147], v214 offset:0
    ds_read_b128 v[148:151], v214 offset:1024
    ds_read_b128 v[152:155], v214 offset:2048
    ds_read_b128 v[156:159], v214 offset:3072
    ds_read_b128 v[160:163], v215 offset:0
    ds_read_b128 v[164:167], v215 offset:1024
    ds_read_b128 v[168:171], v215 offset:2048
    ds_read_b128 v[172:175], v215 offset:3072
    ds_read_b128 v[64:67], v216 offset:0
    ds_read_b128 v[68:71], v216 offset:1024
    ds_read_b128 v[72:75], v216 offset:2048
    ds_read_b128 v[76:79], v216 offset:3072
    ds_read_b128 v[80:83], v217 offset:0
    ds_read_b128 v[84:87], v217 offset:1024
    ds_read_b128 v[88:91], v217 offset:2048
    ds_read_b128 v[92:95], v217 offset:3072
    ds_read_b128 v[96:99], v218 offset:0
    ds_read_b128 v[100:103], v218 offset:1024
    ds_read_b128 v[104:107], v218 offset:2048
    ds_read_b128 v[108:111], v218 offset:3072
    s_waitcnt lgkmcnt(12)
    v_add_f32 v224, v224, v128
    v_add_f32 v144, v144, v160
    v_add_f32 v225, v225, v129
    v_add_f32 v145, v145, v161
    v_add_f32 v226, v226, v130
    v_add_f32 v146, v146, v162
    v_add_f32 v227, v227, v131
    v_add_f32 v147, v147, v163
    v_add_f32 v228, v228, v132
    v_add_f32 v148, v148, v164
    v_add_f32 v229, v229, v133
    v_add_f32 v149, v149, v165
    v_add_f32 v230, v230, v134
    v_add_f32 v150, v150, v166
    v_add_f32 v231, v231, v135
    v_add_f32 v151, v151, v167
    v_add_f32 v232, v232, v136
    v_add_f32 v152, v152, v168
    v_add_f32 v233, v233, v137
    v_add_f32 v153, v153, v169
    v_add_f32 v234, v234, v138
    v_add_f32 v154, v154, v170
    v_add_f32 v235, v235, v139
    v_add_f32 v155, v155, v171
    v_add_f32 v236, v236, v140
    v_add_f32 v156, v156, v172
    v_add_f32 v237, v237, v141
    v_add_f32 v157, v157, v173
    v_add_f32 v238, v238, v142
    v_add_f32 v158, v158, v174
    v_add_f32 v239, v239, v143
    v_add_f32 v159, v159, v175
    v_add_f32 v224, v224, v144
    v_add_f32 v225, v225, v145
    v_add_f32 v226, v226, v146
    v_add_f32 v227, v227, v147
    v_add_f32 v228, v228, v148
    v_add_f32 v229, v229, v149
    v_add_f32 v230, v230, v150
    v_add_f32 v231, v231, v151
    v_add_f32 v232, v232, v152
    v_add_f32 v233, v233, v153
    v_add_f32 v234, v234, v154
    v_add_f32 v235, v235, v155
    v_add_f32 v236, v236, v156
    v_add_f32 v237, v237, v157
    v_add_f32 v238, v238, v158
    v_add_f32 v239, v239, v159
    s_waitcnt lgkmcnt(0)
    v_add_f32 v240, v240, v64
    v_add_f32 v80, v80, v96
    v_add_f32 v241, v241, v65
    v_add_f32 v81, v81, v97
    v_add_f32 v242, v242, v66
    v_add_f32 v82, v82, v98
    v_add_f32 v243, v243, v67
    v_add_f32 v83, v83, v99
    v_add_f32 v244, v244, v68
    v_add_f32 v84, v84, v100
    v_add_f32 v245, v245, v69
    v_add_f32 v85, v85, v101
    v_add_f32 v246, v246, v70
    v_add_f32 v86, v86, v102
    v_add_f32 v247, v247, v71
    v_add_f32 v87, v87, v103
    v_add_f32 v248, v248, v72
    v_add_f32 v88, v88, v104
    v_add_f32 v249, v249, v73
    v_add_f32 v89, v89, v105
    v_add_f32 v250, v250, v74
    v_add_f32 v90, v90, v106
    v_add_f32 v251, v251, v75
    v_add_f32 v91, v91, v107
    v_add_f32 v252, v252, v76
    v_add_f32 v92, v92, v108
    v_add_f32 v253, v253, v77
    v_add_f32 v93, v93, v109
    v_add_f32 v254, v254, v78
    v_add_f32 v94, v94, v110
    v_add_f32 v255, v255, v79
    v_add_f32 v95, v95, v111
    v_add_f32 v240, v240, v80
    v_add_f32 v241, v241, v81
    v_add_f32 v242, v242, v82
    v_add_f32 v243, v243, v83
    v_add_f32 v244, v244, v84
    v_add_f32 v245, v245, v85
    v_add_f32 v246, v246, v86
    v_add_f32 v247, v247, v87
    v_add_f32 v248, v248, v88
    v_add_f32 v249, v249, v89
    v_add_f32 v250, v250, v90
    v_add_f32 v251, v251, v91
    v_add_f32 v252, v252, v92
    v_add_f32 v253, v253, v93
    v_add_f32 v254, v254, v94
    v_add_f32 v255, v255, v95
    s_waitcnt vmcnt(0)
    v_lshlrev_b32 v208, 16, v208
    v_sub_f32 v210, 1.0, v209
    v_cvt_pk_bf16_f32 v210, v210, v210
    v_lshlrev_b32 v210, 16, v210
    v_lshlrev_b32 v23, 2, v22
    v_cvt_pk_bf16_f32 v32, v240, v241
    v_lshlrev_b32 v33, 16, v32
    v_and_b32 v32, 0xffff0000, v32
    v_add_f32 v33, v33, v208
    v_add_f32 v32, v32, v208
    v_cvt_pk_bf16_f32 v32, v33, v32
    v_lshlrev_b32 v33, 16, v32
    v_and_b32 v32, 0xffff0000, v32
    v_mul_f32 v33, v33, v210
    v_mul_f32 v32, v32, v210
    v_cvt_pk_bf16_f32 v32, v33, v32
    v_lshlrev_b32 v240, 16, v32
    v_and_b32 v241, 0xffff0000, v32
    v_lshlrev_b32 v33, 16, v192
    v_and_b32 v32, 0xffff0000, v192
    v_lshlrev_b32 v34, 16, v200
    v_and_b32 v35, 0xffff0000, v200
    v_mul_f32 v33, v33, v34
    v_mul_f32 v32, v32, v35
    v_cvt_pk_bf16_f32 v32, v33, v32
    v_lshlrev_b32 v33, 16, v32
    v_and_b32 v32, 0xffff0000, v32
    v_fma_f32 v33, 2.0, v224, v33
    v_fma_f32 v32, 2.0, v225, v32
    v_mul_f32 v33, v33, v209
    v_mul_f32 v32, v32, v209
    v_add_f32 v240, v240, v33
    v_add_f32 v241, v241, v32
    v_cvt_pk_bf16_f32 v32, v242, v243
    v_lshlrev_b32 v33, 16, v32
    v_and_b32 v32, 0xffff0000, v32
    v_add_f32 v33, v33, v208
    v_add_f32 v32, v32, v208
    v_cvt_pk_bf16_f32 v32, v33, v32
    v_lshlrev_b32 v33, 16, v32
    v_and_b32 v32, 0xffff0000, v32
    v_mul_f32 v33, v33, v210
    v_mul_f32 v32, v32, v210
    v_cvt_pk_bf16_f32 v32, v33, v32
    v_lshlrev_b32 v242, 16, v32
    v_and_b32 v243, 0xffff0000, v32
    v_lshlrev_b32 v33, 16, v193
    v_and_b32 v32, 0xffff0000, v193
    v_lshlrev_b32 v34, 16, v201
    v_and_b32 v35, 0xffff0000, v201
    v_mul_f32 v33, v33, v34
    v_mul_f32 v32, v32, v35
    v_cvt_pk_bf16_f32 v32, v33, v32
    v_lshlrev_b32 v33, 16, v32
    v_and_b32 v32, 0xffff0000, v32
    v_fma_f32 v33, 2.0, v226, v33
    v_fma_f32 v32, 2.0, v227, v32
    v_mul_f32 v33, v33, v209
    v_mul_f32 v32, v32, v209
    v_add_f32 v242, v242, v33
    v_add_f32 v243, v243, v32
    buffer_store_dwordx4 v[240:243], v23, s[32:35], 0 offen offset:0
    v_cvt_pk_bf16_f32 v32, v244, v245
    v_lshlrev_b32 v33, 16, v32
    v_and_b32 v32, 0xffff0000, v32
    v_add_f32 v33, v33, v208
    v_add_f32 v32, v32, v208
    v_cvt_pk_bf16_f32 v32, v33, v32
    v_lshlrev_b32 v33, 16, v32
    v_and_b32 v32, 0xffff0000, v32
    v_mul_f32 v33, v33, v210
    v_mul_f32 v32, v32, v210
    v_cvt_pk_bf16_f32 v32, v33, v32
    v_lshlrev_b32 v244, 16, v32
    v_and_b32 v245, 0xffff0000, v32
    v_lshlrev_b32 v33, 16, v194
    v_and_b32 v32, 0xffff0000, v194
    v_lshlrev_b32 v34, 16, v202
    v_and_b32 v35, 0xffff0000, v202
    v_mul_f32 v33, v33, v34
    v_mul_f32 v32, v32, v35
    v_cvt_pk_bf16_f32 v32, v33, v32
    v_lshlrev_b32 v33, 16, v32
    v_and_b32 v32, 0xffff0000, v32
    v_fma_f32 v33, 2.0, v228, v33
    v_fma_f32 v32, 2.0, v229, v32
    v_mul_f32 v33, v33, v209
    v_mul_f32 v32, v32, v209
    v_add_f32 v244, v244, v33
    v_add_f32 v245, v245, v32
    v_cvt_pk_bf16_f32 v32, v246, v247
    v_lshlrev_b32 v33, 16, v32
    v_and_b32 v32, 0xffff0000, v32
    v_add_f32 v33, v33, v208
    v_add_f32 v32, v32, v208
    v_cvt_pk_bf16_f32 v32, v33, v32
    v_lshlrev_b32 v33, 16, v32
    v_and_b32 v32, 0xffff0000, v32
    v_mul_f32 v33, v33, v210
    v_mul_f32 v32, v32, v210
    v_cvt_pk_bf16_f32 v32, v33, v32
    v_lshlrev_b32 v246, 16, v32
    v_and_b32 v247, 0xffff0000, v32
    v_lshlrev_b32 v33, 16, v195
    v_and_b32 v32, 0xffff0000, v195
    v_lshlrev_b32 v34, 16, v203
    v_and_b32 v35, 0xffff0000, v203
    v_mul_f32 v33, v33, v34
    v_mul_f32 v32, v32, v35
    v_cvt_pk_bf16_f32 v32, v33, v32
    v_lshlrev_b32 v33, 16, v32
    v_and_b32 v32, 0xffff0000, v32
    v_fma_f32 v33, 2.0, v230, v33
    v_fma_f32 v32, 2.0, v231, v32
    v_mul_f32 v33, v33, v209
    v_mul_f32 v32, v32, v209
    v_add_f32 v246, v246, v33
    v_add_f32 v247, v247, v32
    buffer_store_dwordx4 v[244:247], v23, s[32:35], 0 offen offset:32
    v_cvt_pk_bf16_f32 v32, v248, v249
    v_lshlrev_b32 v33, 16, v32
    v_and_b32 v32, 0xffff0000, v32
    v_add_f32 v33, v33, v208
    v_add_f32 v32, v32, v208
    v_cvt_pk_bf16_f32 v32, v33, v32
    v_lshlrev_b32 v33, 16, v32
    v_and_b32 v32, 0xffff0000, v32
    v_mul_f32 v33, v33, v210
    v_mul_f32 v32, v32, v210
    v_cvt_pk_bf16_f32 v32, v33, v32
    v_lshlrev_b32 v248, 16, v32
    v_and_b32 v249, 0xffff0000, v32
    v_lshlrev_b32 v33, 16, v196
    v_and_b32 v32, 0xffff0000, v196
    v_lshlrev_b32 v34, 16, v204
    v_and_b32 v35, 0xffff0000, v204
    v_mul_f32 v33, v33, v34
    v_mul_f32 v32, v32, v35
    v_cvt_pk_bf16_f32 v32, v33, v32
    v_lshlrev_b32 v33, 16, v32
    v_and_b32 v32, 0xffff0000, v32
    v_fma_f32 v33, 2.0, v232, v33
    v_fma_f32 v32, 2.0, v233, v32
    v_mul_f32 v33, v33, v209
    v_mul_f32 v32, v32, v209
    v_add_f32 v248, v248, v33
    v_add_f32 v249, v249, v32
    v_cvt_pk_bf16_f32 v32, v250, v251
    v_lshlrev_b32 v33, 16, v32
    v_and_b32 v32, 0xffff0000, v32
    v_add_f32 v33, v33, v208
    v_add_f32 v32, v32, v208
    v_cvt_pk_bf16_f32 v32, v33, v32
    v_lshlrev_b32 v33, 16, v32
    v_and_b32 v32, 0xffff0000, v32
    v_mul_f32 v33, v33, v210
    v_mul_f32 v32, v32, v210
    v_cvt_pk_bf16_f32 v32, v33, v32
    v_lshlrev_b32 v250, 16, v32
    v_and_b32 v251, 0xffff0000, v32
    v_lshlrev_b32 v33, 16, v197
    v_and_b32 v32, 0xffff0000, v197
    v_lshlrev_b32 v34, 16, v205
    v_and_b32 v35, 0xffff0000, v205
    v_mul_f32 v33, v33, v34
    v_mul_f32 v32, v32, v35
    v_cvt_pk_bf16_f32 v32, v33, v32
    v_lshlrev_b32 v33, 16, v32
    v_and_b32 v32, 0xffff0000, v32
    v_fma_f32 v33, 2.0, v234, v33
    v_fma_f32 v32, 2.0, v235, v32
    v_mul_f32 v33, v33, v209
    v_mul_f32 v32, v32, v209
    v_add_f32 v250, v250, v33
    v_add_f32 v251, v251, v32
    buffer_store_dwordx4 v[248:251], v23, s[32:35], 0 offen offset:64
    v_cvt_pk_bf16_f32 v32, v252, v253
    v_lshlrev_b32 v33, 16, v32
    v_and_b32 v32, 0xffff0000, v32
    v_add_f32 v33, v33, v208
    v_add_f32 v32, v32, v208
    v_cvt_pk_bf16_f32 v32, v33, v32
    v_lshlrev_b32 v33, 16, v32
    v_and_b32 v32, 0xffff0000, v32
    v_mul_f32 v33, v33, v210
    v_mul_f32 v32, v32, v210
    v_cvt_pk_bf16_f32 v32, v33, v32
    v_lshlrev_b32 v252, 16, v32
    v_and_b32 v253, 0xffff0000, v32
    v_lshlrev_b32 v33, 16, v198
    v_and_b32 v32, 0xffff0000, v198
    v_lshlrev_b32 v34, 16, v206
    v_and_b32 v35, 0xffff0000, v206
    v_mul_f32 v33, v33, v34
    v_mul_f32 v32, v32, v35
    v_cvt_pk_bf16_f32 v32, v33, v32
    v_lshlrev_b32 v33, 16, v32
    v_and_b32 v32, 0xffff0000, v32
    v_fma_f32 v33, 2.0, v236, v33
    v_fma_f32 v32, 2.0, v237, v32
    v_mul_f32 v33, v33, v209
    v_mul_f32 v32, v32, v209
    v_add_f32 v252, v252, v33
    v_add_f32 v253, v253, v32
    v_cvt_pk_bf16_f32 v32, v254, v255
    v_lshlrev_b32 v33, 16, v32
    v_and_b32 v32, 0xffff0000, v32
    v_add_f32 v33, v33, v208
    v_add_f32 v32, v32, v208
    v_cvt_pk_bf16_f32 v32, v33, v32
    v_lshlrev_b32 v33, 16, v32
    v_and_b32 v32, 0xffff0000, v32
    v_mul_f32 v33, v33, v210
    v_mul_f32 v32, v32, v210
    v_cvt_pk_bf16_f32 v32, v33, v32
    v_lshlrev_b32 v254, 16, v32
    v_and_b32 v255, 0xffff0000, v32
    v_lshlrev_b32 v33, 16, v199
    v_and_b32 v32, 0xffff0000, v199
    v_lshlrev_b32 v34, 16, v207
    v_and_b32 v35, 0xffff0000, v207
    v_mul_f32 v33, v33, v34
    v_mul_f32 v32, v32, v35
    v_cvt_pk_bf16_f32 v32, v33, v32
    v_lshlrev_b32 v33, 16, v32
    v_and_b32 v32, 0xffff0000, v32
    v_fma_f32 v33, 2.0, v238, v33
    v_fma_f32 v32, 2.0, v239, v32
    v_mul_f32 v33, v33, v209
    v_mul_f32 v32, v32, v209
    v_add_f32 v254, v254, v33
    v_add_f32 v255, v255, v32
    buffer_store_dwordx4 v[252:255], v23, s[32:35], 0 offen offset:96
    s_endpgm
L_lpath:
    s_cmp_ge_u32 s41, 8
    s_cselect_b32 s36, s72, s70
    s_cselect_b32 s37, s73, s71
    s_and_b32 s48, s40, 1
    s_lshl_b32 s48, s48, 18
    s_mov_b32 s38, 524288
    s_xor_b32 s50, s40, 1
    s_lshl_b32 s50, s50, 18
    s_cmp_ge_u32 s41, 16
    s_cselect_b32 s36, s64, s36
    s_cselect_b32 s37, s65, s37
    s_cselect_b32 s38, 2097152, s38
    s_cselect_b32 s48, s50, s48
    s_and_b32 s49, s41, 7
    s_and_b32 s37, s37, 0xffff
    s_mov_b32 s39, 0x00020000
    s_lshl_b32 s49, s49, 2
    s_add_u32 s49, s49, s3
    s_lshl_b32 s49, s49, 13
    s_add_u32 s48, s48, s49
    v_lshlrev_b32 v18, 7, v1
    buffer_load_dword v5, v18, s[36:39], s48 offen
    buffer_load_dwordx2 v[28:29], off, s[4:7], 0 sc1
    s_mov_b32 s32, s88
    s_and_b32 s33, s89, 0xffff
    s_mov_b32 s34, 5636096
    s_mov_b32 s35, 0x00020000
    s_bitcmp1_b32 s40, 1
    s_cselect_b32 s24, s76, s74
    s_cselect_b32 s25, s77, s75
    s_and_b32 s25, s25, 0xffff
    s_mov_b32 s26, 524288
    s_mov_b32 s27, 0x00020000
    s_sub_u32 s43, s41, 20
    s_lshl_b32 s43, s43, 2
    s_add_u32 s43, s43, s3
    s_and_b32 s45, s40, 1
    s_lshl_b32 s44, s45, 4
    s_add_u32 s44, s44, s43
    s_lshl_b32 s44, s44, 14
    s_lshl_b32 s45, s45, 3
    s_and_b32 s46, s43, 7
    s_add_u32 s45, s45, s46
    s_lshl_b32 s45, s45, 14
    s_lshr_b32 s46, s40, 1
    s_lshl_b32 s46, s46, 10
    s_add_u32 s45, s45, s46
    v_lshlrev_b32 v14, 7, v1
    v_lshrrev_b32 v15, 4, v1
    v_lshlrev_b32 v15, 12, v15
    v_and_b32 v16, 7, v1
    v_lshl_add_u32 v15, v16, 7, v15
    v_bfe_u32 v16, v1, 3, 1
    v_lshlrev_b32 v16, 11, v16
    v_sub_u32 v16, 2048, v16
    v_add_u32 v15, v15, v16
    s_sub_u32 s45, s45, 2048
    s_mov_b32 s59, 0
    s_cmp_ge_u32 s43, 8
    s_cselect_b32 s59, 1572864, s59
    s_add_u32 s59, s59, s45
    buffer_load_dword v5, v15, s[32:35], s59 offen
    s_mov_b32 s59, 3145728
    s_cmp_ge_u32 s43, 8
    s_cselect_b32 s59, 4456448, s59
    s_add_u32 s59, s59, s45
    buffer_load_dword v5, v15, s[32:35], s59 offen
    buffer_load_dword v5, v14, s[24:27], s44 offen
    s_add_u32 s44, s44, 8192
    buffer_load_dword v5, v14, s[24:27], s44 offen
    s_mov_b32 s59, 262144
    s_cmp_ge_u32 s43, 8
    s_cselect_b32 s59, 1835008, s59
    s_add_u32 s59, s59, s45
    buffer_load_dword v5, v15, s[32:35], s59 offen
    s_mov_b32 s59, 3407872
    s_cmp_ge_u32 s43, 8
    s_cselect_b32 s59, 4718592, s59
    s_add_u32 s59, s59, s45
    buffer_load_dword v5, v15, s[32:35], s59 offen
    s_mov_b32 s59, 524288
    s_cmp_ge_u32 s43, 8
    s_cselect_b32 s59, 2097152, s59
    s_add_u32 s59, s59, s45
    buffer_load_dword v5, v15, s[32:35], s59 offen
    s_mov_b32 s59, 3670016
    s_cmp_ge_u32 s43, 8
    s_cselect_b32 s59, 4980736, s59
    s_add_u32 s59, s59, s45
    buffer_load_dword v5, v15, s[32:35], s59 offen
    s_mov_b32 s59, 786432
    s_cmp_ge_u32 s43, 8
    s_cselect_b32 s59, 2359296, s59
    s_add_u32 s59, s59, s45
    buffer_load_dword v5, v15, s[32:35], s59 offen
    s_mov_b32 s59, 3932160
    s_cmp_ge_u32 s43, 8
    s_cselect_b32 s59, 5242880, s59
    s_add_u32 s59, s59, s45
    buffer_load_dword v5, v15, s[32:35], s59 offen
    s_mov_b32 s59, 1048576
    s_cmp_ge_u32 s43, 8
    s_cselect_b32 s59, 2621440, s59
    s_add_u32 s59, s59, s45
    buffer_load_dword v5, v15, s[32:35], s59 offen
    s_mov_b32 s59, 4194304
    s_cmp_ge_u32 s43, 8
    s_cselect_b32 s59, 5505024, s59
    s_add_u32 s59, s59, s45
    buffer_load_dword v5, v15, s[32:35], s59 offen
    s_mov_b32 s59, 1310720
    s_cmp_ge_u32 s43, 8
    s_cselect_b32 s59, 2883584, s59
    s_add_u32 s59, s59, s45
    buffer_load_dword v5, v15, s[32:35], s59 offen
    s_waitcnt vmcnt(13)
    s_mov_b32 s60, 20000
L_np_45:
    v_readfirstlane_b32 s100, v28
    v_readfirstlane_b32 s101, v29
    s_cmp_lg_u32 s100, 0
    s_cbranch_scc1 L_npd_46
    buffer_load_dwordx2 v[28:29], off, s[4:7], 0 sc1
    s_waitcnt vmcnt(0)
    s_sub_u32 s60, s60, 1
    s_cmp_lg_u32 s60, 0
    s_cbranch_scc1 L_np_45
L_npd_46:
    s_add_u32 s4, s98, 3670016
    s_addc_u32 s5, s99, 0
    s_and_b32 s5, s5, 0xffff
    s_mov_b32 s6, 65536
    s_mov_b32 s7, 0x00020000
    s_mov_b32 s28, s74
    s_and_b32 s29, s75, 0xffff
    s_mov_b32 s30, 524288
    s_mov_b32 s31, 0x00020000
    s_mov_b32 s36, s76
    s_and_b32 s37, s77, 0xffff
    s_mov_b32 s38, 524288
    s_mov_b32 s39, 0x00020000
    s_lshl_b32 s58, s3, 8
    s_lshl_b32 s43, s53, 16
    s_add_u32 s58, s58, s43
    s_mov_b32 s50, 0x05040100
    s_mov_b32 s51, 0x07060302
    v_lshrrev_b32 v14, 3, v1
    v_mul_u32_u24 v14, 1024, v14
    v_and_b32 v15, 7, v1
    v_lshrrev_b32 v16, 4, v1
    v_xor_b32 v15, v15, v16
    v_lshlrev_b32 v15, 4, v15
    v_add_u32 v2, v14, v15
    v_xor_b32 v15, 64, v15
    v_add_u32 v3, v14, v15
    v_and_b32 v14, 31, v1
    v_lshrrev_b32 v15, 1, v14
    v_and_b32 v15, 7, v15
    v_lshrrev_b32 v16, 5, v1
    v_xor_b32 v15, v15, v16
    v_lshlrev_b32 v15, 4, v15
    v_lshl_add_u32 v14, v14, 7, v15
    v_add_u32 v6, s42, v14
    v_xor_b32 v7, 32, v6
    v_xor_b32 v8, 64, v6
    v_xor_b32 v9, 96, v6
    s_mov_b32 s32, s88
    s_and_b32 s33, s89, 0xffff
    s_mov_b32 s34, 5636096
    s_mov_b32 s35, 0x00020000
    s_mul_i32 s61, s3, 6
    s_cmp_eq_u32 s3, 3
    s_cselect_b32 s61, 17, s61
    s_lshl_b32 s61, s61, 18
    s_lshl_b32 s43, s52, 7
    s_add_u32 s61, s61, s43
    v_lshrrev_b32 v14, 3, v1
    v_mul_u32_u24 v14, 4096, v14
    v_and_b32 v15, 7, v1
    v_lshrrev_b32 v16, 2, v1
    v_and_b32 v16, 4, v16
    v_xor_b32 v15, v15, v16
    v_lshl_add_u32 v12, v15, 4, v14
    v_lshrrev_b32 v14, 5, v1
    v_lshlrev_b32 v14, 3, v14
    v_lshrrev_b32 v15, 2, v1
    v_and_b32 v15, 3, v15
    v_add_u32 v14, v14, v15
    v_lshlrev_b32 v14, 7, v14
    v_lshrrev_b32 v16, 4, v1
    v_and_b32 v16, 1, v16
    v_lshlrev_b32 v16, 1, v16
    v_lshrrev_b32 v17, 1, v1
    v_and_b32 v17, 1, v17
    v_add_u32 v16, v16, v17
    v_lshrrev_b32 v15, 1, v15
    v_lshlrev_b32 v15, 2, v15
    v_xor_b32 v16, v16, v15
    v_lshl_add_u32 v14, v16, 4, v14
    v_and_b32 v17, 1, v1
    v_lshl_add_u32 v14, v17, 3, v14
    v_add_u32 v10, s42, v14
    v_xor_b32 v11, 64, v10
    s_cmp_ge_u32 s3, 2
    s_cselect_b32 s63, 0x40000000, 0
    s_add_u32 s63, s63, s61
    s_add_u32 s8, s98, 8388608
    s_addc_u32 s9, s99, 0
    s_and_b32 s9, s9, 0xffff
    s_mov_b32 s10, 4194304
    s_mov_b32 s11, 0x00020000
    s_add_u32 s12, s98, 4194304
    s_addc_u32 s13, s99, 0
    s_and_b32 s13, s13, 0xffff
    s_mov_b32 s14, 1441792
    s_mov_b32 s15, 0x00020000
    s_lshl_b32 s57, s52, 17
    s_lshl_b32 s43, s3, 9
    s_add_u32 s57, s57, s43
    s_mul_i32 s83, s3, 6
    s_cmp_eq_u32 s3, 3
    s_cselect_b32 s83, 17, s83
    s_lshl_b32 s83, s83, 13
    s_mul_i32 s43, s53, 180224
    s_add_u32 s83, s83, s43
    s_cmp_ge_u32 s3, 2
    s_cselect_b32 s82, 0x40000000, 0
    s_add_u32 s82, s82, s83
    v_lshrrev_b32 v14, 3, v1
    v_mul_u32_u24 v14, 2048, v14
    v_and_b32 v15, 7, v1
    v_lshrrev_b32 v16, 4, v1
    v_xor_b32 v15, v15, v16
    v_lshlrev_b32 v15, 4, v15
    v_add_u32 v28, v14, v15
    v_xor_b32 v15, 64, v15
    v_add_u32 v29, v14, v15
    v_and_b32 v14, 31, v1
    v_lshrrev_b32 v15, 1, v14
    v_and_b32 v15, 7, v15
    v_lshrrev_b32 v16, 5, v1
    v_lshlrev_b32 v16, 1, v16
    v_xor_b32 v15, v15, v16
    v_lshlrev_b32 v15, 4, v15
    v_lshl_add_u32 v14, v14, 7, v15
    v_add_u32 v24, s42, v14
    v_xor_b32 v25, 16, v24
    v_xor_b32 v26, 64, v24
    v_xor_b32 v27, 80, v24
    s_lshr_b32 s43, s52, 1
    s_lshl_b32 s43, s43, 2
    s_add_u32 s43, s43, s3
    s_lshl_b32 s43, s43, 7
    s_add_u32 s43, s43, 32768
    v_lshl_add_u32 v14, v1, 5, s43
    s_mov_b64 exec, 15
    buffer_load_dwordx2 v[18:19], v14, s[4:7], 0 offen sc1
    s_mov_b64 exec, -1
    s_add_u32 m0, s42, 0
    s_add_u32 s59, s58, 0
    buffer_load_dwordx4 v2, s[28:31], s59 offen lds
    s_add_u32 m0, s42, 1024
    s_add_u32 s59, s58, 8192
    buffer_load_dwordx4 v3, s[28:31], s59 offen lds
    s_add_u32 m0, s42, 2048
    s_add_u32 s59, s58, 16384
    buffer_load_dwordx4 v2, s[28:31], s59 offen lds
    s_add_u32 m0, s42, 3072
    s_add_u32 s59, s58, 24576
    buffer_load_dwordx4 v3, s[28:31], s59 offen lds
    s_add_u32 m0, s42, 4096
    s_add_u32 s59, s58, 32768
    buffer_load_dwordx4 v2, s[28:31], s59 offen lds
    s_add_u32 m0, s42, 5120
    s_add_u32 s59, s58, 40960
    buffer_load_dwordx4 v3, s[28:31], s59 offen lds
    s_add_u32 m0, s42, 6144
    s_add_u32 s59, s58, 49152
    buffer_load_dwordx4 v2, s[28:31], s59 offen lds
    s_add_u32 m0, s42, 7168
    s_add_u32 s59, s58, 57344
    buffer_load_dwordx4 v3, s[28:31], s59 offen lds
    s_add_u32 m0, s42, 8192
    s_add_u32 s59, s58, 0
    buffer_load_dwordx4 v2, s[36:39], s59 offen lds
    s_add_u32 m0, s42, 9216
    s_add_u32 s59, s58, 8192
    buffer_load_dwordx4 v3, s[36:39], s59 offen lds
    s_add_u32 m0, s42, 10240
    s_add_u32 s59, s58, 16384
    buffer_load_dwordx4 v2, s[36:39], s59 offen lds
    s_add_u32 m0, s42, 11264
    s_add_u32 s59, s58, 24576
    buffer_load_dwordx4 v3, s[36:39], s59 offen lds
    s_add_u32 m0, s42, 12288
    s_add_u32 s59, s58, 32768
    buffer_load_dwordx4 v2, s[36:39], s59 offen lds
    s_add_u32 m0, s42, 13312
    s_add_u32 s59, s58, 40960
    buffer_load_dwordx4 v3, s[36:39], s59 offen lds
    s_add_u32 m0, s42, 14336
    s_add_u32 s59, s58, 49152
    buffer_load_dwordx4 v2, s[36:39], s59 offen lds
    s_add_u32 m0, s42, 15360
    s_add_u32 s59, s58, 57344
    buffer_load_dwordx4 v3, s[36:39], s59 offen lds
    s_add_u32 m0, s42, 16384
    s_add_u32 s59, s58, 128
    buffer_load_dwordx4 v2, s[28:31], s59 offen lds
    s_add_u32 m0, s42, 17408
    s_add_u32 s59, s58, 8320
    buffer_load_dwordx4 v3, s[28:31], s59 offen lds
    s_add_u32 m0, s42, 18432
    s_add_u32 s59, s58, 16512
    buffer_load_dwordx4 v2, s[28:31], s59 offen lds
    s_add_u32 m0, s42, 19456
    s_add_u32 s59, s58, 24704
    buffer_load_dwordx4 v3, s[28:31], s59 offen lds
    s_add_u32 m0, s42, 20480
    s_add_u32 s59, s58, 32896
    buffer_load_dwordx4 v2, s[28:31], s59 offen lds
    s_add_u32 m0, s42, 21504
    s_add_u32 s59, s58, 41088
    buffer_load_dwordx4 v3, s[28:31], s59 offen lds
    s_add_u32 m0, s42, 22528
    s_add_u32 s59, s58, 49280
    buffer_load_dwordx4 v2, s[28:31], s59 offen lds
    s_add_u32 m0, s42, 23552
    s_add_u32 s59, s58, 57472
    buffer_load_dwordx4 v3, s[28:31], s59 offen lds
    s_add_u32 m0, s42, 24576
    s_add_u32 s59, s58, 128
    buffer_load_dwordx4 v2, s[36:39], s59 offen lds
    s_add_u32 m0, s42, 25600
    s_add_u32 s59, s58, 8320
    buffer_load_dwordx4 v3, s[36:39], s59 offen lds
    s_add_u32 m0, s42, 26624
    s_add_u32 s59, s58, 16512
    buffer_load_dwordx4 v2, s[36:39], s59 offen lds
    s_add_u32 m0, s42, 27648
    s_add_u32 s59, s58, 24704
    buffer_load_dwordx4 v3, s[36:39], s59 offen lds
    s_add_u32 m0, s42, 28672
    s_add_u32 s59, s58, 32896
    buffer_load_dwordx4 v2, s[36:39], s59 offen lds
    s_add_u32 m0, s42, 29696
    s_add_u32 s59, s58, 41088
    buffer_load_dwordx4 v3, s[36:39], s59 offen lds
    s_add_u32 m0, s42, 30720
    s_add_u32 s59, s58, 49280
    buffer_load_dwordx4 v2, s[36:39], s59 offen lds
    s_add_u32 m0, s42, 31744
    s_add_u32 s59, s58, 57472
    buffer_load_dwordx4 v3, s[36:39], s59 offen lds
    s_add_u32 m0, s42, 32768
    s_add_u32 s59, s61, 0
    buffer_load_dwordx4 v12, s[32:35], s59 offen lds
    s_add_u32 m0, s42, 33792
    s_add_u32 s59, s61, 32768
    buffer_load_dwordx4 v12, s[32:35], s59 offen lds
    s_add_u32 m0, s42, 34816
    s_add_u32 s59, s61, 65536
    buffer_load_dwordx4 v12, s[32:35], s59 offen lds
    s_add_u32 m0, s42, 35840
    s_add_u32 s59, s61, 98304
    buffer_load_dwordx4 v12, s[32:35], s59 offen lds
    s_add_u32 m0, s42, 36864
    s_add_u32 s59, s61, 131072
    buffer_load_dwordx4 v12, s[32:35], s59 offen lds
    s_add_u32 m0, s42, 37888
    s_add_u32 s59, s61, 163840
    buffer_load_dwordx4 v12, s[32:35], s59 offen lds
    s_add_u32 m0, s42, 38912
    s_add_u32 s59, s61, 196608
    buffer_load_dwordx4 v12, s[32:35], s59 offen lds
    s_add_u32 m0, s42, 39936
    s_add_u32 s59, s61, 229376
    buffer_load_dwordx4 v12, s[32:35], s59 offen lds
    s_waitcnt vmcnt(24)
    ds_read_b128 v[32:35], v6 offset:0
    ds_read_b128 v[36:39], v6 offset:4096
    ds_read_b128 v[40:43], v6 offset:8192
    ds_read_b128 v[44:47], v6 offset:12288
    ds_read_b128 v[48:51], v7 offset:0
    ds_read_b128 v[52:55], v7 offset:4096
    ds_read_b128 v[56:59], v7 offset:8192
    ds_read_b128 v[60:63], v7 offset:12288
    s_waitcnt lgkmcnt(4)
    v_perm_b32 v128, v40, v32, s50
    v_perm_b32 v129, v40, v32, s51
    v_perm_b32 v130, v41, v33, s50
    v_perm_b32 v131, v41, v33, s51
    v_perm_b32 v136, v42, v34, s50
    v_perm_b32 v137, v42, v34, s51
    v_perm_b32 v138, v43, v35, s50
    v_perm_b32 v139, v43, v35, s51
    v_perm_b32 v132, v44, v36, s50
    v_perm_b32 v133, v44, v36, s51
    v_perm_b32 v134, v45, v37, s50
    v_perm_b32 v135, v45, v37, s51
    v_perm_b32 v140, v46, v38, s50
    v_perm_b32 v141, v46, v38, s51
    v_perm_b32 v142, v47, v39, s50
    v_perm_b32 v143, v47, v39, s51
    s_waitcnt lgkmcnt(0)
    v_perm_b32 v144, v56, v48, s50
    v_perm_b32 v145, v56, v48, s51
    v_perm_b32 v146, v57, v49, s50
    v_perm_b32 v147, v57, v49, s51
    v_perm_b32 v152, v58, v50, s50
    v_perm_b32 v153, v58, v50, s51
    v_perm_b32 v154, v59, v51, s50
    v_perm_b32 v155, v59, v51, s51
    v_perm_b32 v148, v60, v52, s50
    v_perm_b32 v149, v60, v52, s51
    v_perm_b32 v150, v61, v53, s50
    v_perm_b32 v151, v61, v53, s51
    v_perm_b32 v156, v62, v54, s50
    v_perm_b32 v157, v62, v54, s51
    v_perm_b32 v158, v63, v55, s50
    v_perm_b32 v159, v63, v55, s51
    ds_read_b128 v[32:35], v8 offset:0
    ds_read_b128 v[36:39], v8 offset:4096
    ds_read_b128 v[40:43], v8 offset:8192
    ds_read_b128 v[44:47], v8 offset:12288
    ds_read_b128 v[48:51], v9 offset:0
    ds_read_b128 v[52:55], v9 offset:4096
    ds_read_b128 v[56:59], v9 offset:8192
    ds_read_b128 v[60:63], v9 offset:12288
    s_waitcnt lgkmcnt(4)
    v_perm_b32 v160, v40, v32, s50
    v_perm_b32 v161, v40, v32, s51
    v_perm_b32 v162, v41, v33, s50
    v_perm_b32 v163, v41, v33, s51
    v_perm_b32 v168, v42, v34, s50
    v_perm_b32 v169, v42, v34, s51
    v_perm_b32 v170, v43, v35, s50
    v_perm_b32 v171, v43, v35, s51
    v_perm_b32 v164, v44, v36, s50
    v_perm_b32 v165, v44, v36, s51
    v_perm_b32 v166, v45, v37, s50
    v_perm_b32 v167, v45, v37, s51
    v_perm_b32 v172, v46, v38, s50
    v_perm_b32 v173, v46, v38, s51
    v_perm_b32 v174, v47, v39, s50
    v_perm_b32 v175, v47, v39, s51
    s_waitcnt lgkmcnt(0)
    v_perm_b32 v176, v56, v48, s50
    v_perm_b32 v177, v56, v48, s51
    v_perm_b32 v178, v57, v49, s50
    v_perm_b32 v179, v57, v49, s51
    v_perm_b32 v184, v58, v50, s50
    v_perm_b32 v185, v58, v50, s51
    v_perm_b32 v186, v59, v51, s50
    v_perm_b32 v187, v59, v51, s51
    v_perm_b32 v180, v60, v52, s50
    v_perm_b32 v181, v60, v52, s51
    v_perm_b32 v182, v61, v53, s50
    v_perm_b32 v183, v61, v53, s51
    v_perm_b32 v188, v62, v54, s50
    v_perm_b32 v189, v62, v54, s51
    v_perm_b32 v190, v63, v55, s50
    v_perm_b32 v191, v63, v55, s51
    s_add_u32 m0, s42, 0
    s_add_u32 s59, s61, 262144
    buffer_load_dwordx4 v12, s[32:35], s59 offen lds
    s_add_u32 m0, s42, 1024
    s_add_u32 s59, s61, 294912
    buffer_load_dwordx4 v12, s[32:35], s59 offen lds
    s_add_u32 m0, s42, 2048
    s_add_u32 s59, s61, 327680
    buffer_load_dwordx4 v12, s[32:35], s59 offen lds
    s_add_u32 m0, s42, 3072
    s_add_u32 s59, s61, 360448
    buffer_load_dwordx4 v12, s[32:35], s59 offen lds
    s_add_u32 m0, s42, 4096
    s_add_u32 s59, s61, 393216
    buffer_load_dwordx4 v12, s[32:35], s59 offen lds
    s_add_u32 m0, s42, 5120
    s_add_u32 s59, s61, 425984
    buffer_load_dwordx4 v12, s[32:35], s59 offen lds
    s_add_u32 m0, s42, 6144
    s_add_u32 s59, s61, 458752
    buffer_load_dwordx4 v12, s[32:35], s59 offen lds
    s_add_u32 m0, s42, 7168
    s_add_u32 s59, s61, 491520
    buffer_load_dwordx4 v12, s[32:35], s59 offen lds
    s_add_u32 m0, s42, 8192
    s_add_u32 s59, s61, 524288
    buffer_load_dwordx4 v12, s[32:35], s59 offen lds
    s_add_u32 m0, s42, 9216
    s_add_u32 s59, s61, 557056
    buffer_load_dwordx4 v12, s[32:35], s59 offen lds
    s_add_u32 m0, s42, 10240
    s_add_u32 s59, s61, 589824
    buffer_load_dwordx4 v12, s[32:35], s59 offen lds
    s_add_u32 m0, s42, 11264
    s_add_u32 s59, s61, 622592
    buffer_load_dwordx4 v12, s[32:35], s59 offen lds
    s_add_u32 m0, s42, 12288
    s_add_u32 s59, s61, 655360
    buffer_load_dwordx4 v12, s[32:35], s59 offen lds
    s_add_u32 m0, s42, 13312
    s_add_u32 s59, s61, 688128
    buffer_load_dwordx4 v12, s[32:35], s59 offen lds
    s_add_u32 m0, s42, 14336
    s_add_u32 s59, s61, 720896
    buffer_load_dwordx4 v12, s[32:35], s59 offen lds
    s_add_u32 m0, s42, 15360
    s_add_u32 s59, s61, 753664
    buffer_load_dwordx4 v12, s[32:35], s59 offen lds
    s_waitcnt vmcnt(24)
    ds_read_b128 v[32:35], v6 offset:16384
    ds_read_b128 v[36:39], v6 offset:20480
    ds_read_b128 v[40:43], v6 offset:24576
    ds_read_b128 v[44:47], v6 offset:28672
    ds_read_b128 v[48:51], v7 offset:16384
    ds_read_b128 v[52:55], v7 offset:20480
    ds_read_b128 v[56:59], v7 offset:24576
    ds_read_b128 v[60:63], v7 offset:28672
    s_waitcnt lgkmcnt(4)
    v_perm_b32 v192, v40, v32, s50
    v_perm_b32 v193, v40, v32, s51
    v_perm_b32 v194, v41, v33, s50
    v_perm_b32 v195, v41, v33, s51
    v_perm_b32 v200, v42, v34, s50
    v_perm_b32 v201, v42, v34, s51
    v_perm_b32 v202, v43, v35, s50
    v_perm_b32 v203, v43, v35, s51
    v_perm_b32 v196, v44, v36, s50
    v_perm_b32 v197, v44, v36, s51
    v_perm_b32 v198, v45, v37, s50
    v_perm_b32 v199, v45, v37, s51
    v_perm_b32 v204, v46, v38, s50
    v_perm_b32 v205, v46, v38, s51
    v_perm_b32 v206, v47, v39, s50
    v_perm_b32 v207, v47, v39, s51
    s_waitcnt lgkmcnt(0)
    v_perm_b32 v208, v56, v48, s50
    v_perm_b32 v209, v56, v48, s51
    v_perm_b32 v210, v57, v49, s50
    v_perm_b32 v211, v57, v49, s51
    v_perm_b32 v216, v58, v50, s50
    v_perm_b32 v217, v58, v50, s51
    v_perm_b32 v218, v59, v51, s50
    v_perm_b32 v219, v59, v51, s51
    v_perm_b32 v212, v60, v52, s50
    v_perm_b32 v213, v60, v52, s51
    v_perm_b32 v214, v61, v53, s50
    v_perm_b32 v215, v61, v53, s51
    v_perm_b32 v220, v62, v54, s50
    v_perm_b32 v221, v62, v54, s51
    v_perm_b32 v222, v63, v55, s50
    v_perm_b32 v223, v63, v55, s51
    ds_read_b128 v[32:35], v8 offset:16384
    ds_read_b128 v[36:39], v8 offset:20480
    ds_read_b128 v[40:43], v8 offset:24576
    ds_read_b128 v[44:47], v8 offset:28672
    ds_read_b128 v[48:51], v9 offset:16384
    ds_read_b128 v[52:55], v9 offset:20480
    ds_read_b128 v[56:59], v9 offset:24576
    ds_read_b128 v[60:63], v9 offset:28672
    s_waitcnt lgkmcnt(4)
    v_perm_b32 v224, v40, v32, s50
    v_perm_b32 v225, v40, v32, s51
    v_perm_b32 v226, v41, v33, s50
    v_perm_b32 v227, v41, v33, s51
    v_perm_b32 v232, v42, v34, s50
    v_perm_b32 v233, v42, v34, s51
    v_perm_b32 v234, v43, v35, s50
    v_perm_b32 v235, v43, v35, s51
    v_perm_b32 v228, v44, v36, s50
    v_perm_b32 v229, v44, v36, s51
    v_perm_b32 v230, v45, v37, s50
    v_perm_b32 v231, v45, v37, s51
    v_perm_b32 v236, v46, v38, s50
    v_perm_b32 v237, v46, v38, s51
    v_perm_b32 v238, v47, v39, s50
    v_perm_b32 v239, v47, v39, s51
    s_waitcnt lgkmcnt(0)
    v_perm_b32 v240, v56, v48, s50
    v_perm_b32 v241, v56, v48, s51
    v_perm_b32 v242, v57, v49, s50
    v_perm_b32 v243, v57, v49, s51
    v_perm_b32 v248, v58, v50, s50
    v_perm_b32 v249, v58, v50, s51
    v_perm_b32 v250, v59, v51, s50
    v_perm_b32 v251, v59, v51, s51
    v_perm_b32 v244, v60, v52, s50
    v_perm_b32 v245, v60, v52, s51
    v_perm_b32 v246, v61, v53, s50
    v_perm_b32 v247, v61, v53, s51
    v_perm_b32 v252, v62, v54, s50
    v_perm_b32 v253, v62, v54, s51
    v_perm_b32 v254, v63, v55, s50
    v_perm_b32 v255, v63, v55, s51
    s_add_u32 m0, s42, 16384
    s_add_u32 s59, s61, 786432
    buffer_load_dwordx4 v12, s[32:35], s59 offen lds
    s_add_u32 m0, s42, 17408
    s_add_u32 s59, s61, 819200
    buffer_load_dwordx4 v12, s[32:35], s59 offen lds
    s_add_u32 m0, s42, 18432
    s_add_u32 s59, s61, 851968
    buffer_load_dwordx4 v12, s[32:35], s59 offen lds
    s_add_u32 m0, s42, 19456
    s_add_u32 s59, s61, 884736
    buffer_load_dwordx4 v12, s[32:35], s59 offen lds
    s_add_u32 m0, s42, 20480
    s_add_u32 s59, s61, 917504
    buffer_load_dwordx4 v12, s[32:35], s59 offen lds
    s_add_u32 m0, s42, 21504
    s_add_u32 s59, s61, 950272
    buffer_load_dwordx4 v12, s[32:35], s59 offen lds
    s_add_u32 m0, s42, 22528
    s_add_u32 s59, s61, 983040
    buffer_load_dwordx4 v12, s[32:35], s59 offen lds
    s_add_u32 m0, s42, 23552
    s_add_u32 s59, s61, 1015808
    buffer_load_dwordx4 v12, s[32:35], s59 offen lds
    s_add_u32 m0, s42, 24576
    s_add_u32 s59, s61, 1048576
    buffer_load_dwordx4 v12, s[32:35], s59 offen lds
    s_add_u32 m0, s42, 25600
    s_add_u32 s59, s61, 1081344
    buffer_load_dwordx4 v12, s[32:35], s59 offen lds
    s_add_u32 m0, s42, 26624
    s_add_u32 s59, s61, 1114112
    buffer_load_dwordx4 v12, s[32:35], s59 offen lds
    s_add_u32 m0, s42, 27648
    s_add_u32 s59, s61, 1146880
    buffer_load_dwordx4 v12, s[32:35], s59 offen lds
    s_add_u32 m0, s42, 28672
    s_add_u32 s59, s61, 1179648
    buffer_load_dwordx4 v12, s[32:35], s59 offen lds
    s_add_u32 m0, s42, 29696
    s_add_u32 s59, s61, 1212416
    buffer_load_dwordx4 v12, s[32:35], s59 offen lds
    s_add_u32 m0, s42, 30720
    s_add_u32 s59, s61, 1245184
    buffer_load_dwordx4 v12, s[32:35], s59 offen lds
    s_add_u32 m0, s42, 31744
    s_add_u32 s59, s61, 1277952
    buffer_load_dwordx4 v12, s[32:35], s59 offen lds
    s_waitcnt vmcnt(32)
    ds_read_b64_tr_b16 a[0:1], v10 offset:32768
    ds_read_b64_tr_b16 a[2:3], v10 offset:33280
    ds_read_b64_tr_b16 a[4:5], v11 offset:32768
    ds_read_b64_tr_b16 a[6:7], v11 offset:33280
    ds_read_b64_tr_b16 a[8:9], v10 offset:34816
    ds_read_b64_tr_b16 a[10:11], v10 offset:35328
    ds_read_b64_tr_b16 a[12:13], v11 offset:34816
    ds_read_b64_tr_b16 a[14:15], v11 offset:35328
    ds_read_b64_tr_b16 a[16:17], v10 offset:36864
    ds_read_b64_tr_b16 a[18:19], v10 offset:37376
    ds_read_b64_tr_b16 a[20:21], v11 offset:36864
    ds_read_b64_tr_b16 a[22:23], v11 offset:37376
    ds_read_b64_tr_b16 a[24:25], v10 offset:38912
    ds_read_b64_tr_b16 a[26:27], v10 offset:39424
    ds_read_b64_tr_b16 a[28:29], v11 offset:38912
    ds_read_b64_tr_b16 a[30:31], v11 offset:39424
    s_waitcnt lgkmcnt(0)
    s_add_u32 m0, s42, 32768
    s_add_u32 s59, s63, 1310720
    buffer_load_dwordx4 v12, s[32:35], s59 offen lds
    s_add_u32 m0, s42, 33792
    s_add_u32 s59, s63, 1343488
    buffer_load_dwordx4 v12, s[32:35], s59 offen lds
    s_add_u32 m0, s42, 34816
    s_add_u32 s59, s63, 1376256
    buffer_load_dwordx4 v12, s[32:35], s59 offen lds
    s_add_u32 m0, s42, 35840
    s_add_u32 s59, s63, 1409024
    buffer_load_dwordx4 v12, s[32:35], s59 offen lds
    s_add_u32 m0, s42, 36864
    s_add_u32 s59, s63, 1441792
    buffer_load_dwordx4 v12, s[32:35], s59 offen lds
    s_add_u32 m0, s42, 37888
    s_add_u32 s59, s63, 1474560
    buffer_load_dwordx4 v12, s[32:35], s59 offen lds
    s_add_u32 m0, s42, 38912
    s_add_u32 s59, s63, 1507328
    buffer_load_dwordx4 v12, s[32:35], s59 offen lds
    s_add_u32 m0, s42, 39936
    s_add_u32 s59, s63, 1540096
    buffer_load_dwordx4 v12, s[32:35], s59 offen lds
    s_waitcnt vmcnt(32)
    ds_read_b64_tr_b16 a[32:33], v10 offset:0
    ds_read_b64_tr_b16 a[34:35], v10 offset:512
    ds_read_b64_tr_b16 a[36:37], v11 offset:0
    ds_read_b64_tr_b16 a[38:39], v11 offset:512
    ds_read_b64_tr_b16 a[40:41], v10 offset:2048
    ds_read_b64_tr_b16 a[42:43], v10 offset:2560
    ds_read_b64_tr_b16 a[44:45], v11 offset:2048
    ds_read_b64_tr_b16 a[46:47], v11 offset:2560
    ds_read_b64_tr_b16 a[48:49], v10 offset:4096
    ds_read_b64_tr_b16 a[50:51], v10 offset:4608
    ds_read_b64_tr_b16 a[52:53], v11 offset:4096
    ds_read_b64_tr_b16 a[54:55], v11 offset:4608
    ds_read_b64_tr_b16 a[56:57], v10 offset:6144
    ds_read_b64_tr_b16 a[58:59], v10 offset:6656
    ds_read_b64_tr_b16 a[60:61], v11 offset:6144
    ds_read_b64_tr_b16 a[62:63], v11 offset:6656
    s_waitcnt lgkmcnt(0)
    s_lshr_b32 s43, s52, 1
    s_lshl_b32 s43, s43, 2
    s_add_u32 s43, s43, s3
    s_lshl_b32 s43, s43, 7
    s_add_u32 s43, s43, 32768
    v_lshl_add_u32 v14, v1, 5, s43
    s_mov_b64 exec, 15
    s_mov_b32 s60, 20000
    s_branch L_pollc_48
L_poll_47:
    buffer_load_dwordx2 v[18:19], v14, s[4:7], 0 offen sc1
    s_waitcnt vmcnt(0)
L_pollc_48:
    v_cmp_ne_u64 vcc, s[100:101], v[18:19]
    s_cbranch_vccz L_polld_49
    s_sleep 4
    s_sub_u32 s60, s60, 1
    s_cmp_lg_u32 s60, 0
    s_cbranch_scc1 L_poll_47
L_polld_49:
    s_mov_b64 exec, -1
    s_add_u32 m0, s42, 0
    s_add_u32 s59, s57, 0
    buffer_load_dwordx4 v28, s[8:11], s59 offen lds
    s_add_u32 m0, s42, 1024
    s_add_u32 s59, s57, 16384
    buffer_load_dwordx4 v29, s[8:11], s59 offen lds
    s_add_u32 m0, s42, 2048
    s_add_u32 s59, s57, 32768
    buffer_load_dwordx4 v28, s[8:11], s59 offen lds
    s_add_u32 m0, s42, 3072
    s_add_u32 s59, s57, 49152
    buffer_load_dwordx4 v29, s[8:11], s59 offen lds
    s_add_u32 m0, s42, 4096
    s_add_u32 s59, s57, 65536
    buffer_load_dwordx4 v28, s[8:11], s59 offen lds
    s_add_u32 m0, s42, 5120
    s_add_u32 s59, s57, 81920
    buffer_load_dwordx4 v29, s[8:11], s59 offen lds
    s_add_u32 m0, s42, 6144
    s_add_u32 s59, s57, 98304
    buffer_load_dwordx4 v28, s[8:11], s59 offen lds
    s_add_u32 m0, s42, 7168
    s_add_u32 s59, s57, 114688
    buffer_load_dwordx4 v29, s[8:11], s59 offen lds
    s_waitcnt vmcnt(32)
    ds_read_b64_tr_b16 a[64:65], v10 offset:8192
    ds_read_b64_tr_b16 a[66:67], v10 offset:8704
    ds_read_b64_tr_b16 a[68:69], v11 offset:8192
    ds_read_b64_tr_b16 a[70:71], v11 offset:8704
    ds_read_b64_tr_b16 a[72:73], v10 offset:10240
    ds_read_b64_tr_b16 a[74:75], v10 offset:10752
    ds_read_b64_tr_b16 a[76:77], v11 offset:10240
    ds_read_b64_tr_b16 a[78:79], v11 offset:10752
    ds_read_b64_tr_b16 a[80:81], v10 offset:12288
    ds_read_b64_tr_b16 a[82:83], v10 offset:12800
    ds_read_b64_tr_b16 a[84:85], v11 offset:12288
    ds_read_b64_tr_b16 a[86:87], v11 offset:12800
    ds_read_b64_tr_b16 a[88:89], v10 offset:14336
    ds_read_b64_tr_b16 a[90:91], v10 offset:14848
    ds_read_b64_tr_b16 a[92:93], v11 offset:14336
    ds_read_b64_tr_b16 a[94:95], v11 offset:14848
    s_waitcnt lgkmcnt(0)
    s_add_u32 m0, s42, 8192
    s_add_u32 s59, s57, 128
    buffer_load_dwordx4 v28, s[8:11], s59 offen lds
    s_add_u32 m0, s42, 9216
    s_add_u32 s59, s57, 16512
    buffer_load_dwordx4 v29, s[8:11], s59 offen lds
    s_add_u32 m0, s42, 10240
    s_add_u32 s59, s57, 32896
    buffer_load_dwordx4 v28, s[8:11], s59 offen lds
    s_add_u32 m0, s42, 11264
    s_add_u32 s59, s57, 49280
    buffer_load_dwordx4 v29, s[8:11], s59 offen lds
    s_add_u32 m0, s42, 12288
    s_add_u32 s59, s57, 65664
    buffer_load_dwordx4 v28, s[8:11], s59 offen lds
    s_add_u32 m0, s42, 13312
    s_add_u32 s59, s57, 82048
    buffer_load_dwordx4 v29, s[8:11], s59 offen lds
    s_add_u32 m0, s42, 14336
    s_add_u32 s59, s57, 98432
    buffer_load_dwordx4 v28, s[8:11], s59 offen lds
    s_add_u32 m0, s42, 15360
    s_add_u32 s59, s57, 114816
    buffer_load_dwordx4 v29, s[8:11], s59 offen lds
    s_waitcnt vmcnt(32)
    ds_read_b64_tr_b16 a[96:97], v10 offset:16384
    ds_read_b64_tr_b16 a[98:99], v10 offset:16896
    ds_read_b64_tr_b16 a[100:101], v11 offset:16384
    ds_read_b64_tr_b16 a[102:103], v11 offset:16896
    ds_read_b64_tr_b16 a[104:105], v10 offset:18432
    ds_read_b64_tr_b16 a[106:107], v10 offset:18944
    ds_read_b64_tr_b16 a[108:109], v11 offset:18432
    ds_read_b64_tr_b16 a[110:111], v11 offset:18944
    ds_read_b64_tr_b16 a[112:113], v10 offset:20480
    ds_read_b64_tr_b16 a[114:115], v10 offset:20992
    ds_read_b64_tr_b16 a[116:117], v11 offset:20480
    ds_read_b64_tr_b16 a[118:119], v11 offset:20992
    ds_read_b64_tr_b16 a[120:121], v10 offset:22528
    ds_read_b64_tr_b16 a[122:123], v10 offset:23040
    ds_read_b64_tr_b16 a[124:125], v11 offset:22528
    ds_read_b64_tr_b16 a[126:127], v11 offset:23040
    s_waitcnt lgkmcnt(0)
    s_add_u32 m0, s42, 16384
    s_add_u32 s59, s57, 256
    buffer_load_dwordx4 v28, s[8:11], s59 offen lds
    s_add_u32 m0, s42, 17408
    s_add_u32 s59, s57, 16640
    buffer_load_dwordx4 v29, s[8:11], s59 offen lds
    s_add_u32 m0, s42, 18432
    s_add_u32 s59, s57, 33024
    buffer_load_dwordx4 v28, s[8:11], s59 offen lds
    s_add_u32 m0, s42, 19456
    s_add_u32 s59, s57, 49408
    buffer_load_dwordx4 v29, s[8:11], s59 offen lds
    s_add_u32 m0, s42, 20480
    s_add_u32 s59, s57, 65792
    buffer_load_dwordx4 v28, s[8:11], s59 offen lds
    s_add_u32 m0, s42, 21504
    s_add_u32 s59, s57, 82176
    buffer_load_dwordx4 v29, s[8:11], s59 offen lds
    s_add_u32 m0, s42, 22528
    s_add_u32 s59, s57, 98560
    buffer_load_dwordx4 v28, s[8:11], s59 offen lds
    s_add_u32 m0, s42, 23552
    s_add_u32 s59, s57, 114944
    buffer_load_dwordx4 v29, s[8:11], s59 offen lds
    s_waitcnt vmcnt(32)
    ds_read_b64_tr_b16 a[128:129], v10 offset:24576
    ds_read_b64_tr_b16 a[130:131], v10 offset:25088
    ds_read_b64_tr_b16 a[132:133], v11 offset:24576
    ds_read_b64_tr_b16 a[134:135], v11 offset:25088
    ds_read_b64_tr_b16 a[136:137], v10 offset:26624
    ds_read_b64_tr_b16 a[138:139], v10 offset:27136
    ds_read_b64_tr_b16 a[140:141], v11 offset:26624
    ds_read_b64_tr_b16 a[142:143], v11 offset:27136
    ds_read_b64_tr_b16 a[144:145], v10 offset:28672
    ds_read_b64_tr_b16 a[146:147], v10 offset:29184
    ds_read_b64_tr_b16 a[148:149], v11 offset:28672
    ds_read_b64_tr_b16 a[150:151], v11 offset:29184
    ds_read_b64_tr_b16 a[152:153], v10 offset:30720
    ds_read_b64_tr_b16 a[154:155], v10 offset:31232
    ds_read_b64_tr_b16 a[156:157], v11 offset:30720
    ds_read_b64_tr_b16 a[158:159], v11 offset:31232
    s_waitcnt lgkmcnt(0)
    s_add_u32 m0, s42, 24576
    s_add_u32 s59, s57, 384
    buffer_load_dwordx4 v28, s[8:11], s59 offen lds
    s_add_u32 m0, s42, 25600
    s_add_u32 s59, s57, 16768
    buffer_load_dwordx4 v29, s[8:11], s59 offen lds
    s_add_u32 m0, s42, 26624
    s_add_u32 s59, s57, 33152
    buffer_load_dwordx4 v28, s[8:11], s59 offen lds
    s_add_u32 m0, s42, 27648
    s_add_u32 s59, s57, 49536
    buffer_load_dwordx4 v29, s[8:11], s59 offen lds
    s_add_u32 m0, s42, 28672
    s_add_u32 s59, s57, 65920
    buffer_load_dwordx4 v28, s[8:11], s59 offen lds
    s_add_u32 m0, s42, 29696
    s_add_u32 s59, s57, 82304
    buffer_load_dwordx4 v29, s[8:11], s59 offen lds
    s_add_u32 m0, s42, 30720
    s_add_u32 s59, s57, 98688
    buffer_load_dwordx4 v28, s[8:11], s59 offen lds
    s_add_u32 m0, s42, 31744
    s_add_u32 s59, s57, 115072
    buffer_load_dwordx4 v29, s[8:11], s59 offen lds
    s_waitcnt vmcnt(32)
    s_cmp_ge_u32 s3, 2
    s_cbranch_scc1 L_co_50
    ds_read_b64_tr_b16 a[160:161], v10 offset:32768
    ds_read_b64_tr_b16 a[162:163], v10 offset:33280
    ds_read_b64_tr_b16 a[164:165], v11 offset:32768
    ds_read_b64_tr_b16 a[166:167], v11 offset:33280
    ds_read_b64_tr_b16 a[168:169], v10 offset:34816
    ds_read_b64_tr_b16 a[170:171], v10 offset:35328
    ds_read_b64_tr_b16 a[172:173], v11 offset:34816
    ds_read_b64_tr_b16 a[174:175], v11 offset:35328
    ds_read_b64_tr_b16 a[176:177], v10 offset:36864
    ds_read_b64_tr_b16 a[178:179], v10 offset:37376
    ds_read_b64_tr_b16 a[180:181], v11 offset:36864
    ds_read_b64_tr_b16 a[182:183], v11 offset:37376
    ds_read_b64_tr_b16 a[184:185], v10 offset:38912
    ds_read_b64_tr_b16 a[186:187], v10 offset:39424
    ds_read_b64_tr_b16 a[188:189], v11 offset:38912
    ds_read_b64_tr_b16 a[190:191], v11 offset:39424
    s_waitcnt lgkmcnt(0)
L_co_50:
    s_waitcnt vmcnt(24)
    ds_read_b128 v[32:35], v24 offset:0
    ds_read_b128 v[36:39], v24 offset:4096
    ds_read_b128 v[40:43], v25 offset:0
    ds_read_b128 v[44:47], v25 offset:4096
    s_waitcnt lgkmcnt(2)
    v_mfma_f32_32x32x16_bf16 a[192:207], v[128:131], v[32:35], 0
    ds_read_b128 v[48:51], v26 offset:0
    v_mfma_f32_32x32x16_bf16 a[208:223], v[128:131], v[36:39], 0
    v_mfma_f32_32x32x16_bf16 a[224:239], v[132:135], v[32:35], 0
    ds_read_b128 v[52:55], v26 offset:4096
    v_mfma_f32_32x32x16_bf16 a[240:255], v[132:135], v[36:39], 0
    s_waitcnt lgkmcnt(2)
    s_mul_i32 s44, s3, 6
    s_cmp_eq_u32 s3, 3
    s_cselect_b32 s44, 17, s44
    s_mul_i32 s43, s53, 22
    s_add_u32 s43, s43, s44
    s_lshl_b32 s43, s43, 7
    s_add_u32 s43, s43, 8192
    v_lshl_add_u32 v14, v1, 5, s43
    s_cmp_ge_u32 s3, 2
    s_cselect_b32 s44, 20, 24
    s_bfm_b32 exec_lo, s44, 0
    s_mov_b32 exec_hi, 0
    buffer_load_dwordx2 v[18:19], v14, s[4:7], 0 offen sc1
    s_mov_b64 exec, -1
    v_mfma_f32_32x32x16_bf16 a[192:207], v[136:139], v[40:43], a[192:207]
    ds_read_b128 v[56:59], v27 offset:0
    v_mfma_f32_32x32x16_bf16 a[208:223], v[136:139], v[44:47], a[208:223]
    v_mfma_f32_32x32x16_bf16 a[224:239], v[140:143], v[40:43], a[224:239]
    ds_read_b128 v[60:63], v27 offset:4096
    v_mfma_f32_32x32x16_bf16 a[240:255], v[140:143], v[44:47], a[240:255]
    s_waitcnt vmcnt(17)
    s_waitcnt lgkmcnt(2)
    v_mfma_f32_32x32x16_bf16 a[192:207], v[144:147], v[48:51], a[192:207]
    ds_read_b128 v[32:35], v24 offset:8192
    v_mfma_f32_32x32x16_bf16 a[208:223], v[144:147], v[52:55], a[208:223]
    v_mfma_f32_32x32x16_bf16 a[224:239], v[148:151], v[48:51], a[224:239]
    ds_read_b128 v[36:39], v24 offset:12288
    v_mfma_f32_32x32x16_bf16 a[240:255], v[148:151], v[52:55], a[240:255]
    s_waitcnt lgkmcnt(2)
    v_mfma_f32_32x32x16_bf16 a[192:207], v[152:155], v[56:59], a[192:207]
    ds_read_b128 v[40:43], v25 offset:8192
    v_mfma_f32_32x32x16_bf16 a[208:223], v[152:155], v[60:63], a[208:223]
    v_mfma_f32_32x32x16_bf16 a[224:239], v[156:159], v[56:59], a[224:239]
    ds_read_b128 v[44:47], v25 offset:12288
    v_mfma_f32_32x32x16_bf16 a[240:255], v[156:159], v[60:63], a[240:255]
    s_waitcnt lgkmcnt(2)
    s_waitcnt vmcnt(0)
    s_mul_i32 s44, s3, 6
    s_cmp_eq_u32 s3, 3
    s_cselect_b32 s44, 17, s44
    s_mul_i32 s43, s53, 22
    s_add_u32 s43, s43, s44
    s_lshl_b32 s43, s43, 7
    s_add_u32 s43, s43, 8192
    v_lshl_add_u32 v14, v1, 5, s43
    s_cmp_ge_u32 s3, 2
    s_cselect_b32 s44, 20, 24
    s_bfm_b32 exec_lo, s44, 0
    s_mov_b32 exec_hi, 0
    s_mov_b32 s60, 20000
    s_branch L_pollc_52
L_poll_51:
    buffer_load_dwordx2 v[18:19], v14, s[4:7], 0 offen sc1
    s_waitcnt vmcnt(0)
L_pollc_52:
    v_cmp_ne_u64 vcc, s[100:101], v[18:19]
    s_cbranch_vccz L_polld_53
    s_sleep 4
    s_sub_u32 s60, s60, 1
    s_cmp_lg_u32 s60, 0
    s_cbranch_scc1 L_poll_51
L_polld_53:
    s_mov_b64 exec, -1
    v_lshrrev_b32 v14, 3, v1
    v_mul_u32_u24 v14, 64, v14
    v_and_b32 v15, 7, v1
    v_lshrrev_b32 v16, 4, v1
    v_xor_b32 v15, v15, v16
    v_and_b32 v16, 3, v15
    v_lshrrev_b32 v15, 2, v15
    v_lshlrev_b32 v15, 12, v15
    v_lshl_add_u32 v15, v16, 4, v15
    v_add_u32 v2, v14, v15
    v_xor_b32 v15, 4096, v15
    v_add_u32 v3, v14, v15
    v_mfma_f32_32x32x16_bf16 a[192:207], v[160:163], v[32:35], a[192:207]
    ds_read_b128 v[48:51], v26 offset:8192
    s_add_u32 m0, s42, 32768
    s_add_u32 s59, s83, 0
    buffer_load_dwordx4 v2, s[12:15], s59 offen lds
    v_mfma_f32_32x32x16_bf16 a[208:223], v[160:163], v[36:39], a[208:223]
    s_add_u32 m0, s42, 33792
    s_add_u32 s59, s83, 512
    buffer_load_dwordx4 v3, s[12:15], s59 offen lds
    v_mfma_f32_32x32x16_bf16 a[224:239], v[164:167], v[32:35], a[224:239]
    ds_read_b128 v[52:55], v26 offset:12288
    s_add_u32 m0, s42, 34816
    s_add_u32 s59, s83, 1024
    buffer_load_dwordx4 v2, s[12:15], s59 offen lds
    v_mfma_f32_32x32x16_bf16 a[240:255], v[164:167], v[36:39], a[240:255]
    s_add_u32 m0, s42, 35840
    s_add_u32 s59, s83, 1536
    buffer_load_dwordx4 v3, s[12:15], s59 offen lds
    s_waitcnt lgkmcnt(2)
    v_mfma_f32_32x32x16_bf16 a[192:207], v[168:171], v[40:43], a[192:207]
    ds_read_b128 v[56:59], v27 offset:8192
    s_add_u32 m0, s42, 36864
    s_add_u32 s59, s83, 2048
    buffer_load_dwordx4 v2, s[12:15], s59 offen lds
    v_mfma_f32_32x32x16_bf16 a[208:223], v[168:171], v[44:47], a[208:223]
    s_add_u32 m0, s42, 37888
    s_add_u32 s59, s83, 2560
    buffer_load_dwordx4 v3, s[12:15], s59 offen lds
    v_mfma_f32_32x32x16_bf16 a[224:239], v[172:175], v[40:43], a[224:239]
    ds_read_b128 v[60:63], v27 offset:12288
    s_add_u32 m0, s42, 38912
    s_add_u32 s59, s83, 3072
    buffer_load_dwordx4 v2, s[12:15], s59 offen lds
    v_mfma_f32_32x32x16_bf16 a[240:255], v[172:175], v[44:47], a[240:255]
    s_add_u32 m0, s42, 39936
    s_add_u32 s59, s83, 3584
    buffer_load_dwordx4 v3, s[12:15], s59 offen lds
    s_waitcnt lgkmcnt(2)
    v_mfma_f32_32x32x16_bf16 a[192:207], v[176:179], v[48:51], a[192:207]
    ds_read_b128 v[32:35], v24 offset:16384
    s_add_u32 m0, s42, 0
    s_add_u32 s59, s83, 8192
    buffer_load_dwordx4 v2, s[12:15], s59 offen lds
    v_mfma_f32_32x32x16_bf16 a[208:223], v[176:179], v[52:55], a[208:223]
    s_add_u32 m0, s42, 1024
    s_add_u32 s59, s83, 8704
    buffer_load_dwordx4 v3, s[12:15], s59 offen lds
    v_mfma_f32_32x32x16_bf16 a[224:239], v[180:183], v[48:51], a[224:239]
    ds_read_b128 v[36:39], v24 offset:20480
    s_add_u32 m0, s42, 2048
    s_add_u32 s59, s83, 9216
    buffer_load_dwordx4 v2, s[12:15], s59 offen lds
    v_mfma_f32_32x32x16_bf16 a[240:255], v[180:183], v[52:55], a[240:255]
    s_add_u32 m0, s42, 3072
    s_add_u32 s59, s83, 9728
    buffer_load_dwordx4 v3, s[12:15], s59 offen lds
    s_waitcnt lgkmcnt(2)
    v_mfma_f32_32x32x16_bf16 a[192:207], v[184:187], v[56:59], a[192:207]
    ds_read_b128 v[40:43], v25 offset:16384
    s_add_u32 m0, s42, 4096
    s_add_u32 s59, s83, 10240
    buffer_load_dwordx4 v2, s[12:15], s59 offen lds
    v_mfma_f32_32x32x16_bf16 a[208:223], v[184:187], v[60:63], a[208:223]
    s_add_u32 m0, s42, 5120
    s_add_u32 s59, s83, 10752
    buffer_load_dwordx4 v3, s[12:15], s59 offen lds
    v_mfma_f32_32x32x16_bf16 a[224:239], v[188:191], v[56:59], a[224:239]
    ds_read_b128 v[44:47], v25 offset:20480
    s_add_u32 m0, s42, 6144
    s_add_u32 s59, s83, 11264
    buffer_load_dwordx4 v2, s[12:15], s59 offen lds
    v_mfma_f32_32x32x16_bf16 a[240:255], v[188:191], v[60:63], a[240:255]
    s_add_u32 m0, s42, 7168
    s_add_u32 s59, s83, 11776
    buffer_load_dwordx4 v3, s[12:15], s59 offen lds
    s_waitcnt lgkmcnt(2)
    v_mfma_f32_32x32x16_bf16 a[192:207], v[192:195], v[32:35], a[192:207]
    ds_read_b128 v[48:51], v26 offset:16384
    v_mfma_f32_32x32x16_bf16 a[208:223], v[192:195], v[36:39], a[208:223]
    s_add_u32 m0, s42, 8192
    s_add_u32 s59, s83, 16384
    buffer_load_dwordx4 v2, s[12:15], s59 offen lds
    v_mfma_f32_32x32x16_bf16 a[224:239], v[196:199], v[32:35], a[224:239]
    ds_read_b128 v[52:55], v26 offset:20480
    v_mfma_f32_32x32x16_bf16 a[240:255], v[196:199], v[36:39], a[240:255]
    s_add_u32 m0, s42, 9216
    s_add_u32 s59, s83, 16896
    buffer_load_dwordx4 v3, s[12:15], s59 offen lds
    s_waitcnt lgkmcnt(2)
    v_mfma_f32_32x32x16_bf16 a[192:207], v[200:203], v[40:43], a[192:207]
    ds_read_b128 v[56:59], v27 offset:16384
    v_mfma_f32_32x32x16_bf16 a[208:223], v[200:203], v[44:47], a[208:223]
    s_add_u32 m0, s42, 10240
    s_add_u32 s59, s83, 17408
    buffer_load_dwordx4 v2, s[12:15], s59 offen lds
    v_mfma_f32_32x32x16_bf16 a[224:239], v[204:207], v[40:43], a[224:239]
    ds_read_b128 v[60:63], v27 offset:20480
    v_mfma_f32_32x32x16_bf16 a[240:255], v[204:207], v[44:47], a[240:255]
    s_add_u32 m0, s42, 11264
    s_add_u32 s59, s83, 17920
    buffer_load_dwordx4 v3, s[12:15], s59 offen lds
    s_waitcnt lgkmcnt(2)
    v_mfma_f32_32x32x16_bf16 a[192:207], v[208:211], v[48:51], a[192:207]
    ds_read_b128 v[32:35], v24 offset:24576
    v_mfma_f32_32x32x16_bf16 a[208:223], v[208:211], v[52:55], a[208:223]
    s_add_u32 m0, s42, 12288
    s_add_u32 s59, s83, 18432
    buffer_load_dwordx4 v2, s[12:15], s59 offen lds
    v_mfma_f32_32x32x16_bf16 a[224:239], v[212:215], v[48:51], a[224:239]
    ds_read_b128 v[36:39], v24 offset:28672
    v_mfma_f32_32x32x16_bf16 a[240:255], v[212:215], v[52:55], a[240:255]
    s_add_u32 m0, s42, 13312
    s_add_u32 s59, s83, 18944
    buffer_load_dwordx4 v3, s[12:15], s59 offen lds
    s_waitcnt lgkmcnt(2)
    v_mfma_f32_32x32x16_bf16 a[192:207], v[216:219], v[56:59], a[192:207]
    ds_read_b128 v[40:43], v25 offset:24576
    v_mfma_f32_32x32x16_bf16 a[208:223], v[216:219], v[60:63], a[208:223]
    s_add_u32 m0, s42, 14336
    s_add_u32 s59, s83, 19456
    buffer_load_dwordx4 v2, s[12:15], s59 offen lds
    v_mfma_f32_32x32x16_bf16 a[224:239], v[220:223], v[56:59], a[224:239]
    ds_read_b128 v[44:47], v25 offset:28672
    v_mfma_f32_32x32x16_bf16 a[240:255], v[220:223], v[60:63], a[240:255]
    s_add_u32 m0, s42, 15360
    s_add_u32 s59, s83, 19968
    buffer_load_dwordx4 v3, s[12:15], s59 offen lds
    s_waitcnt lgkmcnt(2)
    v_mfma_f32_32x32x16_bf16 a[192:207], v[224:227], v[32:35], a[192:207]
    ds_read_b128 v[48:51], v26 offset:24576
    v_mfma_f32_32x32x16_bf16 a[208:223], v[224:227], v[36:39], a[208:223]
    s_add_u32 m0, s42, 16384
    s_add_u32 s59, s83, 24576
    buffer_load_dwordx4 v2, s[12:15], s59 offen lds
    v_mfma_f32_32x32x16_bf16 a[224:239], v[228:231], v[32:35], a[224:239]
    ds_read_b128 v[52:55], v26 offset:28672
    v_mfma_f32_32x32x16_bf16 a[240:255], v[228:231], v[36:39], a[240:255]
    s_add_u32 m0, s42, 17408
    s_add_u32 s59, s83, 25088
    buffer_load_dwordx4 v3, s[12:15], s59 offen lds
    s_waitcnt lgkmcnt(2)
    v_mfma_f32_32x32x16_bf16 a[192:207], v[232:235], v[40:43], a[192:207]
    ds_read_b128 v[56:59], v27 offset:24576
    v_mfma_f32_32x32x16_bf16 a[208:223], v[232:235], v[44:47], a[208:223]
    s_add_u32 m0, s42, 18432
    s_add_u32 s59, s83, 25600
    buffer_load_dwordx4 v2, s[12:15], s59 offen lds
    v_mfma_f32_32x32x16_bf16 a[224:239], v[236:239], v[40:43], a[224:239]
    ds_read_b128 v[60:63], v27 offset:28672
    v_mfma_f32_32x32x16_bf16 a[240:255], v[236:239], v[44:47], a[240:255]
    s_add_u32 m0, s42, 19456
    s_add_u32 s59, s83, 26112
    buffer_load_dwordx4 v3, s[12:15], s59 offen lds
    s_waitcnt vmcnt(20)
    s_waitcnt lgkmcnt(2)
    v_mfma_f32_32x32x16_bf16 a[192:207], v[240:243], v[48:51], a[192:207]
    ds_read_b128 v[32:35], v6 offset:32768
    v_mfma_f32_32x32x16_bf16 a[208:223], v[240:243], v[52:55], a[208:223]
    s_add_u32 m0, s42, 20480
    s_add_u32 s59, s83, 26624
    buffer_load_dwordx4 v2, s[12:15], s59 offen lds
    v_mfma_f32_32x32x16_bf16 a[224:239], v[244:247], v[48:51], a[224:239]
    ds_read_b128 v[36:39], v6 offset:36864
    v_mfma_f32_32x32x16_bf16 a[240:255], v[244:247], v[52:55], a[240:255]
    s_add_u32 m0, s42, 21504
    s_add_u32 s59, s83, 27136
    buffer_load_dwordx4 v3, s[12:15], s59 offen lds
    s_waitcnt lgkmcnt(2)
    v_mfma_f32_32x32x16_bf16 a[192:207], v[248:251], v[56:59], a[192:207]
    ds_read_b128 v[40:43], v7 offset:32768
    v_mfma_f32_32x32x16_bf16 a[208:223], v[248:251], v[60:63], a[208:223]
    s_add_u32 m0, s42, 22528
    s_add_u32 s59, s83, 27648
    buffer_load_dwordx4 v2, s[12:15], s59 offen lds
    v_mfma_f32_32x32x16_bf16 a[224:239], v[252:255], v[56:59], a[224:239]
    ds_read_b128 v[44:47], v7 offset:36864
    v_mfma_f32_32x32x16_bf16 a[240:255], v[252:255], v[60:63], a[240:255]
    s_add_u32 m0, s42, 23552
    s_add_u32 s59, s83, 28160
    buffer_load_dwordx4 v3, s[12:15], s59 offen lds
    s_waitcnt lgkmcnt(2)
    v_mfma_f32_32x32x16_bf16 v[64:79], v[32:35], a[0:3], 0
    ds_read_b128 v[48:51], v8 offset:32768
    v_mfma_f32_32x32x16_bf16 v[80:95], v[32:35], a[4:7], 0
    s_add_u32 m0, s42, 24576
    s_add_u32 s59, s83, 32768
    buffer_load_dwordx4 v2, s[12:15], s59 offen lds
    v_mfma_f32_32x32x16_bf16 v[96:111], v[36:39], a[0:3], 0
    ds_read_b128 v[52:55], v8 offset:36864
    v_mfma_f32_32x32x16_bf16 v[112:127], v[36:39], a[4:7], 0
    s_add_u32 m0, s42, 25600
    s_add_u32 s59, s83, 33280
    buffer_load_dwordx4 v3, s[12:15], s59 offen lds
    s_waitcnt lgkmcnt(2)
    v_mfma_f32_32x32x16_bf16 v[64:79], v[40:43], a[8:11], v[64:79]
    ds_read_b128 v[56:59], v9 offset:32768
    v_mfma_f32_32x32x16_bf16 v[80:95], v[40:43], a[12:15], v[80:95]
    s_add_u32 m0, s42, 26624
    s_add_u32 s59, s83, 33792
    buffer_load_dwordx4 v2, s[12:15], s59 offen lds
    v_mfma_f32_32x32x16_bf16 v[96:111], v[44:47], a[8:11], v[96:111]
    ds_read_b128 v[60:63], v9 offset:36864
    v_mfma_f32_32x32x16_bf16 v[112:127], v[44:47], a[12:15], v[112:127]
    s_add_u32 m0, s42, 27648
    s_add_u32 s59, s83, 34304
    buffer_load_dwordx4 v3, s[12:15], s59 offen lds
    s_waitcnt vmcnt(20)
    s_waitcnt lgkmcnt(2)
    v_mfma_f32_32x32x16_bf16 v[64:79], v[48:51], a[16:19], v[64:79]
    ds_read_b128 v[32:35], v6 offset:0
    v_mfma_f32_32x32x16_bf16 v[80:95], v[48:51], a[20:23], v[80:95]
    s_add_u32 m0, s42, 28672
    s_add_u32 s59, s83, 34816
    buffer_load_dwordx4 v2, s[12:15], s59 offen lds
    v_mfma_f32_32x32x16_bf16 v[96:111], v[52:55], a[16:19], v[96:111]
    ds_read_b128 v[36:39], v6 offset:4096
    v_mfma_f32_32x32x16_bf16 v[112:127], v[52:55], a[20:23], v[112:127]
    s_add_u32 m0, s42, 29696
    s_add_u32 s59, s83, 35328
    buffer_load_dwordx4 v3, s[12:15], s59 offen lds
    s_waitcnt lgkmcnt(2)
    v_mfma_f32_32x32x16_bf16 v[64:79], v[56:59], a[24:27], v[64:79]
    ds_read_b128 v[40:43], v7 offset:0
    v_mfma_f32_32x32x16_bf16 v[80:95], v[56:59], a[28:31], v[80:95]
    s_add_u32 m0, s42, 30720
    s_add_u32 s59, s83, 35840
    buffer_load_dwordx4 v2, s[12:15], s59 offen lds
    v_mfma_f32_32x32x16_bf16 v[96:111], v[60:63], a[24:27], v[96:111]
    ds_read_b128 v[44:47], v7 offset:4096
    v_mfma_f32_32x32x16_bf16 v[112:127], v[60:63], a[28:31], v[112:127]
    s_add_u32 m0, s42, 31744
    s_add_u32 s59, s83, 36352
    buffer_load_dwordx4 v3, s[12:15], s59 offen lds
    s_waitcnt lgkmcnt(2)
    v_mfma_f32_32x32x16_bf16 v[64:79], v[32:35], a[32:35], v[64:79]
    ds_read_b128 v[48:51], v8 offset:0
    v_mfma_f32_32x32x16_bf16 v[80:95], v[32:35], a[36:39], v[80:95]
    s_add_u32 m0, s42, 32768
    s_add_u32 s59, s82, 40960
    buffer_load_dwordx4 v2, s[12:15], s59 offen lds
    v_mfma_f32_32x32x16_bf16 v[96:111], v[36:39], a[32:35], v[96:111]
    ds_read_b128 v[52:55], v8 offset:4096
    v_mfma_f32_32x32x16_bf16 v[112:127], v[36:39], a[36:39], v[112:127]
    s_add_u32 m0, s42, 33792
    s_add_u32 s59, s82, 41472
    buffer_load_dwordx4 v3, s[12:15], s59 offen lds
    s_waitcnt lgkmcnt(2)
    v_mfma_f32_32x32x16_bf16 v[64:79], v[40:43], a[40:43], v[64:79]
    ds_read_b128 v[56:59], v9 offset:0
    v_mfma_f32_32x32x16_bf16 v[80:95], v[40:43], a[44:47], v[80:95]
    s_add_u32 m0, s42, 34816
    s_add_u32 s59, s82, 41984
    buffer_load_dwordx4 v2, s[12:15], s59 offen lds
    v_mfma_f32_32x32x16_bf16 v[96:111], v[44:47], a[40:43], v[96:111]
    ds_read_b128 v[60:63], v9 offset:4096
    v_mfma_f32_32x32x16_bf16 v[112:127], v[44:47], a[44:47], v[112:127]
    s_add_u32 m0, s42, 35840
    s_add_u32 s59, s82, 42496
    buffer_load_dwordx4 v3, s[12:15], s59 offen lds
    s_waitcnt vmcnt(20)
    s_waitcnt lgkmcnt(2)
    v_mfma_f32_32x32x16_bf16 v[64:79], v[48:51], a[48:51], v[64:79]
    ds_read_b128 v[32:35], v6 offset:8192
    v_mfma_f32_32x32x16_bf16 v[80:95], v[48:51], a[52:55], v[80:95]
    s_add_u32 m0, s42, 36864
    s_add_u32 s59, s82, 43008
    buffer_load_dwordx4 v2, s[12:15], s59 offen lds
    v_mfma_f32_32x32x16_bf16 v[96:111], v[52:55], a[48:51], v[96:111]
    ds_read_b128 v[36:39], v6 offset:12288
    v_mfma_f32_32x32x16_bf16 v[112:127], v[52:55], a[52:55], v[112:127]
    s_add_u32 m0, s42, 37888
    s_add_u32 s59, s82, 43520
    buffer_load_dwordx4 v3, s[12:15], s59 offen lds
    s_waitcnt lgkmcnt(2)
    v_mfma_f32_32x32x16_bf16 v[64:79], v[56:59], a[56:59], v[64:79]
    ds_read_b128 v[40:43], v7 offset:8192
    v_mfma_f32_32x32x16_bf16 v[80:95], v[56:59], a[60:63], v[80:95]
    s_add_u32 m0, s42, 38912
    s_add_u32 s59, s82, 44032
    buffer_load_dwordx4 v2, s[12:15], s59 offen lds
    v_mfma_f32_32x32x16_bf16 v[96:111], v[60:63], a[56:59], v[96:111]
    ds_read_b128 v[44:47], v7 offset:12288
    v_mfma_f32_32x32x16_bf16 v[112:127], v[60:63], a[60:63], v[112:127]
    s_add_u32 m0, s42, 39936
    s_add_u32 s59, s82, 44544
    buffer_load_dwordx4 v3, s[12:15], s59 offen lds
    s_waitcnt lgkmcnt(2)
    v_mfma_f32_32x32x16_bf16 v[64:79], v[32:35], a[64:67], v[64:79]
    ds_read_b128 v[48:51], v8 offset:8192
    v_mfma_f32_32x32x16_bf16 v[80:95], v[32:35], a[68:71], v[80:95]
    v_mfma_f32_32x32x16_bf16 v[96:111], v[36:39], a[64:67], v[96:111]
    ds_read_b128 v[52:55], v8 offset:12288
    v_mfma_f32_32x32x16_bf16 v[112:127], v[36:39], a[68:71], v[112:127]
    s_waitcnt lgkmcnt(2)
    s_mov_b32 s16, s64
    s_and_b32 s17, s65, 0xffff
    s_mov_b32 s18, 2097152
    s_mov_b32 s19, 0x00020000
    s_mov_b32 s20, s80
    s_and_b32 s21, s81, 0xffff
    s_mov_b32 s22, 1024
    s_mov_b32 s23, 0x00020000
    s_mov_b32 s24, s90
    s_and_b32 s25, s91, 0xffff
    s_mov_b32 s26, 4096
    s_mov_b32 s27, 0x00020000
    s_add_u32 s28, s98, 2097152
    s_addc_u32 s29, s99, 0
    s_and_b32 s29, s29, 0xffff
    s_mov_b32 s30, 98304
    s_mov_b32 s31, 0x00020000
    s_mov_b32 s32, s94
    s_and_b32 s33, s95, 0xffff
    s_mov_b32 s34, 4194304
    s_mov_b32 s35, 0x00020000
    v_and_b32 v20, 31, v1
    s_lshl_b32 s43, s52, 1
    s_and_b32 s44, s3, 1
    s_add_u32 s43, s43, s44
    s_lshl_b32 s43, s43, 5
    v_add_u32 v20, s43, v20
    v_lshrrev_b32 v21, 5, v1
    s_lshl_b32 s43, s53, 1
    s_lshr_b32 s44, s3, 1
    s_add_u32 s43, s43, s44
    s_lshl_b32 s43, s43, 5
    v_lshl_add_u32 v21, v21, 2, s43
    v_lshl_add_u32 v22, v20, 9, v21
    v_lshlrev_b32 v23, 1, v22
    buffer_load_dwordx2 v[192:193], v23, s[16:19], 0 offen offset:0
    buffer_load_dwordx2 v[194:195], v23, s[16:19], 0 offen offset:16
    buffer_load_dwordx2 v[196:197], v23, s[16:19], 0 offen offset:32
    buffer_load_dwordx2 v[198:199], v23, s[16:19], 0 offen offset:48
    v_lshlrev_b32 v23, 1, v21
    buffer_load_dwordx2 v[200:201], v23, s[20:23], 0 offen offset:0
    buffer_load_dwordx2 v[202:203], v23, s[20:23], 0 offen offset:16
    buffer_load_dwordx2 v[204:205], v23, s[20:23], 0 offen offset:32
    buffer_load_dwordx2 v[206:207], v23, s[20:23], 0 offen offset:48
    v_lshlrev_b32 v23, 1, v20
    buffer_load_ushort v208, v23, s[24:27], 0 offen
    v_lshrrev_b32 v23, 2, v20
    v_and_b32 v19, 3, v20
    v_lshlrev_b32 v19, 2, v19
    v_lshl_add_u32 v23, v23, 7, v19
    buffer_load_dword v209, v23, s[28:31], 0 offen sc1
    v_lshl_add_u32 v212, v1, 4, s42
    v_mfma_f32_32x32x16_bf16 v[64:79], v[40:43], a[72:75], v[64:79]
    ds_read_b128 v[56:59], v9 offset:8192
    v_mfma_f32_32x32x16_bf16 v[80:95], v[40:43], a[76:79], v[80:95]
    v_mfma_f32_32x32x16_bf16 v[96:111], v[44:47], a[72:75], v[96:111]
    ds_read_b128 v[60:63], v9 offset:12288
    v_mfma_f32_32x32x16_bf16 v[112:127], v[44:47], a[76:79], v[112:127]
    s_waitcnt vmcnt(26)
    s_waitcnt lgkmcnt(2)
    v_mfma_f32_32x32x16_bf16 v[64:79], v[48:51], a[80:83], v[64:79]
    ds_read_b128 v[32:35], v6 offset:16384
    v_mfma_f32_32x32x16_bf16 v[80:95], v[48:51], a[84:87], v[80:95]
    v_mfma_f32_32x32x16_bf16 v[96:111], v[52:55], a[80:83], v[96:111]
    ds_read_b128 v[36:39], v6 offset:20480
    v_mfma_f32_32x32x16_bf16 v[112:127], v[52:55], a[84:87], v[112:127]
    s_waitcnt lgkmcnt(2)
    v_mfma_f32_32x32x16_bf16 v[64:79], v[56:59], a[88:91], v[64:79]
    ds_read_b128 v[40:43], v7 offset:16384
    v_mfma_f32_32x32x16_bf16 v[80:95], v[56:59], a[92:95], v[80:95]
    v_mfma_f32_32x32x16_bf16 v[96:111], v[60:63], a[88:91], v[96:111]
    ds_read_b128 v[44:47], v7 offset:20480
    v_mfma_f32_32x32x16_bf16 v[112:127], v[60:63], a[92:95], v[112:127]
    s_waitcnt lgkmcnt(2)
    s_cmp_eq_u32 s3, 0
    s_cbranch_scc1 L_xw_54
    ds_write_b128 v212, a[192:195] offset:0
    ds_write_b128 v212, a[196:199] offset:1024
    ds_write_b128 v212, a[200:203] offset:2048
    ds_write_b128 v212, a[204:207] offset:3072
L_xw_54:
    v_mfma_f32_32x32x16_bf16 v[64:79], v[32:35], a[96:99], v[64:79]
    ds_read_b128 v[48:51], v8 offset:16384
    v_mfma_f32_32x32x16_bf16 v[80:95], v[32:35], a[100:103], v[80:95]
    v_mfma_f32_32x32x16_bf16 v[96:111], v[36:39], a[96:99], v[96:111]
    ds_read_b128 v[52:55], v8 offset:20480
    v_mfma_f32_32x32x16_bf16 v[112:127], v[36:39], a[100:103], v[112:127]
    s_waitcnt lgkmcnt(2)
    s_cmp_eq_u32 s3, 1
    s_cbranch_scc1 L_xw_55
    ds_write_b128 v212, a[208:211] offset:4096
    ds_write_b128 v212, a[212:215] offset:5120
    ds_write_b128 v212, a[216:219] offset:6144
    ds_write_b128 v212, a[220:223] offset:7168
L_xw_55:
    v_mfma_f32_32x32x16_bf16 v[64:79], v[40:43], a[104:107], v[64:79]
    ds_read_b128 v[56:59], v9 offset:16384
    v_mfma_f32_32x32x16_bf16 v[80:95], v[40:43], a[108:111], v[80:95]
    v_mfma_f32_32x32x16_bf16 v[96:111], v[44:47], a[104:107], v[96:111]
    ds_read_b128 v[60:63], v9 offset:20480
    v_mfma_f32_32x32x16_bf16 v[112:127], v[44:47], a[108:111], v[112:127]
    s_waitcnt vmcnt(18)
    s_waitcnt lgkmcnt(2)
    s_cmp_eq_u32 s3, 2
    s_cbranch_scc1 L_xw_56
    ds_write_b128 v212, a[224:227] offset:8192
    ds_write_b128 v212, a[228:231] offset:9216
    ds_write_b128 v212, a[232:235] offset:10240
    ds_write_b128 v212, a[236:239] offset:11264
L_xw_56:
    v_mfma_f32_32x32x16_bf16 v[64:79], v[48:51], a[112:115], v[64:79]
    ds_read_b128 v[32:35], v6 offset:24576
    v_mfma_f32_32x32x16_bf16 v[80:95], v[48:51], a[116:119], v[80:95]
    v_mfma_f32_32x32x16_bf16 v[96:111], v[52:55], a[112:115], v[96:111]
    ds_read_b128 v[36:39], v6 offset:28672
    v_mfma_f32_32x32x16_bf16 v[112:127], v[52:55], a[116:119], v[112:127]
    s_waitcnt lgkmcnt(2)
    s_cmp_eq_u32 s3, 3
    s_cbranch_scc1 L_xw_57
    ds_write_b128 v212, a[240:243] offset:12288
    ds_write_b128 v212, a[244:247] offset:13312
    ds_write_b128 v212, a[248:251] offset:14336
    ds_write_b128 v212, a[252:255] offset:15360
L_xw_57:
    v_mfma_f32_32x32x16_bf16 v[64:79], v[56:59], a[120:123], v[64:79]
    ds_read_b128 v[40:43], v7 offset:24576
    v_mfma_f32_32x32x16_bf16 v[80:95], v[56:59], a[124:127], v[80:95]
    v_mfma_f32_32x32x16_bf16 v[96:111], v[60:63], a[120:123], v[96:111]
    ds_read_b128 v[44:47], v7 offset:28672
    v_mfma_f32_32x32x16_bf16 v[112:127], v[60:63], a[124:127], v[112:127]
    s_waitcnt lgkmcnt(2)
    s_cmp_ge_u32 s3, 2
    s_cselect_b32 s43, 1, 0
    s_lshl_b32 s43, s43, 1
    s_and_b32 s44, s3, 1
    s_add_u32 s43, s43, s44
    s_lshl_b32 s43, s43, 12
    s_add_u32 s44, s3, 1
    s_and_b32 s44, s44, 3
    s_mul_i32 s44, s44, 40960
    s_add_u32 s44, s44, s43
    v_lshl_add_u32 v213, v1, 4, s44
    s_add_u32 s44, s3, 2
    s_and_b32 s44, s44, 3
    s_mul_i32 s44, s44, 40960
    s_add_u32 s44, s44, s43
    v_lshl_add_u32 v214, v1, 4, s44
    s_add_u32 s44, s3, 3
    s_and_b32 s44, s44, 3
    s_mul_i32 s44, s44, 40960
    s_add_u32 s44, s44, s43
    v_lshl_add_u32 v215, v1, 4, s44
    v_mfma_f32_32x32x16_bf16 v[64:79], v[32:35], a[128:131], v[64:79]
    ds_read_b128 v[48:51], v8 offset:24576
    v_mfma_f32_32x32x16_bf16 v[80:95], v[32:35], a[132:135], v[80:95]
    v_mfma_f32_32x32x16_bf16 v[96:111], v[36:39], a[128:131], v[96:111]
    ds_read_b128 v[52:55], v8 offset:28672
    v_mfma_f32_32x32x16_bf16 v[112:127], v[36:39], a[132:135], v[112:127]
    s_waitcnt lgkmcnt(2)
    s_cmp_eq_u32 s3, 1
    s_cbranch_scc1 L_ow_60
    s_cmp_eq_u32 s3, 2
    s_cbranch_scc1 L_ow_61
    s_cmp_eq_u32 s3, 3
    s_cbranch_scc1 L_ow_62
L_ow_59:
    v_accvgpr_read_b32 v224, a192
    v_accvgpr_read_b32 v225, a193
    v_accvgpr_read_b32 v226, a194
    v_accvgpr_read_b32 v227, a195
    v_accvgpr_read_b32 v228, a196
    v_accvgpr_read_b32 v229, a197
    v_accvgpr_read_b32 v230, a198
    v_accvgpr_read_b32 v231, a199
    v_accvgpr_read_b32 v232, a200
    v_accvgpr_read_b32 v233, a201
    v_accvgpr_read_b32 v234, a202
    v_accvgpr_read_b32 v235, a203
    v_accvgpr_read_b32 v236, a204
    v_accvgpr_read_b32 v237, a205
    v_accvgpr_read_b32 v238, a206
    v_accvgpr_read_b32 v239, a207
    s_branch L_oe_58
L_ow_60:
    v_accvgpr_read_b32 v224, a208
    v_accvgpr_read_b32 v225, a209
    v_accvgpr_read_b32 v226, a210
    v_accvgpr_read_b32 v227, a211
    v_accvgpr_read_b32 v228, a212
    v_accvgpr_read_b32 v229, a213
    v_accvgpr_read_b32 v230, a214
    v_accvgpr_read_b32 v231, a215
    v_accvgpr_read_b32 v232, a216
    v_accvgpr_read_b32 v233, a217
    v_accvgpr_read_b32 v234, a218
    v_accvgpr_read_b32 v235, a219
    v_accvgpr_read_b32 v236, a220
    v_accvgpr_read_b32 v237, a221
    v_accvgpr_read_b32 v238, a222
    v_accvgpr_read_b32 v239, a223
    s_branch L_oe_58
L_ow_61:
    v_accvgpr_read_b32 v224, a224
    v_accvgpr_read_b32 v225, a225
    v_accvgpr_read_b32 v226, a226
    v_accvgpr_read_b32 v227, a227
    v_accvgpr_read_b32 v228, a228
    v_accvgpr_read_b32 v229, a229
    v_accvgpr_read_b32 v230, a230
    v_accvgpr_read_b32 v231, a231
    v_accvgpr_read_b32 v232, a232
    v_accvgpr_read_b32 v233, a233
    v_accvgpr_read_b32 v234, a234
    v_accvgpr_read_b32 v235, a235
    v_accvgpr_read_b32 v236, a236
    v_accvgpr_read_b32 v237, a237
    v_accvgpr_read_b32 v238, a238
    v_accvgpr_read_b32 v239, a239
    s_branch L_oe_58
L_ow_62:
    v_accvgpr_read_b32 v224, a240
    v_accvgpr_read_b32 v225, a241
    v_accvgpr_read_b32 v226, a242
    v_accvgpr_read_b32 v227, a243
    v_accvgpr_read_b32 v228, a244
    v_accvgpr_read_b32 v229, a245
    v_accvgpr_read_b32 v230, a246
    v_accvgpr_read_b32 v231, a247
    v_accvgpr_read_b32 v232, a248
    v_accvgpr_read_b32 v233, a249
    v_accvgpr_read_b32 v234, a250
    v_accvgpr_read_b32 v235, a251
    v_accvgpr_read_b32 v236, a252
    v_accvgpr_read_b32 v237, a253
    v_accvgpr_read_b32 v238, a254
    v_accvgpr_read_b32 v239, a255
L_oe_58:
    v_mfma_f32_32x32x16_bf16 v[64:79], v[40:43], a[136:139], v[64:79]
    ds_read_b128 v[56:59], v9 offset:24576
    v_mfma_f32_32x32x16_bf16 v[80:95], v[40:43], a[140:143], v[80:95]
    v_mfma_f32_32x32x16_bf16 v[96:111], v[44:47], a[136:139], v[96:111]
    ds_read_b128 v[60:63], v9 offset:28672
    v_mfma_f32_32x32x16_bf16 v[112:127], v[44:47], a[140:143], v[112:127]
    s_waitcnt vmcnt(10)
    s_waitcnt lgkmcnt(2)
    v_mfma_f32_32x32x16_bf16 v[64:79], v[48:51], a[144:147], v[64:79]
    ds_read_b128 v[32:35], v6 offset:32768
    v_mfma_f32_32x32x16_bf16 v[80:95], v[48:51], a[148:151], v[80:95]
    v_mfma_f32_32x32x16_bf16 v[96:111], v[52:55], a[144:147], v[96:111]
    ds_read_b128 v[36:39], v6 offset:36864
    v_mfma_f32_32x32x16_bf16 v[112:127], v[52:55], a[148:151], v[112:127]
    s_waitcnt lgkmcnt(2)
    v_mfma_f32_32x32x16_bf16 v[64:79], v[56:59], a[152:155], v[64:79]
    ds_read_b128 v[40:43], v7 offset:32768
    v_mfma_f32_32x32x16_bf16 v[80:95], v[56:59], a[156:159], v[80:95]
    v_mfma_f32_32x32x16_bf16 v[96:111], v[60:63], a[152:155], v[96:111]
    ds_read_b128 v[44:47], v7 offset:36864
    v_mfma_f32_32x32x16_bf16 v[112:127], v[60:63], a[156:159], v[112:127]
    s_cmp_ge_u32 s3, 2
    s_cbranch_scc1 L_sk_63
    s_waitcnt lgkmcnt(2)
    v_mfma_f32_32x32x16_bf16 v[64:79], v[32:35], a[160:163], v[64:79]
    ds_read_b128 v[48:51], v8 offset:32768
    v_mfma_f32_32x32x16_bf16 v[80:95], v[32:35], a[164:167], v[80:95]
    v_mfma_f32_32x32x16_bf16 v[96:111], v[36:39], a[160:163], v[96:111]
    ds_read_b128 v[52:55], v8 offset:36864
    v_mfma_f32_32x32x16_bf16 v[112:127], v[36:39], a[164:167], v[112:127]
    s_waitcnt lgkmcnt(2)
    v_mfma_f32_32x32x16_bf16 v[64:79], v[40:43], a[168:171], v[64:79]
    ds_read_b128 v[56:59], v9 offset:32768
    v_mfma_f32_32x32x16_bf16 v[80:95], v[40:43], a[172:175], v[80:95]
    v_mfma_f32_32x32x16_bf16 v[96:111], v[44:47], a[168:171], v[96:111]
    ds_read_b128 v[60:63], v9 offset:36864
    v_mfma_f32_32x32x16_bf16 v[112:127], v[44:47], a[172:175], v[112:127]
    s_waitcnt lgkmcnt(2)
    v_mfma_f32_32x32x16_bf16 v[64:79], v[48:51], a[176:179], v[64:79]
    v_mfma_f32_32x32x16_bf16 v[80:95], v[48:51], a[180:183], v[80:95]
    v_mfma_f32_32x32x16_bf16 v[96:111], v[52:55], a[176:179], v[96:111]
    v_mfma_f32_32x32x16_bf16 v[112:127], v[52:55], a[180:183], v[112:127]
    s_waitcnt lgkmcnt(0)
    v_mfma_f32_32x32x16_bf16 v[64:79], v[56:59], a[184:187], v[64:79]
    v_mfma_f32_32x32x16_bf16 v[80:95], v[56:59], a[188:191], v[80:95]
    v_mfma_f32_32x32x16_bf16 v[96:111], v[60:63], a[184:187], v[96:111]
    v_mfma_f32_32x32x16_bf16 v[112:127], v[60:63], a[188:191], v[112:127]
L_sk_63:
    s_waitcnt lgkmcnt(0)
    s_nop 7
    s_nop 7
    s_cmp_eq_u32 s3, 0
    s_cbranch_scc1 L_xw_64
    ds_write_b128 v212, v[64:67] offset:16384
    ds_write_b128 v212, v[68:71] offset:17408
    ds_write_b128 v212, v[72:75] offset:18432
    ds_write_b128 v212, v[76:79] offset:19456
L_xw_64:
    s_cmp_eq_u32 s3, 1
    s_cbranch_scc1 L_xw_65
    ds_write_b128 v212, v[80:83] offset:20480
    ds_write_b128 v212, v[84:87] offset:21504
    ds_write_b128 v212, v[88:91] offset:22528
    ds_write_b128 v212, v[92:95] offset:23552
L_xw_65:
    s_cmp_eq_u32 s3, 2
    s_cbranch_scc1 L_xw_66
    ds_write_b128 v212, v[96:99] offset:24576
    ds_write_b128 v212, v[100:103] offset:25600
    ds_write_b128 v212, v[104:107] offset:26624
    ds_write_b128 v212, v[108:111] offset:27648
L_xw_66:
    s_cmp_eq_u32 s3, 3
    s_cbranch_scc1 L_xw_67
    ds_write_b128 v212, v[112:115] offset:28672
    ds_write_b128 v212, v[116:119] offset:29696
    ds_write_b128 v212, v[120:123] offset:30720
    ds_write_b128 v212, v[124:127] offset:31744
L_xw_67:
    s_cmp_ge_u32 s3, 2
    s_cselect_b32 s43, 3, 2
    s_lshl_b32 s43, s43, 1
    s_and_b32 s44, s3, 1
    s_add_u32 s43, s43, s44
    s_lshl_b32 s43, s43, 12
    s_add_u32 s44, s3, 1
    s_and_b32 s44, s44, 3
    s_mul_i32 s44, s44, 40960
    s_add_u32 s44, s44, s43
    v_lshl_add_u32 v216, v1, 4, s44
    s_add_u32 s44, s3, 2
    s_and_b32 s44, s44, 3
    s_mul_i32 s44, s44, 40960
    s_add_u32 s44, s44, s43
    v_lshl_add_u32 v217, v1, 4, s44
    s_add_u32 s44, s3, 3
    s_and_b32 s44, s44, 3
    s_mul_i32 s44, s44, 40960
    s_add_u32 s44, s44, s43
    v_lshl_add_u32 v218, v1, 4, s44
    s_cmp_eq_u32 s3, 1
    s_cbranch_scc1 L_ow_70
    s_cmp_eq_u32 s3, 2
    s_cbranch_scc1 L_ow_71
    s_cmp_eq_u32 s3, 3
    s_cbranch_scc1 L_ow_72
L_ow_69:
    v_mov_b32 v240, v64
    v_mov_b32 v241, v65
    v_mov_b32 v242, v66
    v_mov_b32 v243, v67
    v_mov_b32 v244, v68
    v_mov_b32 v245, v69
    v_mov_b32 v246, v70
    v_mov_b32 v247, v71
    v_mov_b32 v248, v72
    v_mov_b32 v249, v73
    v_mov_b32 v250, v74
    v_mov_b32 v251, v75
    v_mov_b32 v252, v76
    v_mov_b32 v253, v77
    v_mov_b32 v254, v78
    v_mov_b32 v255, v79
    s_branch L_oe_68
L_ow_70:
    v_mov_b32 v240, v80
    v_mov_b32 v241, v81
    v_mov_b32 v242, v82
    v_mov_b32 v243, v83
    v_mov_b32 v244, v84
    v_mov_b32 v245, v85
    v_mov_b32 v246, v86
    v_mov_b32 v247, v87
    v_mov_b32 v248, v88
    v_mov_b32 v249, v89
    v_mov_b32 v250, v90
    v_mov_b32 v251, v91
    v_mov_b32 v252, v92
    v_mov_b32 v253, v93
    v_mov_b32 v254, v94
    v_mov_b32 v255, v95
    s_branch L_oe_68
L_ow_71:
    v_mov_b32 v240, v96
    v_mov_b32 v241, v97
    v_mov_b32 v242, v98
    v_mov_b32 v243, v99
    v_mov_b32 v244, v100
    v_mov_b32 v245, v101
    v_mov_b32 v246, v102
    v_mov_b32 v247, v103
    v_mov_b32 v248, v104
    v_mov_b32 v249, v105
    v_mov_b32 v250, v106
    v_mov_b32 v251, v107
    v_mov_b32 v252, v108
    v_mov_b32 v253, v109
    v_mov_b32 v254, v110
    v_mov_b32 v255, v111
    s_branch L_oe_68
L_ow_72:
    v_mov_b32 v240, v112
    v_mov_b32 v241, v113
    v_mov_b32 v242, v114
    v_mov_b32 v243, v115
    v_mov_b32 v244, v116
    v_mov_b32 v245, v117
    v_mov_b32 v246, v118
    v_mov_b32 v247, v119
    v_mov_b32 v248, v120
    v_mov_b32 v249, v121
    v_mov_b32 v250, v122
    v_mov_b32 v251, v123
    v_mov_b32 v252, v124
    v_mov_b32 v253, v125
    v_mov_b32 v254, v126
    v_mov_b32 v255, v127
L_oe_68:
    s_waitcnt lgkmcnt(0)
    s_barrier
    ds_read_b128 v[128:131], v213 offset:0
    ds_read_b128 v[132:135], v213 offset:1024
    ds_read_b128 v[136:139], v213 offset:2048
    ds_read_b128 v[140:143], v213 offset:3072
    ds_read_b128 v[144:147], v214 offset:0
    ds_read_b128 v[148:151], v214 offset:1024
    ds_read_b128 v[152:155], v214 offset:2048
    ds_read_b128 v[156:159], v214 offset:3072
    ds_read_b128 v[160:163], v215 offset:0
    ds_read_b128 v[164:167], v215 offset:1024
    ds_read_b128 v[168:171], v215 offset:2048
    ds_read_b128 v[172:175], v215 offset:3072
    ds_read_b128 v[64:67], v216 offset:0
    ds_read_b128 v[68:71], v216 offset:1024
    ds_read_b128 v[72:75], v216 offset:2048
    ds_read_b128 v[76:79], v216 offset:3072
    ds_read_b128 v[80:83], v217 offset:0
    ds_read_b128 v[84:87], v217 offset:1024
    ds_read_b128 v[88:91], v217 offset:2048
    ds_read_b128 v[92:95], v217 offset:3072
    ds_read_b128 v[96:99], v218 offset:0
    ds_read_b128 v[100:103], v218 offset:1024
    ds_read_b128 v[104:107], v218 offset:2048
    ds_read_b128 v[108:111], v218 offset:3072
    s_waitcnt lgkmcnt(12)
    v_add_f32 v224, v224, v128
    v_add_f32 v144, v144, v160
    v_add_f32 v225, v225, v129
    v_add_f32 v145, v145, v161
    v_add_f32 v226, v226, v130
    v_add_f32 v146, v146, v162
    v_add_f32 v227, v227, v131
    v_add_f32 v147, v147, v163
    v_add_f32 v228, v228, v132
    v_add_f32 v148, v148, v164
    v_add_f32 v229, v229, v133
    v_add_f32 v149, v149, v165
    v_add_f32 v230, v230, v134
    v_add_f32 v150, v150, v166
    v_add_f32 v231, v231, v135
    v_add_f32 v151, v151, v167
    v_add_f32 v232, v232, v136
    v_add_f32 v152, v152, v168
    v_add_f32 v233, v233, v137
    v_add_f32 v153, v153, v169
    v_add_f32 v234, v234, v138
    v_add_f32 v154, v154, v170
    v_add_f32 v235, v235, v139
    v_add_f32 v155, v155, v171
    v_add_f32 v236, v236, v140
    v_add_f32 v156, v156, v172
    v_add_f32 v237, v237, v141
    v_add_f32 v157, v157, v173
    v_add_f32 v238, v238, v142
    v_add_f32 v158, v158, v174
    v_add_f32 v239, v239, v143
    v_add_f32 v159, v159, v175
    v_add_f32 v224, v224, v144
    v_add_f32 v225, v225, v145
    v_add_f32 v226, v226, v146
    v_add_f32 v227, v227, v147
    v_add_f32 v228, v228, v148
    v_add_f32 v229, v229, v149
    v_add_f32 v230, v230, v150
    v_add_f32 v231, v231, v151
    v_add_f32 v232, v232, v152
    v_add_f32 v233, v233, v153
    v_add_f32 v234, v234, v154
    v_add_f32 v235, v235, v155
    v_add_f32 v236, v236, v156
    v_add_f32 v237, v237, v157
    v_add_f32 v238, v238, v158
    v_add_f32 v239, v239, v159
    s_waitcnt lgkmcnt(0)
    v_add_f32 v240, v240, v64
    v_add_f32 v80, v80, v96
    v_add_f32 v241, v241, v65
    v_add_f32 v81, v81, v97
    v_add_f32 v242, v242, v66
    v_add_f32 v82, v82, v98
    v_add_f32 v243, v243, v67
    v_add_f32 v83, v83, v99
    v_add_f32 v244, v244, v68
    v_add_f32 v84, v84, v100
    v_add_f32 v245, v245, v69
    v_add_f32 v85, v85, v101
    v_add_f32 v246, v246, v70
    v_add_f32 v86, v86, v102
    v_add_f32 v247, v247, v71
    v_add_f32 v87, v87, v103
    v_add_f32 v248, v248, v72
    v_add_f32 v88, v88, v104
    v_add_f32 v249, v249, v73
    v_add_f32 v89, v89, v105
    v_add_f32 v250, v250, v74
    v_add_f32 v90, v90, v106
    v_add_f32 v251, v251, v75
    v_add_f32 v91, v91, v107
    v_add_f32 v252, v252, v76
    v_add_f32 v92, v92, v108
    v_add_f32 v253, v253, v77
    v_add_f32 v93, v93, v109
    v_add_f32 v254, v254, v78
    v_add_f32 v94, v94, v110
    v_add_f32 v255, v255, v79
    v_add_f32 v95, v95, v111
    v_add_f32 v240, v240, v80
    v_add_f32 v241, v241, v81
    v_add_f32 v242, v242, v82
    v_add_f32 v243, v243, v83
    v_add_f32 v244, v244, v84
    v_add_f32 v245, v245, v85
    v_add_f32 v246, v246, v86
    v_add_f32 v247, v247, v87
    v_add_f32 v248, v248, v88
    v_add_f32 v249, v249, v89
    v_add_f32 v250, v250, v90
    v_add_f32 v251, v251, v91
    v_add_f32 v252, v252, v92
    v_add_f32 v253, v253, v93
    v_add_f32 v254, v254, v94
    v_add_f32 v255, v255, v95
    s_waitcnt vmcnt(0)
    v_lshlrev_b32 v208, 16, v208
    v_sub_f32 v210, 1.0, v209
    v_cvt_pk_bf16_f32 v210, v210, v210
    v_lshlrev_b32 v210, 16, v210
    v_lshlrev_b32 v23, 2, v22
    v_cvt_pk_bf16_f32 v32, v240, v241
    v_lshlrev_b32 v33, 16, v32
    v_and_b32 v32, 0xffff0000, v32
    v_add_f32 v33, v33, v208
    v_add_f32 v32, v32, v208
    v_cvt_pk_bf16_f32 v32, v33, v32
    v_lshlrev_b32 v33, 16, v32
    v_and_b32 v32, 0xffff0000, v32
    v_mul_f32 v33, v33, v210
    v_mul_f32 v32, v32, v210
    v_cvt_pk_bf16_f32 v32, v33, v32
    v_lshlrev_b32 v240, 16, v32
    v_and_b32 v241, 0xffff0000, v32
    v_lshlrev_b32 v33, 16, v192
    v_and_b32 v32, 0xffff0000, v192
    v_lshlrev_b32 v34, 16, v200
    v_and_b32 v35, 0xffff0000, v200
    v_mul_f32 v33, v33, v34
    v_mul_f32 v32, v32, v35
    v_cvt_pk_bf16_f32 v32, v33, v32
    v_lshlrev_b32 v33, 16, v32
    v_and_b32 v32, 0xffff0000, v32
    v_fma_f32 v33, 2.0, v224, v33
    v_fma_f32 v32, 2.0, v225, v32
    v_mul_f32 v33, v33, v209
    v_mul_f32 v32, v32, v209
    v_add_f32 v240, v240, v33
    v_add_f32 v241, v241, v32
    v_cvt_pk_bf16_f32 v32, v242, v243
    v_lshlrev_b32 v33, 16, v32
    v_and_b32 v32, 0xffff0000, v32
    v_add_f32 v33, v33, v208
    v_add_f32 v32, v32, v208
    v_cvt_pk_bf16_f32 v32, v33, v32
    v_lshlrev_b32 v33, 16, v32
    v_and_b32 v32, 0xffff0000, v32
    v_mul_f32 v33, v33, v210
    v_mul_f32 v32, v32, v210
    v_cvt_pk_bf16_f32 v32, v33, v32
    v_lshlrev_b32 v242, 16, v32
    v_and_b32 v243, 0xffff0000, v32
    v_lshlrev_b32 v33, 16, v193
    v_and_b32 v32, 0xffff0000, v193
    v_lshlrev_b32 v34, 16, v201
    v_and_b32 v35, 0xffff0000, v201
    v_mul_f32 v33, v33, v34
    v_mul_f32 v32, v32, v35
    v_cvt_pk_bf16_f32 v32, v33, v32
    v_lshlrev_b32 v33, 16, v32
    v_and_b32 v32, 0xffff0000, v32
    v_fma_f32 v33, 2.0, v226, v33
    v_fma_f32 v32, 2.0, v227, v32
    v_mul_f32 v33, v33, v209
    v_mul_f32 v32, v32, v209
    v_add_f32 v242, v242, v33
    v_add_f32 v243, v243, v32
    buffer_store_dwordx4 v[240:243], v23, s[32:35], 0 offen offset:0
    v_cvt_pk_bf16_f32 v32, v244, v245
    v_lshlrev_b32 v33, 16, v32
    v_and_b32 v32, 0xffff0000, v32
    v_add_f32 v33, v33, v208
    v_add_f32 v32, v32, v208
    v_cvt_pk_bf16_f32 v32, v33, v32
    v_lshlrev_b32 v33, 16, v32
    v_and_b32 v32, 0xffff0000, v32
    v_mul_f32 v33, v33, v210
    v_mul_f32 v32, v32, v210
    v_cvt_pk_bf16_f32 v32, v33, v32
    v_lshlrev_b32 v244, 16, v32
    v_and_b32 v245, 0xffff0000, v32
    v_lshlrev_b32 v33, 16, v194
    v_and_b32 v32, 0xffff0000, v194
    v_lshlrev_b32 v34, 16, v202
    v_and_b32 v35, 0xffff0000, v202
    v_mul_f32 v33, v33, v34
    v_mul_f32 v32, v32, v35
    v_cvt_pk_bf16_f32 v32, v33, v32
    v_lshlrev_b32 v33, 16, v32
    v_and_b32 v32, 0xffff0000, v32
    v_fma_f32 v33, 2.0, v228, v33
    v_fma_f32 v32, 2.0, v229, v32
    v_mul_f32 v33, v33, v209
    v_mul_f32 v32, v32, v209
    v_add_f32 v244, v244, v33
    v_add_f32 v245, v245, v32
    v_cvt_pk_bf16_f32 v32, v246, v247
    v_lshlrev_b32 v33, 16, v32
    v_and_b32 v32, 0xffff0000, v32
    v_add_f32 v33, v33, v208
    v_add_f32 v32, v32, v208
    v_cvt_pk_bf16_f32 v32, v33, v32
    v_lshlrev_b32 v33, 16, v32
    v_and_b32 v32, 0xffff0000, v32
    v_mul_f32 v33, v33, v210
    v_mul_f32 v32, v32, v210
    v_cvt_pk_bf16_f32 v32, v33, v32
    v_lshlrev_b32 v246, 16, v32
    v_and_b32 v247, 0xffff0000, v32
    v_lshlrev_b32 v33, 16, v195
    v_and_b32 v32, 0xffff0000, v195
    v_lshlrev_b32 v34, 16, v203
    v_and_b32 v35, 0xffff0000, v203
    v_mul_f32 v33, v33, v34
    v_mul_f32 v32, v32, v35
    v_cvt_pk_bf16_f32 v32, v33, v32
    v_lshlrev_b32 v33, 16, v32
    v_and_b32 v32, 0xffff0000, v32
    v_fma_f32 v33, 2.0, v230, v33
    v_fma_f32 v32, 2.0, v231, v32
    v_mul_f32 v33, v33, v209
    v_mul_f32 v32, v32, v209
    v_add_f32 v246, v246, v33
    v_add_f32 v247, v247, v32
    buffer_store_dwordx4 v[244:247], v23, s[32:35], 0 offen offset:32
    v_cvt_pk_bf16_f32 v32, v248, v249
    v_lshlrev_b32 v33, 16, v32
    v_and_b32 v32, 0xffff0000, v32
    v_add_f32 v33, v33, v208
    v_add_f32 v32, v32, v208
    v_cvt_pk_bf16_f32 v32, v33, v32
    v_lshlrev_b32 v33, 16, v32
    v_and_b32 v32, 0xffff0000, v32
    v_mul_f32 v33, v33, v210
    v_mul_f32 v32, v32, v210
    v_cvt_pk_bf16_f32 v32, v33, v32
    v_lshlrev_b32 v248, 16, v32
    v_and_b32 v249, 0xffff0000, v32
    v_lshlrev_b32 v33, 16, v196
    v_and_b32 v32, 0xffff0000, v196
    v_lshlrev_b32 v34, 16, v204
    v_and_b32 v35, 0xffff0000, v204
    v_mul_f32 v33, v33, v34
    v_mul_f32 v32, v32, v35
    v_cvt_pk_bf16_f32 v32, v33, v32
    v_lshlrev_b32 v33, 16, v32
    v_and_b32 v32, 0xffff0000, v32
    v_fma_f32 v33, 2.0, v232, v33
    v_fma_f32 v32, 2.0, v233, v32
    v_mul_f32 v33, v33, v209
    v_mul_f32 v32, v32, v209
    v_add_f32 v248, v248, v33
    v_add_f32 v249, v249, v32
    v_cvt_pk_bf16_f32 v32, v250, v251
    v_lshlrev_b32 v33, 16, v32
    v_and_b32 v32, 0xffff0000, v32
    v_add_f32 v33, v33, v208
    v_add_f32 v32, v32, v208
    v_cvt_pk_bf16_f32 v32, v33, v32
    v_lshlrev_b32 v33, 16, v32
    v_and_b32 v32, 0xffff0000, v32
    v_mul_f32 v33, v33, v210
    v_mul_f32 v32, v32, v210
    v_cvt_pk_bf16_f32 v32, v33, v32
    v_lshlrev_b32 v250, 16, v32
    v_and_b32 v251, 0xffff0000, v32
    v_lshlrev_b32 v33, 16, v197
    v_and_b32 v32, 0xffff0000, v197
    v_lshlrev_b32 v34, 16, v205
    v_and_b32 v35, 0xffff0000, v205
    v_mul_f32 v33, v33, v34
    v_mul_f32 v32, v32, v35
    v_cvt_pk_bf16_f32 v32, v33, v32
    v_lshlrev_b32 v33, 16, v32
    v_and_b32 v32, 0xffff0000, v32
    v_fma_f32 v33, 2.0, v234, v33
    v_fma_f32 v32, 2.0, v235, v32
    v_mul_f32 v33, v33, v209
    v_mul_f32 v32, v32, v209
    v_add_f32 v250, v250, v33
    v_add_f32 v251, v251, v32
    buffer_store_dwordx4 v[248:251], v23, s[32:35], 0 offen offset:64
    v_cvt_pk_bf16_f32 v32, v252, v253
    v_lshlrev_b32 v33, 16, v32
    v_and_b32 v32, 0xffff0000, v32
    v_add_f32 v33, v33, v208
    v_add_f32 v32, v32, v208
    v_cvt_pk_bf16_f32 v32, v33, v32
    v_lshlrev_b32 v33, 16, v32
    v_and_b32 v32, 0xffff0000, v32
    v_mul_f32 v33, v33, v210
    v_mul_f32 v32, v32, v210
    v_cvt_pk_bf16_f32 v32, v33, v32
    v_lshlrev_b32 v252, 16, v32
    v_and_b32 v253, 0xffff0000, v32
    v_lshlrev_b32 v33, 16, v198
    v_and_b32 v32, 0xffff0000, v198
    v_lshlrev_b32 v34, 16, v206
    v_and_b32 v35, 0xffff0000, v206
    v_mul_f32 v33, v33, v34
    v_mul_f32 v32, v32, v35
    v_cvt_pk_bf16_f32 v32, v33, v32
    v_lshlrev_b32 v33, 16, v32
    v_and_b32 v32, 0xffff0000, v32
    v_fma_f32 v33, 2.0, v236, v33
    v_fma_f32 v32, 2.0, v237, v32
    v_mul_f32 v33, v33, v209
    v_mul_f32 v32, v32, v209
    v_add_f32 v252, v252, v33
    v_add_f32 v253, v253, v32
    v_cvt_pk_bf16_f32 v32, v254, v255
    v_lshlrev_b32 v33, 16, v32
    v_and_b32 v32, 0xffff0000, v32
    v_add_f32 v33, v33, v208
    v_add_f32 v32, v32, v208
    v_cvt_pk_bf16_f32 v32, v33, v32
    v_lshlrev_b32 v33, 16, v32
    v_and_b32 v32, 0xffff0000, v32
    v_mul_f32 v33, v33, v210
    v_mul_f32 v32, v32, v210
    v_cvt_pk_bf16_f32 v32, v33, v32
    v_lshlrev_b32 v254, 16, v32
    v_and_b32 v255, 0xffff0000, v32
    v_lshlrev_b32 v33, 16, v199
    v_and_b32 v32, 0xffff0000, v199
    v_lshlrev_b32 v34, 16, v207
    v_and_b32 v35, 0xffff0000, v207
    v_mul_f32 v33, v33, v34
    v_mul_f32 v32, v32, v35
    v_cvt_pk_bf16_f32 v32, v33, v32
    v_lshlrev_b32 v33, 16, v32
    v_and_b32 v32, 0xffff0000, v32
    v_fma_f32 v33, 2.0, v238, v33
    v_fma_f32 v32, 2.0, v239, v32
    v_mul_f32 v33, v33, v209
    v_mul_f32 v32, v32, v209
    v_add_f32 v254, v254, v33
    v_add_f32 v255, v255, v32
    buffer_store_dwordx4 v[252:255], v23, s[32:35], 0 offen offset:96
    s_endpgm
L_apath:
    s_mov_b32 s8, s64
    s_and_b32 s9, s65, 0xffff
    s_mov_b32 s10, 2097152
    s_mov_b32 s11, 0x00020000
    s_mov_b32 s12, s70
    s_and_b32 s13, s71, 0xffff
    s_mov_b32 s14, 524288
    s_mov_b32 s15, 0x00020000
    s_mov_b32 s16, s72
    s_and_b32 s17, s73, 0xffff
    s_mov_b32 s18, 524288
    s_mov_b32 s19, 0x00020000
    s_lshr_b32 s55, s40, 1
    s_lshl_b32 s55, s55, 2
    s_and_b32 s43, s41, 3
    s_add_u32 s55, s55, s43
    s_and_b32 s56, s40, 1
    s_lshl_b32 s56, s56, 1
    s_lshr_b32 s43, s41, 2
    s_and_b32 s43, s43, 1
    s_add_u32 s56, s56, s43
    s_lshl_b32 s54, s55, 2
    s_add_u32 s54, s54, s56
    s_lshl_b32 s54, s54, 2
    s_add_u32 s54, s54, s3
    s_lshl_b32 s43, s3, 15
    s_lshl_b32 s57, s55, 17
    s_add_u32 s57, s57, s43
    s_lshl_b32 s58, s56, 17
    s_add_u32 s58, s58, s43
    s_lshl_b32 s61, s3, 12
    s_mul_i32 s62, s3, 24576
    s_add_u32 s62, s62, 49152
    v_lshrrev_b32 v14, 3, v1
    v_mul_u32_u24 v14, 1024, v14
    v_and_b32 v15, 7, v1
    v_lshrrev_b32 v16, 4, v1
    v_xor_b32 v15, v15, v16
    v_lshlrev_b32 v15, 4, v15
    v_add_u32 v2, v14, v15
    v_xor_b32 v15, 64, v15
    v_add_u32 v3, v14, v15
    s_add_u32 m0, s61, 0
    s_add_u32 s59, s57, 0
    buffer_load_dwordx4 v2, s[8:11], s59 offen lds
    s_add_u32 m0, s61, 1024
    s_add_u32 s59, s57, 8192
    buffer_load_dwordx4 v3, s[8:11], s59 offen lds
    s_add_u32 m0, s61, 2048
    s_add_u32 s59, s57, 16384
    buffer_load_dwordx4 v2, s[8:11], s59 offen lds
    s_add_u32 m0, s61, 3072
    s_add_u32 s59, s57, 24576
    buffer_load_dwordx4 v3, s[8:11], s59 offen lds
    s_add_u32 m0, s62, 0
    s_add_u32 s59, s58, 0
    buffer_load_dwordx4 v2, s[12:15], s59 offen lds
    s_add_u32 m0, s62, 1024
    s_add_u32 s59, s58, 8192
    buffer_load_dwordx4 v3, s[12:15], s59 offen lds
    s_add_u32 m0, s62, 2048
    s_add_u32 s59, s58, 16384
    buffer_load_dwordx4 v2, s[12:15], s59 offen lds
    s_add_u32 m0, s62, 3072
    s_add_u32 s59, s58, 24576
    buffer_load_dwordx4 v3, s[12:15], s59 offen lds
    s_add_u32 m0, s62, 4096
    s_add_u32 s59, s58, 0
    buffer_load_dwordx4 v2, s[16:19], s59 offen lds
    s_add_u32 m0, s62, 5120
    s_add_u32 s59, s58, 8192
    buffer_load_dwordx4 v3, s[16:19], s59 offen lds
    s_add_u32 m0, s62, 6144
    s_add_u32 s59, s58, 16384
    buffer_load_dwordx4 v2, s[16:19], s59 offen lds
    s_add_u32 m0, s62, 7168
    s_add_u32 s59, s58, 24576
    buffer_load_dwordx4 v3, s[16:19], s59 offen lds
    s_mov_b32 s20, s66
    s_and_b32 s21, s67, 0xffff
    s_mov_b32 s22, 1024
    s_mov_b32 s23, 0x00020000
    s_mov_b32 s24, s68
    s_and_b32 s25, s69, 0xffff
    s_mov_b32 s26, 1024
    s_mov_b32 s27, 0x00020000
    s_mov_b32 s28, s78
    s_and_b32 s29, s79, 0xffff
    s_mov_b32 s30, 1024
    s_mov_b32 s31, 0x00020000
    v_and_b32 v30, 31, v1
    s_lshl_b32 s43, s56, 7
    s_lshl_b32 s44, s3, 5
    s_add_u32 s43, s43, s44
    v_add_u32 v30, s43, v30
    v_lshlrev_b32 v29, 1, v30
    buffer_load_ushort v26, v29, s[20:23], 0 offen
    buffer_load_ushort v27, v29, s[24:27], 0 offen
    buffer_load_ushort v28, v29, s[28:31], 0 offen
    v_and_b32 v14, 31, v1
    v_lshrrev_b32 v15, 2, v14
    v_and_b32 v15, 1, v15
    v_lshlrev_b32 v15, 5, v15
    v_lshrrev_b32 v16, 3, v14
    v_lshl_add_u32 v15, v16, 2, v15
    v_and_b32 v14, 3, v14
    v_add_u32 v14, v14, v15
    v_lshrrev_b32 v15, 1, v14
    v_and_b32 v15, 7, v15
    v_lshrrev_b32 v16, 5, v1
    v_xor_b32 v15, v15, v16
    v_lshlrev_b32 v15, 4, v15
    v_lshl_add_u32 v14, v14, 7, v15
    v_mov_b32 v6, v14
    v_xor_b32 v7, 32, v6
    v_xor_b32 v8, 64, v6
    v_xor_b32 v9, 96, v6
    v_and_b32 v14, 31, v1
    v_lshrrev_b32 v15, 1, v14
    v_and_b32 v15, 7, v15
    v_lshrrev_b32 v16, 5, v1
    v_xor_b32 v15, v15, v16
    v_lshlrev_b32 v15, 4, v15
    v_lshl_add_u32 v14, v14, 7, v15
    v_add_u32 v10, s62, v14
    v_xor_b32 v11, 32, v10
    v_xor_b32 v12, 64, v10
    v_xor_b32 v13, 96, v10
    s_add_u32 m0, s61, 16384
    s_add_u32 s59, s57, 128
    buffer_load_dwordx4 v2, s[8:11], s59 offen lds
    s_add_u32 m0, s61, 17408
    s_add_u32 s59, s57, 8320
    buffer_load_dwordx4 v3, s[8:11], s59 offen lds
    s_add_u32 m0, s61, 18432
    s_add_u32 s59, s57, 16512
    buffer_load_dwordx4 v2, s[8:11], s59 offen lds
    s_add_u32 m0, s61, 19456
    s_add_u32 s59, s57, 24704
    buffer_load_dwordx4 v3, s[8:11], s59 offen lds
    s_add_u32 m0, s62, 8192
    s_add_u32 s59, s58, 128
    buffer_load_dwordx4 v2, s[12:15], s59 offen lds
    s_add_u32 m0, s62, 9216
    s_add_u32 s59, s58, 8320
    buffer_load_dwordx4 v3, s[12:15], s59 offen lds
    s_add_u32 m0, s62, 10240
    s_add_u32 s59, s58, 16512
    buffer_load_dwordx4 v2, s[12:15], s59 offen lds
    s_add_u32 m0, s62, 11264
    s_add_u32 s59, s58, 24704
    buffer_load_dwordx4 v3, s[12:15], s59 offen lds
    s_add_u32 m0, s62, 12288
    s_add_u32 s59, s58, 128
    buffer_load_dwordx4 v2, s[16:19], s59 offen lds
    s_add_u32 m0, s62, 13312
    s_add_u32 s59, s58, 8320
    buffer_load_dwordx4 v3, s[16:19], s59 offen lds
    s_add_u32 m0, s62, 14336
    s_add_u32 s59, s58, 16512
    buffer_load_dwordx4 v2, s[16:19], s59 offen lds
    s_add_u32 m0, s62, 15360
    s_add_u32 s59, s58, 24704
    buffer_load_dwordx4 v3, s[16:19], s59 offen lds
    s_waitcnt vmcnt(12)
    v_lshlrev_b32 v26, 16, v26
    v_lshlrev_b32 v27, 16, v27
    v_lshlrev_b32 v28, 16, v28
    v_mul_f32 v28, 0x3fb8aa3b, v28
    v_exp_f32 v28, v28
    s_nop 0
    v_cvt_pk_bf16_f32 v28, v28, v28
    v_lshlrev_b32 v28, 16, v28
    v_mul_f32 v32, v28, v26
    v_mul_f32 v33, v28, v27
    v_mul_f32 v32, 0x3fb8aa3b, v32
    v_exp_f32 v32, v32
    v_mul_f32 v33, 0.15915494, v33
    v_fract_f32 v33, v33
    v_cos_f32 v34, v33
    v_sin_f32 v35, v33
    s_nop 0
    v_mul_f32 v20, v32, v34
    v_mul_f32 v21, v32, v35
    v_add_f32 v32, -1.0, v20
    v_mul_f32 v33, v26, v26
    v_fma_f32 v33, v27, v27, v33
    v_rcp_f32 v33, v33
    v_mul_f32 v34, v32, v26
    v_fma_f32 v34, v21, v27, v34
    v_mul_f32 v35, v21, v26
    v_fma_f32 v35, -v32, v27, v35
    v_mul_f32 v22, v34, v33
    v_mul_f32 v23, v35, v33
    v_mov_b32 v24, v20
    v_mov_b32 v25, v21
    v_mul_f32 v14, v25, v25
    v_mul_f32 v15, v24, v25
    v_fma_f32 v24, v24, v24, -v14
    v_add_f32 v25, v15, v15
    v_mul_f32 v14, v25, v25
    v_mul_f32 v15, v24, v25
    v_fma_f32 v24, v24, v24, -v14
    v_add_f32 v25, v15, v15
    v_mul_f32 v14, v25, v25
    v_mul_f32 v15, v24, v25
    v_fma_f32 v24, v24, v24, -v14
    v_add_f32 v25, v15, v15
    v_mul_f32 v14, v25, v25
    v_mul_f32 v15, v24, v25
    v_fma_f32 v24, v24, v24, -v14
    v_add_f32 v25, v15, v15
    v_mul_f32 v14, v25, v25
    v_mul_f32 v15, v24, v25
    v_fma_f32 v24, v24, v24, -v14
    v_add_f32 v25, v15, v15
    s_barrier
    ds_read_b128 v[192:195], v6 offset:0
    ds_read_b128 v[196:199], v6 offset:2048
    ds_read_b128 v[200:203], v6 offset:8192
    ds_read_b128 v[204:207], v6 offset:10240
    ds_read_b128 v[208:211], v10 offset:0
    ds_read_b128 v[212:215], v10 offset:4096
    ds_read_b128 v[216:219], v7 offset:0
    ds_read_b128 v[220:223], v7 offset:2048
    ds_read_b128 v[224:227], v7 offset:8192
    ds_read_b128 v[228:231], v7 offset:10240
    ds_read_b128 v[232:235], v11 offset:0
    ds_read_b128 v[236:239], v11 offset:4096
    s_waitcnt lgkmcnt(6)
    v_mfma_f32_32x32x16_bf16 v[64:79], v[192:195], v[208:211], 0
    ds_read_b128 v[240:243], v8 offset:0
    v_mfma_f32_32x32x16_bf16 v[80:95], v[192:195], v[212:215], 0
    ds_read_b128 v[244:247], v8 offset:2048
    s_add_u32 m0, s61, 32768
    s_add_u32 s59, s57, 256
    buffer_load_dwordx4 v2, s[8:11], s59 offen lds
    v_mfma_f32_32x32x16_bf16 v[96:111], v[196:199], v[208:211], 0
    ds_read_b128 v[248:251], v8 offset:8192
    v_mfma_f32_32x32x16_bf16 v[112:127], v[196:199], v[212:215], 0
    ds_read_b128 v[252:255], v8 offset:10240
    v_mfma_f32_32x32x16_bf16 v[128:143], v[200:203], v[208:211], 0
    ds_read_b128 v[32:35], v12 offset:0
    s_add_u32 m0, s61, 33792
    s_add_u32 s59, s57, 8448
    buffer_load_dwordx4 v3, s[8:11], s59 offen lds
    v_mfma_f32_32x32x16_bf16 v[144:159], v[200:203], v[212:215], 0
    ds_read_b128 v[36:39], v12 offset:4096
    v_mfma_f32_32x32x16_bf16 v[160:175], v[204:207], v[208:211], 0
    v_mfma_f32_32x32x16_bf16 v[176:191], v[204:207], v[212:215], 0
    s_add_u32 m0, s61, 34816
    s_add_u32 s59, s57, 16640
    buffer_load_dwordx4 v2, s[8:11], s59 offen lds
    s_waitcnt lgkmcnt(6)
    v_mfma_f32_32x32x16_bf16 v[64:79], v[216:219], v[232:235], v[64:79]
    ds_read_b128 v[40:43], v9 offset:0
    v_mfma_f32_32x32x16_bf16 v[80:95], v[216:219], v[236:239], v[80:95]
    ds_read_b128 v[44:47], v9 offset:2048
    s_add_u32 m0, s61, 35840
    s_add_u32 s59, s57, 24832
    buffer_load_dwordx4 v3, s[8:11], s59 offen lds
    v_mfma_f32_32x32x16_bf16 v[96:111], v[220:223], v[232:235], v[96:111]
    ds_read_b128 v[48:51], v9 offset:8192
    v_mfma_f32_32x32x16_bf16 v[112:127], v[220:223], v[236:239], v[112:127]
    ds_read_b128 v[52:55], v9 offset:10240
    v_mfma_f32_32x32x16_bf16 v[128:143], v[224:227], v[232:235], v[128:143]
    ds_read_b128 v[56:59], v13 offset:0
    s_add_u32 m0, s62, 16384
    s_add_u32 s59, s58, 256
    buffer_load_dwordx4 v2, s[12:15], s59 offen lds
    v_mfma_f32_32x32x16_bf16 v[144:159], v[224:227], v[236:239], v[144:159]
    ds_read_b128 v[60:63], v13 offset:4096
    v_mfma_f32_32x32x16_bf16 v[160:175], v[228:231], v[232:235], v[160:175]
    v_mfma_f32_32x32x16_bf16 v[176:191], v[228:231], v[236:239], v[176:191]
    s_add_u32 m0, s62, 17408
    s_add_u32 s59, s58, 8448
    buffer_load_dwordx4 v3, s[12:15], s59 offen lds
    s_add_u32 m0, s62, 18432
    s_add_u32 s59, s58, 16640
    buffer_load_dwordx4 v2, s[12:15], s59 offen lds
    s_add_u32 m0, s62, 19456
    s_add_u32 s59, s58, 24832
    buffer_load_dwordx4 v3, s[12:15], s59 offen lds
    s_add_u32 m0, s62, 20480
    s_add_u32 s59, s58, 256
    buffer_load_dwordx4 v2, s[16:19], s59 offen lds
    s_add_u32 m0, s62, 21504
    s_add_u32 s59, s58, 8448
    buffer_load_dwordx4 v3, s[16:19], s59 offen lds
    s_add_u32 m0, s62, 22528
    s_add_u32 s59, s58, 16640
    buffer_load_dwordx4 v2, s[16:19], s59 offen lds
    s_add_u32 m0, s62, 23552
    s_add_u32 s59, s58, 24832
    buffer_load_dwordx4 v3, s[16:19], s59 offen lds
    s_waitcnt vmcnt(12)
    s_waitcnt lgkmcnt(0)
    s_barrier
    v_mfma_f32_32x32x16_bf16 v[64:79], v[240:243], v[32:35], v[64:79]
    ds_read_b128 v[192:195], v6 offset:16384
    v_mfma_f32_32x32x16_bf16 v[80:95], v[240:243], v[36:39], v[80:95]
    ds_read_b128 v[196:199], v6 offset:18432
    s_add_u32 m0, s61, 0
    s_add_u32 s59, s57, 384
    buffer_load_dwordx4 v2, s[8:11], s59 offen lds
    v_mfma_f32_32x32x16_bf16 v[96:111], v[244:247], v[32:35], v[96:111]
    ds_read_b128 v[200:203], v6 offset:24576
    v_mfma_f32_32x32x16_bf16 v[112:127], v[244:247], v[36:39], v[112:127]
    ds_read_b128 v[204:207], v6 offset:26624
    v_mfma_f32_32x32x16_bf16 v[128:143], v[248:251], v[32:35], v[128:143]
    ds_read_b128 v[208:211], v10 offset:8192
    s_add_u32 m0, s61, 1024
    s_add_u32 s59, s57, 8576
    buffer_load_dwordx4 v3, s[8:11], s59 offen lds
    v_mfma_f32_32x32x16_bf16 v[144:159], v[248:251], v[36:39], v[144:159]
    ds_read_b128 v[212:215], v10 offset:12288
    v_mfma_f32_32x32x16_bf16 v[160:175], v[252:255], v[32:35], v[160:175]
    v_mfma_f32_32x32x16_bf16 v[176:191], v[252:255], v[36:39], v[176:191]
    s_add_u32 m0, s61, 2048
    s_add_u32 s59, s57, 16768
    buffer_load_dwordx4 v2, s[8:11], s59 offen lds
    s_waitcnt lgkmcnt(6)
    v_mfma_f32_32x32x16_bf16 v[64:79], v[40:43], v[56:59], v[64:79]
    ds_read_b128 v[216:219], v7 offset:16384
    v_mfma_f32_32x32x16_bf16 v[80:95], v[40:43], v[60:63], v[80:95]
    ds_read_b128 v[220:223], v7 offset:18432
    s_add_u32 m0, s61, 3072
    s_add_u32 s59, s57, 24960
    buffer_load_dwordx4 v3, s[8:11], s59 offen lds
    v_mfma_f32_32x32x16_bf16 v[96:111], v[44:47], v[56:59], v[96:111]
    ds_read_b128 v[224:227], v7 offset:24576
    v_mfma_f32_32x32x16_bf16 v[112:127], v[44:47], v[60:63], v[112:127]
    ds_read_b128 v[228:231], v7 offset:26624
    v_mfma_f32_32x32x16_bf16 v[128:143], v[48:51], v[56:59], v[128:143]
    ds_read_b128 v[232:235], v11 offset:8192
    s_add_u32 m0, s62, 0
    s_add_u32 s59, s58, 384
    buffer_load_dwordx4 v2, s[12:15], s59 offen lds
    v_mfma_f32_32x32x16_bf16 v[144:159], v[48:51], v[60:63], v[144:159]
    ds_read_b128 v[236:239], v11 offset:12288
    v_mfma_f32_32x32x16_bf16 v[160:175], v[52:55], v[56:59], v[160:175]
    v_mfma_f32_32x32x16_bf16 v[176:191], v[52:55], v[60:63], v[176:191]
    s_add_u32 m0, s62, 1024
    s_add_u32 s59, s58, 8576
    buffer_load_dwordx4 v3, s[12:15], s59 offen lds
    s_waitcnt lgkmcnt(6)
    v_mfma_f32_32x32x16_bf16 v[64:79], v[192:195], v[208:211], v[64:79]
    ds_read_b128 v[240:243], v8 offset:16384
    v_mfma_f32_32x32x16_bf16 v[80:95], v[192:195], v[212:215], v[80:95]
    ds_read_b128 v[244:247], v8 offset:18432
    s_add_u32 m0, s62, 2048
    s_add_u32 s59, s58, 16768
    buffer_load_dwordx4 v2, s[12:15], s59 offen lds
    v_mfma_f32_32x32x16_bf16 v[96:111], v[196:199], v[208:211], v[96:111]
    ds_read_b128 v[248:251], v8 offset:24576
    v_mfma_f32_32x32x16_bf16 v[112:127], v[196:199], v[212:215], v[112:127]
    ds_read_b128 v[252:255], v8 offset:26624
    v_mfma_f32_32x32x16_bf16 v[128:143], v[200:203], v[208:211], v[128:143]
    ds_read_b128 v[32:35], v12 offset:8192
    s_add_u32 m0, s62, 3072
    s_add_u32 s59, s58, 24960
    buffer_load_dwordx4 v3, s[12:15], s59 offen lds
    v_mfma_f32_32x32x16_bf16 v[144:159], v[200:203], v[212:215], v[144:159]
    ds_read_b128 v[36:39], v12 offset:12288
    v_mfma_f32_32x32x16_bf16 v[160:175], v[204:207], v[208:211], v[160:175]
    v_mfma_f32_32x32x16_bf16 v[176:191], v[204:207], v[212:215], v[176:191]
    s_add_u32 m0, s62, 4096
    s_add_u32 s59, s58, 384
    buffer_load_dwordx4 v2, s[16:19], s59 offen lds
    s_waitcnt lgkmcnt(6)
    v_mfma_f32_32x32x16_bf16 v[64:79], v[216:219], v[232:235], v[64:79]
    ds_read_b128 v[40:43], v9 offset:16384
    v_mfma_f32_32x32x16_bf16 v[80:95], v[216:219], v[236:239], v[80:95]
    ds_read_b128 v[44:47], v9 offset:18432
    s_add_u32 m0, s62, 5120
    s_add_u32 s59, s58, 8576
    buffer_load_dwordx4 v3, s[16:19], s59 offen lds
    v_mfma_f32_32x32x16_bf16 v[96:111], v[220:223], v[232:235], v[96:111]
    ds_read_b128 v[48:51], v9 offset:24576
    v_mfma_f32_32x32x16_bf16 v[112:127], v[220:223], v[236:239], v[112:127]
    ds_read_b128 v[52:55], v9 offset:26624
    v_mfma_f32_32x32x16_bf16 v[128:143], v[224:227], v[232:235], v[128:143]
    ds_read_b128 v[56:59], v13 offset:8192
    s_add_u32 m0, s62, 6144
    s_add_u32 s59, s58, 16768
    buffer_load_dwordx4 v2, s[16:19], s59 offen lds
    v_mfma_f32_32x32x16_bf16 v[144:159], v[224:227], v[236:239], v[144:159]
    ds_read_b128 v[60:63], v13 offset:12288
    v_mfma_f32_32x32x16_bf16 v[160:175], v[228:231], v[232:235], v[160:175]
    v_mfma_f32_32x32x16_bf16 v[176:191], v[228:231], v[236:239], v[176:191]
    s_add_u32 m0, s62, 7168
    s_add_u32 s59, s58, 24960
    buffer_load_dwordx4 v3, s[16:19], s59 offen lds
    s_waitcnt vmcnt(12)
    s_waitcnt lgkmcnt(0)
    s_barrier
    v_mfma_f32_32x32x16_bf16 v[64:79], v[240:243], v[32:35], v[64:79]
    ds_read_b128 v[192:195], v6 offset:32768
    v_mfma_f32_32x32x16_bf16 v[80:95], v[240:243], v[36:39], v[80:95]
    ds_read_b128 v[196:199], v6 offset:34816
    s_add_u32 m0, s61, 16384
    s_add_u32 s59, s57, 512
    buffer_load_dwordx4 v2, s[8:11], s59 offen lds
    v_mfma_f32_32x32x16_bf16 v[96:111], v[244:247], v[32:35], v[96:111]
    ds_read_b128 v[200:203], v6 offset:40960
    v_mfma_f32_32x32x16_bf16 v[112:127], v[244:247], v[36:39], v[112:127]
    ds_read_b128 v[204:207], v6 offset:43008
    v_mfma_f32_32x32x16_bf16 v[128:143], v[248:251], v[32:35], v[128:143]
    ds_read_b128 v[208:211], v10 offset:16384
    s_add_u32 m0, s61, 17408
    s_add_u32 s59, s57, 8704
    buffer_load_dwordx4 v3, s[8:11], s59 offen lds
    v_mfma_f32_32x32x16_bf16 v[144:159], v[248:251], v[36:39], v[144:159]
    ds_read_b128 v[212:215], v10 offset:20480
    v_mfma_f32_32x32x16_bf16 v[160:175], v[252:255], v[32:35], v[160:175]
    v_mfma_f32_32x32x16_bf16 v[176:191], v[252:255], v[36:39], v[176:191]
    s_add_u32 m0, s61, 18432
    s_add_u32 s59, s57, 16896
    buffer_load_dwordx4 v2, s[8:11], s59 offen lds
    s_waitcnt lgkmcnt(6)
    v_mfma_f32_32x32x16_bf16 v[64:79], v[40:43], v[56:59], v[64:79]
    ds_read_b128 v[216:219], v7 offset:32768
    v_mfma_f32_32x32x16_bf16 v[80:95], v[40:43], v[60:63], v[80:95]
    ds_read_b128 v[220:223], v7 offset:34816
    s_add_u32 m0, s61, 19456
    s_add_u32 s59, s57, 25088
    buffer_load_dwordx4 v3, s[8:11], s59 offen lds
    v_mfma_f32_32x32x16_bf16 v[96:111], v[44:47], v[56:59], v[96:111]
    ds_read_b128 v[224:227], v7 offset:40960
    v_mfma_f32_32x32x16_bf16 v[112:127], v[44:47], v[60:63], v[112:127]
    ds_read_b128 v[228:231], v7 offset:43008
    v_mfma_f32_32x32x16_bf16 v[128:143], v[48:51], v[56:59], v[128:143]
    ds_read_b128 v[232:235], v11 offset:16384
    s_add_u32 m0, s62, 8192
    s_add_u32 s59, s58, 512
    buffer_load_dwordx4 v2, s[12:15], s59 offen lds
    v_mfma_f32_32x32x16_bf16 v[144:159], v[48:51], v[60:63], v[144:159]
    ds_read_b128 v[236:239], v11 offset:20480
    v_mfma_f32_32x32x16_bf16 v[160:175], v[52:55], v[56:59], v[160:175]
    v_mfma_f32_32x32x16_bf16 v[176:191], v[52:55], v[60:63], v[176:191]
    s_add_u32 m0, s62, 9216
    s_add_u32 s59, s58, 8704
    buffer_load_dwordx4 v3, s[12:15], s59 offen lds
    s_waitcnt lgkmcnt(6)
    v_mfma_f32_32x32x16_bf16 v[64:79], v[192:195], v[208:211], v[64:79]
    ds_read_b128 v[240:243], v8 offset:32768
    v_mfma_f32_32x32x16_bf16 v[80:95], v[192:195], v[212:215], v[80:95]
    ds_read_b128 v[244:247], v8 offset:34816
    s_add_u32 m0, s62, 10240
    s_add_u32 s59, s58, 16896
    buffer_load_dwordx4 v2, s[12:15], s59 offen lds
    v_mfma_f32_32x32x16_bf16 v[96:111], v[196:199], v[208:211], v[96:111]
    ds_read_b128 v[248:251], v8 offset:40960
    v_mfma_f32_32x32x16_bf16 v[112:127], v[196:199], v[212:215], v[112:127]
    ds_read_b128 v[252:255], v8 offset:43008
    v_mfma_f32_32x32x16_bf16 v[128:143], v[200:203], v[208:211], v[128:143]
    ds_read_b128 v[32:35], v12 offset:16384
    s_add_u32 m0, s62, 11264
    s_add_u32 s59, s58, 25088
    buffer_load_dwordx4 v3, s[12:15], s59 offen lds
    v_mfma_f32_32x32x16_bf16 v[144:159], v[200:203], v[212:215], v[144:159]
    ds_read_b128 v[36:39], v12 offset:20480
    v_mfma_f32_32x32x16_bf16 v[160:175], v[204:207], v[208:211], v[160:175]
    v_mfma_f32_32x32x16_bf16 v[176:191], v[204:207], v[212:215], v[176:191]
    s_add_u32 m0, s62, 12288
    s_add_u32 s59, s58, 512
    buffer_load_dwordx4 v2, s[16:19], s59 offen lds
    s_waitcnt lgkmcnt(6)
    v_mfma_f32_32x32x16_bf16 v[64:79], v[216:219], v[232:235], v[64:79]
    ds_read_b128 v[40:43], v9 offset:32768
    v_mfma_f32_32x32x16_bf16 v[80:95], v[216:219], v[236:239], v[80:95]
    ds_read_b128 v[44:47], v9 offset:34816
    s_add_u32 m0, s62, 13312
    s_add_u32 s59, s58, 8704
    buffer_load_dwordx4 v3, s[16:19], s59 offen lds
    v_mfma_f32_32x32x16_bf16 v[96:111], v[220:223], v[232:235], v[96:111]
    ds_read_b128 v[48:51], v9 offset:40960
    v_mfma_f32_32x32x16_bf16 v[112:127], v[220:223], v[236:239], v[112:127]
    ds_read_b128 v[52:55], v9 offset:43008
    v_mfma_f32_32x32x16_bf16 v[128:143], v[224:227], v[232:235], v[128:143]
    ds_read_b128 v[56:59], v13 offset:16384
    s_add_u32 m0, s62, 14336
    s_add_u32 s59, s58, 16896
    buffer_load_dwordx4 v2, s[16:19], s59 offen lds
    v_mfma_f32_32x32x16_bf16 v[144:159], v[224:227], v[236:239], v[144:159]
    ds_read_b128 v[60:63], v13 offset:20480
    v_mfma_f32_32x32x16_bf16 v[160:175], v[228:231], v[232:235], v[160:175]
    v_mfma_f32_32x32x16_bf16 v[176:191], v[228:231], v[236:239], v[176:191]
    s_add_u32 m0, s62, 15360
    s_add_u32 s59, s58, 25088
    buffer_load_dwordx4 v3, s[16:19], s59 offen lds
    s_waitcnt vmcnt(12)
    s_waitcnt lgkmcnt(0)
    s_barrier
    v_mfma_f32_32x32x16_bf16 v[64:79], v[240:243], v[32:35], v[64:79]
    ds_read_b128 v[192:195], v6 offset:0
    v_mfma_f32_32x32x16_bf16 v[80:95], v[240:243], v[36:39], v[80:95]
    ds_read_b128 v[196:199], v6 offset:2048
    s_add_u32 m0, s61, 32768
    s_add_u32 s59, s57, 640
    buffer_load_dwordx4 v2, s[8:11], s59 offen lds
    v_mfma_f32_32x32x16_bf16 v[96:111], v[244:247], v[32:35], v[96:111]
    ds_read_b128 v[200:203], v6 offset:8192
    v_mfma_f32_32x32x16_bf16 v[112:127], v[244:247], v[36:39], v[112:127]
    ds_read_b128 v[204:207], v6 offset:10240
    v_mfma_f32_32x32x16_bf16 v[128:143], v[248:251], v[32:35], v[128:143]
    ds_read_b128 v[208:211], v10 offset:0
    s_add_u32 m0, s61, 33792
    s_add_u32 s59, s57, 8832
    buffer_load_dwordx4 v3, s[8:11], s59 offen lds
    v_mfma_f32_32x32x16_bf16 v[144:159], v[248:251], v[36:39], v[144:159]
    ds_read_b128 v[212:215], v10 offset:4096
    v_mfma_f32_32x32x16_bf16 v[160:175], v[252:255], v[32:35], v[160:175]
    v_mfma_f32_32x32x16_bf16 v[176:191], v[252:255], v[36:39], v[176:191]
    s_add_u32 m0, s61, 34816
    s_add_u32 s59, s57, 17024
    buffer_load_dwordx4 v2, s[8:11], s59 offen lds
    s_waitcnt lgkmcnt(6)
    v_mfma_f32_32x32x16_bf16 v[64:79], v[40:43], v[56:59], v[64:79]
    ds_read_b128 v[216:219], v7 offset:0
    v_mfma_f32_32x32x16_bf16 v[80:95], v[40:43], v[60:63], v[80:95]
    ds_read_b128 v[220:223], v7 offset:2048
    s_add_u32 m0, s61, 35840
    s_add_u32 s59, s57, 25216
    buffer_load_dwordx4 v3, s[8:11], s59 offen lds
    v_mfma_f32_32x32x16_bf16 v[96:111], v[44:47], v[56:59], v[96:111]
    ds_read_b128 v[224:227], v7 offset:8192
    v_mfma_f32_32x32x16_bf16 v[112:127], v[44:47], v[60:63], v[112:127]
    ds_read_b128 v[228:231], v7 offset:10240
    v_mfma_f32_32x32x16_bf16 v[128:143], v[48:51], v[56:59], v[128:143]
    ds_read_b128 v[232:235], v11 offset:0
    s_add_u32 m0, s62, 16384
    s_add_u32 s59, s58, 640
    buffer_load_dwordx4 v2, s[12:15], s59 offen lds
    v_mfma_f32_32x32x16_bf16 v[144:159], v[48:51], v[60:63], v[144:159]
    ds_read_b128 v[236:239], v11 offset:4096
    v_mfma_f32_32x32x16_bf16 v[160:175], v[52:55], v[56:59], v[160:175]
    v_mfma_f32_32x32x16_bf16 v[176:191], v[52:55], v[60:63], v[176:191]
    s_add_u32 m0, s62, 17408
    s_add_u32 s59, s58, 8832
    buffer_load_dwordx4 v3, s[12:15], s59 offen lds
    s_waitcnt lgkmcnt(6)
    v_mfma_f32_32x32x16_bf16 v[64:79], v[192:195], v[208:211], v[64:79]
    ds_read_b128 v[240:243], v8 offset:0
    v_mfma_f32_32x32x16_bf16 v[80:95], v[192:195], v[212:215], v[80:95]
    ds_read_b128 v[244:247], v8 offset:2048
    s_add_u32 m0, s62, 18432
    s_add_u32 s59, s58, 17024
    buffer_load_dwordx4 v2, s[12:15], s59 offen lds
    v_mfma_f32_32x32x16_bf16 v[96:111], v[196:199], v[208:211], v[96:111]
    ds_read_b128 v[248:251], v8 offset:8192
    v_mfma_f32_32x32x16_bf16 v[112:127], v[196:199], v[212:215], v[112:127]
    ds_read_b128 v[252:255], v8 offset:10240
    v_mfma_f32_32x32x16_bf16 v[128:143], v[200:203], v[208:211], v[128:143]
    ds_read_b128 v[32:35], v12 offset:0
    s_add_u32 m0, s62, 19456
    s_add_u32 s59, s58, 25216
    buffer_load_dwordx4 v3, s[12:15], s59 offen lds
    v_mfma_f32_32x32x16_bf16 v[144:159], v[200:203], v[212:215], v[144:159]
    ds_read_b128 v[36:39], v12 offset:4096
    v_mfma_f32_32x32x16_bf16 v[160:175], v[204:207], v[208:211], v[160:175]
    v_mfma_f32_32x32x16_bf16 v[176:191], v[204:207], v[212:215], v[176:191]
    s_add_u32 m0, s62, 20480
    s_add_u32 s59, s58, 640
    buffer_load_dwordx4 v2, s[16:19], s59 offen lds
    s_waitcnt lgkmcnt(6)
    v_mfma_f32_32x32x16_bf16 v[64:79], v[216:219], v[232:235], v[64:79]
    ds_read_b128 v[40:43], v9 offset:0
    v_mfma_f32_32x32x16_bf16 v[80:95], v[216:219], v[236:239], v[80:95]
    ds_read_b128 v[44:47], v9 offset:2048
    s_add_u32 m0, s62, 21504
    s_add_u32 s59, s58, 8832
    buffer_load_dwordx4 v3, s[16:19], s59 offen lds
    v_mfma_f32_32x32x16_bf16 v[96:111], v[220:223], v[232:235], v[96:111]
    ds_read_b128 v[48:51], v9 offset:8192
    v_mfma_f32_32x32x16_bf16 v[112:127], v[220:223], v[236:239], v[112:127]
    ds_read_b128 v[52:55], v9 offset:10240
    v_mfma_f32_32x32x16_bf16 v[128:143], v[224:227], v[232:235], v[128:143]
    ds_read_b128 v[56:59], v13 offset:0
    s_add_u32 m0, s62, 22528
    s_add_u32 s59, s58, 17024
    buffer_load_dwordx4 v2, s[16:19], s59 offen lds
    v_mfma_f32_32x32x16_bf16 v[144:159], v[224:227], v[236:239], v[144:159]
    ds_read_b128 v[60:63], v13 offset:4096
    v_mfma_f32_32x32x16_bf16 v[160:175], v[228:231], v[232:235], v[160:175]
    v_mfma_f32_32x32x16_bf16 v[176:191], v[228:231], v[236:239], v[176:191]
    s_add_u32 m0, s62, 23552
    s_add_u32 s59, s58, 25216
    buffer_load_dwordx4 v3, s[16:19], s59 offen lds
    s_waitcnt vmcnt(12)
    s_waitcnt lgkmcnt(0)
    s_barrier
    v_mfma_f32_32x32x16_bf16 v[64:79], v[240:243], v[32:35], v[64:79]
    ds_read_b128 v[192:195], v6 offset:16384
    v_mfma_f32_32x32x16_bf16 v[80:95], v[240:243], v[36:39], v[80:95]
    ds_read_b128 v[196:199], v6 offset:18432
    s_add_u32 m0, s61, 0
    s_add_u32 s59, s57, 768
    buffer_load_dwordx4 v2, s[8:11], s59 offen lds
    v_mfma_f32_32x32x16_bf16 v[96:111], v[244:247], v[32:35], v[96:111]
    ds_read_b128 v[200:203], v6 offset:24576
    v_mfma_f32_32x32x16_bf16 v[112:127], v[244:247], v[36:39], v[112:127]
    ds_read_b128 v[204:207], v6 offset:26624
    v_mfma_f32_32x32x16_bf16 v[128:143], v[248:251], v[32:35], v[128:143]
    ds_read_b128 v[208:211], v10 offset:8192
    s_add_u32 m0, s61, 1024
    s_add_u32 s59, s57, 8960
    buffer_load_dwordx4 v3, s[8:11], s59 offen lds
    v_mfma_f32_32x32x16_bf16 v[144:159], v[248:251], v[36:39], v[144:159]
    ds_read_b128 v[212:215], v10 offset:12288
    v_mfma_f32_32x32x16_bf16 v[160:175], v[252:255], v[32:35], v[160:175]
    v_mfma_f32_32x32x16_bf16 v[176:191], v[252:255], v[36:39], v[176:191]
    s_add_u32 m0, s61, 2048
    s_add_u32 s59, s57, 17152
    buffer_load_dwordx4 v2, s[8:11], s59 offen lds
    s_waitcnt lgkmcnt(6)
    v_mfma_f32_32x32x16_bf16 v[64:79], v[40:43], v[56:59], v[64:79]
    ds_read_b128 v[216:219], v7 offset:16384
    v_mfma_f32_32x32x16_bf16 v[80:95], v[40:43], v[60:63], v[80:95]
    ds_read_b128 v[220:223], v7 offset:18432
    s_add_u32 m0, s61, 3072
    s_add_u32 s59, s57, 25344
    buffer_load_dwordx4 v3, s[8:11], s59 offen lds
    v_mfma_f32_32x32x16_bf16 v[96:111], v[44:47], v[56:59], v[96:111]
    ds_read_b128 v[224:227], v7 offset:24576
    v_mfma_f32_32x32x16_bf16 v[112:127], v[44:47], v[60:63], v[112:127]
    ds_read_b128 v[228:231], v7 offset:26624
    v_mfma_f32_32x32x16_bf16 v[128:143], v[48:51], v[56:59], v[128:143]
    ds_read_b128 v[232:235], v11 offset:8192
    s_add_u32 m0, s62, 0
    s_add_u32 s59, s58, 768
    buffer_load_dwordx4 v2, s[12:15], s59 offen lds
    v_mfma_f32_32x32x16_bf16 v[144:159], v[48:51], v[60:63], v[144:159]
    ds_read_b128 v[236:239], v11 offset:12288
    v_mfma_f32_32x32x16_bf16 v[160:175], v[52:55], v[56:59], v[160:175]
    v_mfma_f32_32x32x16_bf16 v[176:191], v[52:55], v[60:63], v[176:191]
    s_add_u32 m0, s62, 1024
    s_add_u32 s59, s58, 8960
    buffer_load_dwordx4 v3, s[12:15], s59 offen lds
    s_waitcnt lgkmcnt(6)
    v_mfma_f32_32x32x16_bf16 v[64:79], v[192:195], v[208:211], v[64:79]
    ds_read_b128 v[240:243], v8 offset:16384
    v_mfma_f32_32x32x16_bf16 v[80:95], v[192:195], v[212:215], v[80:95]
    ds_read_b128 v[244:247], v8 offset:18432
    s_add_u32 m0, s62, 2048
    s_add_u32 s59, s58, 17152
    buffer_load_dwordx4 v2, s[12:15], s59 offen lds
    v_mfma_f32_32x32x16_bf16 v[96:111], v[196:199], v[208:211], v[96:111]
    ds_read_b128 v[248:251], v8 offset:24576
    v_mfma_f32_32x32x16_bf16 v[112:127], v[196:199], v[212:215], v[112:127]
    ds_read_b128 v[252:255], v8 offset:26624
    v_mfma_f32_32x32x16_bf16 v[128:143], v[200:203], v[208:211], v[128:143]
    ds_read_b128 v[32:35], v12 offset:8192
    s_add_u32 m0, s62, 3072
    s_add_u32 s59, s58, 25344
    buffer_load_dwordx4 v3, s[12:15], s59 offen lds
    v_mfma_f32_32x32x16_bf16 v[144:159], v[200:203], v[212:215], v[144:159]
    ds_read_b128 v[36:39], v12 offset:12288
    v_mfma_f32_32x32x16_bf16 v[160:175], v[204:207], v[208:211], v[160:175]
    v_mfma_f32_32x32x16_bf16 v[176:191], v[204:207], v[212:215], v[176:191]
    s_add_u32 m0, s62, 4096
    s_add_u32 s59, s58, 768
    buffer_load_dwordx4 v2, s[16:19], s59 offen lds
    s_waitcnt lgkmcnt(6)
    v_mfma_f32_32x32x16_bf16 v[64:79], v[216:219], v[232:235], v[64:79]
    ds_read_b128 v[40:43], v9 offset:16384
    v_mfma_f32_32x32x16_bf16 v[80:95], v[216:219], v[236:239], v[80:95]
    ds_read_b128 v[44:47], v9 offset:18432
    s_add_u32 m0, s62, 5120
    s_add_u32 s59, s58, 8960
    buffer_load_dwordx4 v3, s[16:19], s59 offen lds
    v_mfma_f32_32x32x16_bf16 v[96:111], v[220:223], v[232:235], v[96:111]
    ds_read_b128 v[48:51], v9 offset:24576
    v_mfma_f32_32x32x16_bf16 v[112:127], v[220:223], v[236:239], v[112:127]
    ds_read_b128 v[52:55], v9 offset:26624
    v_mfma_f32_32x32x16_bf16 v[128:143], v[224:227], v[232:235], v[128:143]
    ds_read_b128 v[56:59], v13 offset:8192
    s_add_u32 m0, s62, 6144
    s_add_u32 s59, s58, 17152
    buffer_load_dwordx4 v2, s[16:19], s59 offen lds
    v_mfma_f32_32x32x16_bf16 v[144:159], v[224:227], v[236:239], v[144:159]
    ds_read_b128 v[60:63], v13 offset:12288
    v_mfma_f32_32x32x16_bf16 v[160:175], v[228:231], v[232:235], v[160:175]
    v_mfma_f32_32x32x16_bf16 v[176:191], v[228:231], v[236:239], v[176:191]
    s_add_u32 m0, s62, 7168
    s_add_u32 s59, s58, 25344
    buffer_load_dwordx4 v3, s[16:19], s59 offen lds
    s_waitcnt vmcnt(12)
    s_waitcnt lgkmcnt(0)
    s_barrier
    v_mfma_f32_32x32x16_bf16 v[64:79], v[240:243], v[32:35], v[64:79]
    ds_read_b128 v[192:195], v6 offset:32768
    v_mfma_f32_32x32x16_bf16 v[80:95], v[240:243], v[36:39], v[80:95]
    ds_read_b128 v[196:199], v6 offset:34816
    s_add_u32 m0, s61, 16384
    s_add_u32 s59, s57, 896
    buffer_load_dwordx4 v2, s[8:11], s59 offen lds
    v_mfma_f32_32x32x16_bf16 v[96:111], v[244:247], v[32:35], v[96:111]
    ds_read_b128 v[200:203], v6 offset:40960
    v_mfma_f32_32x32x16_bf16 v[112:127], v[244:247], v[36:39], v[112:127]
    ds_read_b128 v[204:207], v6 offset:43008
    v_mfma_f32_32x32x16_bf16 v[128:143], v[248:251], v[32:35], v[128:143]
    ds_read_b128 v[208:211], v10 offset:16384
    s_add_u32 m0, s61, 17408
    s_add_u32 s59, s57, 9088
    buffer_load_dwordx4 v3, s[8:11], s59 offen lds
    v_mfma_f32_32x32x16_bf16 v[144:159], v[248:251], v[36:39], v[144:159]
    ds_read_b128 v[212:215], v10 offset:20480
    v_mfma_f32_32x32x16_bf16 v[160:175], v[252:255], v[32:35], v[160:175]
    v_mfma_f32_32x32x16_bf16 v[176:191], v[252:255], v[36:39], v[176:191]
    s_add_u32 m0, s61, 18432
    s_add_u32 s59, s57, 17280
    buffer_load_dwordx4 v2, s[8:11], s59 offen lds
    s_waitcnt lgkmcnt(6)
    v_mfma_f32_32x32x16_bf16 v[64:79], v[40:43], v[56:59], v[64:79]
    ds_read_b128 v[216:219], v7 offset:32768
    v_mfma_f32_32x32x16_bf16 v[80:95], v[40:43], v[60:63], v[80:95]
    ds_read_b128 v[220:223], v7 offset:34816
    s_add_u32 m0, s61, 19456
    s_add_u32 s59, s57, 25472
    buffer_load_dwordx4 v3, s[8:11], s59 offen lds
    v_mfma_f32_32x32x16_bf16 v[96:111], v[44:47], v[56:59], v[96:111]
    ds_read_b128 v[224:227], v7 offset:40960
    v_mfma_f32_32x32x16_bf16 v[112:127], v[44:47], v[60:63], v[112:127]
    ds_read_b128 v[228:231], v7 offset:43008
    v_mfma_f32_32x32x16_bf16 v[128:143], v[48:51], v[56:59], v[128:143]
    ds_read_b128 v[232:235], v11 offset:16384
    s_add_u32 m0, s62, 8192
    s_add_u32 s59, s58, 896
    buffer_load_dwordx4 v2, s[12:15], s59 offen lds
    v_mfma_f32_32x32x16_bf16 v[144:159], v[48:51], v[60:63], v[144:159]
    ds_read_b128 v[236:239], v11 offset:20480
    v_mfma_f32_32x32x16_bf16 v[160:175], v[52:55], v[56:59], v[160:175]
    v_mfma_f32_32x32x16_bf16 v[176:191], v[52:55], v[60:63], v[176:191]
    s_add_u32 m0, s62, 9216
    s_add_u32 s59, s58, 9088
    buffer_load_dwordx4 v3, s[12:15], s59 offen lds
    s_waitcnt lgkmcnt(6)
    v_mfma_f32_32x32x16_bf16 v[64:79], v[192:195], v[208:211], v[64:79]
    ds_read_b128 v[240:243], v8 offset:32768
    v_mfma_f32_32x32x16_bf16 v[80:95], v[192:195], v[212:215], v[80:95]
    ds_read_b128 v[244:247], v8 offset:34816
    s_add_u32 m0, s62, 10240
    s_add_u32 s59, s58, 17280
    buffer_load_dwordx4 v2, s[12:15], s59 offen lds
    v_mfma_f32_32x32x16_bf16 v[96:111], v[196:199], v[208:211], v[96:111]
    ds_read_b128 v[248:251], v8 offset:40960
    v_mfma_f32_32x32x16_bf16 v[112:127], v[196:199], v[212:215], v[112:127]
    ds_read_b128 v[252:255], v8 offset:43008
    v_mfma_f32_32x32x16_bf16 v[128:143], v[200:203], v[208:211], v[128:143]
    ds_read_b128 v[32:35], v12 offset:16384
    s_add_u32 m0, s62, 11264
    s_add_u32 s59, s58, 25472
    buffer_load_dwordx4 v3, s[12:15], s59 offen lds
    v_mfma_f32_32x32x16_bf16 v[144:159], v[200:203], v[212:215], v[144:159]
    ds_read_b128 v[36:39], v12 offset:20480
    v_mfma_f32_32x32x16_bf16 v[160:175], v[204:207], v[208:211], v[160:175]
    v_mfma_f32_32x32x16_bf16 v[176:191], v[204:207], v[212:215], v[176:191]
    s_add_u32 m0, s62, 12288
    s_add_u32 s59, s58, 896
    buffer_load_dwordx4 v2, s[16:19], s59 offen lds
    s_waitcnt lgkmcnt(6)
    v_mfma_f32_32x32x16_bf16 v[64:79], v[216:219], v[232:235], v[64:79]
    ds_read_b128 v[40:43], v9 offset:32768
    v_mfma_f32_32x32x16_bf16 v[80:95], v[216:219], v[236:239], v[80:95]
    ds_read_b128 v[44:47], v9 offset:34816
    s_add_u32 m0, s62, 13312
    s_add_u32 s59, s58, 9088
    buffer_load_dwordx4 v3, s[16:19], s59 offen lds
    v_mfma_f32_32x32x16_bf16 v[96:111], v[220:223], v[232:235], v[96:111]
    ds_read_b128 v[48:51], v9 offset:40960
    v_mfma_f32_32x32x16_bf16 v[112:127], v[220:223], v[236:239], v[112:127]
    ds_read_b128 v[52:55], v9 offset:43008
    v_mfma_f32_32x32x16_bf16 v[128:143], v[224:227], v[232:235], v[128:143]
    ds_read_b128 v[56:59], v13 offset:16384
    s_add_u32 m0, s62, 14336
    s_add_u32 s59, s58, 17280
    buffer_load_dwordx4 v2, s[16:19], s59 offen lds
    v_mfma_f32_32x32x16_bf16 v[144:159], v[224:227], v[236:239], v[144:159]
    ds_read_b128 v[60:63], v13 offset:20480
    v_mfma_f32_32x32x16_bf16 v[160:175], v[228:231], v[232:235], v[160:175]
    v_mfma_f32_32x32x16_bf16 v[176:191], v[228:231], v[236:239], v[176:191]
    s_add_u32 m0, s62, 15360
    s_add_u32 s59, s58, 25472
    buffer_load_dwordx4 v3, s[16:19], s59 offen lds
    s_waitcnt vmcnt(12)
    s_waitcnt lgkmcnt(0)
    s_barrier
    buffer_load_dwordx2 v[18:19], off, s[4:7], 0 sc1
    v_mfma_f32_32x32x16_bf16 v[64:79], v[240:243], v[32:35], v[64:79]
    ds_read_b128 v[192:195], v6 offset:0
    v_mfma_f32_32x32x16_bf16 v[80:95], v[240:243], v[36:39], v[80:95]
    ds_read_b128 v[196:199], v6 offset:2048
    v_mfma_f32_32x32x16_bf16 v[96:111], v[244:247], v[32:35], v[96:111]
    ds_read_b128 v[200:203], v6 offset:8192
    v_mfma_f32_32x32x16_bf16 v[112:127], v[244:247], v[36:39], v[112:127]
    ds_read_b128 v[204:207], v6 offset:10240
    v_mfma_f32_32x32x16_bf16 v[128:143], v[248:251], v[32:35], v[128:143]
    ds_read_b128 v[208:211], v10 offset:0
    v_mfma_f32_32x32x16_bf16 v[144:159], v[248:251], v[36:39], v[144:159]
    ds_read_b128 v[212:215], v10 offset:4096
    v_mfma_f32_32x32x16_bf16 v[160:175], v[252:255], v[32:35], v[160:175]
    v_mfma_f32_32x32x16_bf16 v[176:191], v[252:255], v[36:39], v[176:191]
    s_waitcnt lgkmcnt(6)
    v_mfma_f32_32x32x16_bf16 v[64:79], v[40:43], v[56:59], v[64:79]
    ds_read_b128 v[216:219], v7 offset:0
    v_mfma_f32_32x32x16_bf16 v[80:95], v[40:43], v[60:63], v[80:95]
    ds_read_b128 v[220:223], v7 offset:2048
    v_mfma_f32_32x32x16_bf16 v[96:111], v[44:47], v[56:59], v[96:111]
    ds_read_b128 v[224:227], v7 offset:8192
    v_mfma_f32_32x32x16_bf16 v[112:127], v[44:47], v[60:63], v[112:127]
    ds_read_b128 v[228:231], v7 offset:10240
    v_mfma_f32_32x32x16_bf16 v[128:143], v[48:51], v[56:59], v[128:143]
    ds_read_b128 v[232:235], v11 offset:0
    v_mfma_f32_32x32x16_bf16 v[144:159], v[48:51], v[60:63], v[144:159]
    ds_read_b128 v[236:239], v11 offset:4096
    v_mfma_f32_32x32x16_bf16 v[160:175], v[52:55], v[56:59], v[160:175]
    v_mfma_f32_32x32x16_bf16 v[176:191], v[52:55], v[60:63], v[176:191]
    s_waitcnt lgkmcnt(6)
    v_mfma_f32_32x32x16_bf16 v[64:79], v[192:195], v[208:211], v[64:79]
    ds_read_b128 v[240:243], v8 offset:0
    v_mfma_f32_32x32x16_bf16 v[80:95], v[192:195], v[212:215], v[80:95]
    ds_read_b128 v[244:247], v8 offset:2048
    v_mfma_f32_32x32x16_bf16 v[96:111], v[196:199], v[208:211], v[96:111]
    ds_read_b128 v[248:251], v8 offset:8192
    v_mfma_f32_32x32x16_bf16 v[112:127], v[196:199], v[212:215], v[112:127]
    ds_read_b128 v[252:255], v8 offset:10240
    v_mfma_f32_32x32x16_bf16 v[128:143], v[200:203], v[208:211], v[128:143]
    ds_read_b128 v[32:35], v12 offset:0
    v_mfma_f32_32x32x16_bf16 v[144:159], v[200:203], v[212:215], v[144:159]
    ds_read_b128 v[36:39], v12 offset:4096
    v_mfma_f32_32x32x16_bf16 v[160:175], v[204:207], v[208:211], v[160:175]
    v_mfma_f32_32x32x16_bf16 v[176:191], v[204:207], v[212:215], v[176:191]
    s_waitcnt lgkmcnt(6)
    v_mfma_f32_32x32x16_bf16 v[64:79], v[216:219], v[232:235], v[64:79]
    ds_read_b128 v[40:43], v9 offset:0
    v_mfma_f32_32x32x16_bf16 v[80:95], v[216:219], v[236:239], v[80:95]
    ds_read_b128 v[44:47], v9 offset:2048
    v_mfma_f32_32x32x16_bf16 v[96:111], v[220:223], v[232:235], v[96:111]
    ds_read_b128 v[48:51], v9 offset:8192
    v_mfma_f32_32x32x16_bf16 v[112:127], v[220:223], v[236:239], v[112:127]
    ds_read_b128 v[52:55], v9 offset:10240
    v_mfma_f32_32x32x16_bf16 v[128:143], v[224:227], v[232:235], v[128:143]
    ds_read_b128 v[56:59], v13 offset:0
    v_mfma_f32_32x32x16_bf16 v[144:159], v[224:227], v[236:239], v[144:159]
    ds_read_b128 v[60:63], v13 offset:4096
    v_mfma_f32_32x32x16_bf16 v[160:175], v[228:231], v[232:235], v[160:175]
    v_mfma_f32_32x32x16_bf16 v[176:191], v[228:231], v[236:239], v[176:191]
    s_waitcnt vmcnt(1)
    s_waitcnt lgkmcnt(0)
    s_barrier
    v_mfma_f32_32x32x16_bf16 v[64:79], v[240:243], v[32:35], v[64:79]
    ds_read_b128 v[192:195], v6 offset:16384
    v_mfma_f32_32x32x16_bf16 v[80:95], v[240:243], v[36:39], v[80:95]
    ds_read_b128 v[196:199], v6 offset:18432
    v_mfma_f32_32x32x16_bf16 v[96:111], v[244:247], v[32:35], v[96:111]
    ds_read_b128 v[200:203], v6 offset:24576
    v_mfma_f32_32x32x16_bf16 v[112:127], v[244:247], v[36:39], v[112:127]
    ds_read_b128 v[204:207], v6 offset:26624
    v_mfma_f32_32x32x16_bf16 v[128:143], v[248:251], v[32:35], v[128:143]
    ds_read_b128 v[208:211], v10 offset:8192
    v_mfma_f32_32x32x16_bf16 v[144:159], v[248:251], v[36:39], v[144:159]
    ds_read_b128 v[212:215], v10 offset:12288
    v_mfma_f32_32x32x16_bf16 v[160:175], v[252:255], v[32:35], v[160:175]
    v_mfma_f32_32x32x16_bf16 v[176:191], v[252:255], v[36:39], v[176:191]
    s_waitcnt lgkmcnt(6)
    v_mfma_f32_32x32x16_bf16 v[64:79], v[40:43], v[56:59], v[64:79]
    ds_read_b128 v[216:219], v7 offset:16384
    v_mfma_f32_32x32x16_bf16 v[80:95], v[40:43], v[60:63], v[80:95]
    ds_read_b128 v[220:223], v7 offset:18432
    v_mfma_f32_32x32x16_bf16 v[96:111], v[44:47], v[56:59], v[96:111]
    ds_read_b128 v[224:227], v7 offset:24576
    v_mfma_f32_32x32x16_bf16 v[112:127], v[44:47], v[60:63], v[112:127]
    ds_read_b128 v[228:231], v7 offset:26624
    v_mfma_f32_32x32x16_bf16 v[128:143], v[48:51], v[56:59], v[128:143]
    ds_read_b128 v[232:235], v11 offset:8192
    v_mfma_f32_32x32x16_bf16 v[144:159], v[48:51], v[60:63], v[144:159]
    ds_read_b128 v[236:239], v11 offset:12288
    v_mfma_f32_32x32x16_bf16 v[160:175], v[52:55], v[56:59], v[160:175]
    v_mfma_f32_32x32x16_bf16 v[176:191], v[52:55], v[60:63], v[176:191]
    s_waitcnt lgkmcnt(6)
    v_mfma_f32_32x32x16_bf16 v[64:79], v[192:195], v[208:211], v[64:79]
    ds_read_b128 v[240:243], v8 offset:16384
    v_mfma_f32_32x32x16_bf16 v[80:95], v[192:195], v[212:215], v[80:95]
    ds_read_b128 v[244:247], v8 offset:18432
    v_mfma_f32_32x32x16_bf16 v[96:111], v[196:199], v[208:211], v[96:111]
    ds_read_b128 v[248:251], v8 offset:24576
    v_mfma_f32_32x32x16_bf16 v[112:127], v[196:199], v[212:215], v[112:127]
    ds_read_b128 v[252:255], v8 offset:26624
    v_mfma_f32_32x32x16_bf16 v[128:143], v[200:203], v[208:211], v[128:143]
    ds_read_b128 v[32:35], v12 offset:8192
    v_mfma_f32_32x32x16_bf16 v[144:159], v[200:203], v[212:215], v[144:159]
    ds_read_b128 v[36:39], v12 offset:12288
    v_mfma_f32_32x32x16_bf16 v[160:175], v[204:207], v[208:211], v[160:175]
    v_mfma_f32_32x32x16_bf16 v[176:191], v[204:207], v[212:215], v[176:191]
    s_waitcnt lgkmcnt(6)
    v_mfma_f32_32x32x16_bf16 v[64:79], v[216:219], v[232:235], v[64:79]
    ds_read_b128 v[40:43], v9 offset:16384
    v_mfma_f32_32x32x16_bf16 v[80:95], v[216:219], v[236:239], v[80:95]
    ds_read_b128 v[44:47], v9 offset:18432
    v_mfma_f32_32x32x16_bf16 v[96:111], v[220:223], v[232:235], v[96:111]
    ds_read_b128 v[48:51], v9 offset:24576
    v_mfma_f32_32x32x16_bf16 v[112:127], v[220:223], v[236:239], v[112:127]
    ds_read_b128 v[52:55], v9 offset:26624
    v_mfma_f32_32x32x16_bf16 v[128:143], v[224:227], v[232:235], v[128:143]
    ds_read_b128 v[56:59], v13 offset:8192
    v_mfma_f32_32x32x16_bf16 v[144:159], v[224:227], v[236:239], v[144:159]
    ds_read_b128 v[60:63], v13 offset:12288
    v_mfma_f32_32x32x16_bf16 v[160:175], v[228:231], v[232:235], v[160:175]
    v_mfma_f32_32x32x16_bf16 v[176:191], v[228:231], v[236:239], v[176:191]
    s_waitcnt lgkmcnt(6)
    v_mfma_f32_32x32x16_bf16 v[64:79], v[240:243], v[32:35], v[64:79]
    v_mfma_f32_32x32x16_bf16 v[80:95], v[240:243], v[36:39], v[80:95]
    v_mfma_f32_32x32x16_bf16 v[96:111], v[244:247], v[32:35], v[96:111]
    v_mfma_f32_32x32x16_bf16 v[112:127], v[244:247], v[36:39], v[112:127]
    v_mfma_f32_32x32x16_bf16 v[128:143], v[248:251], v[32:35], v[128:143]
    v_mfma_f32_32x32x16_bf16 v[144:159], v[248:251], v[36:39], v[144:159]
    v_mfma_f32_32x32x16_bf16 v[160:175], v[252:255], v[32:35], v[160:175]
    v_mfma_f32_32x32x16_bf16 v[176:191], v[252:255], v[36:39], v[176:191]
    s_waitcnt lgkmcnt(0)
    v_mfma_f32_32x32x16_bf16 v[64:79], v[40:43], v[56:59], v[64:79]
    v_mfma_f32_32x32x16_bf16 v[80:95], v[40:43], v[60:63], v[80:95]
    v_mfma_f32_32x32x16_bf16 v[96:111], v[44:47], v[56:59], v[96:111]
    v_mfma_f32_32x32x16_bf16 v[112:127], v[44:47], v[60:63], v[112:127]
    v_mfma_f32_32x32x16_bf16 v[128:143], v[48:51], v[56:59], v[128:143]
    v_mfma_f32_32x32x16_bf16 v[144:159], v[48:51], v[60:63], v[144:159]
    v_mfma_f32_32x32x16_bf16 v[160:175], v[52:55], v[56:59], v[160:175]
    v_mfma_f32_32x32x16_bf16 v[176:191], v[52:55], v[60:63], v[176:191]
    s_waitcnt vmcnt(0)
    s_mov_b32 s60, 20000
L_np_73:
    v_readfirstlane_b32 s100, v18
    v_readfirstlane_b32 s101, v19
    s_cmp_lg_u32 s100, 0
    s_cbranch_scc1 L_npd_74
    buffer_load_dwordx2 v[18:19], off, s[4:7], 0 sc1
    s_waitcnt vmcnt(0)
    s_sub_u32 s60, s60, 1
    s_cmp_lg_u32 s60, 0
    s_cbranch_scc1 L_np_73
L_npd_74:
    s_add_u32 s4, s98, 3670016
    s_addc_u32 s5, s99, 0
    s_and_b32 s5, s5, 0xffff
    s_mov_b32 s6, 65536
    s_mov_b32 s7, 0x00020000
    s_add_u32 s20, s98, 3145728
    s_addc_u32 s21, s99, 0
    s_and_b32 s21, s21, 0xffff
    s_mov_b32 s22, 131072
    s_mov_b32 s23, 0x00020000
    v_lshlrev_b32 v29, 4, v30
    s_lshl_b32 s43, s55, 13
    v_mov_b32 v56, v20
    v_mov_b32 v57, v21
    v_mul_f32 v14, v57, v57
    v_mul_f32 v15, v56, v57
    v_fma_f32 v56, v56, v56, -v14
    v_add_f32 v57, v15, v15
    v_mov_b32 v58, v20
    v_mov_b32 v59, v56
    v_mov_b32 v60, v21
    v_mov_b32 v61, v57
    s_nop 7
    v_pk_fma_f32 v[48:49], v[80:81], v[56:57], v[66:67] op_sel:[0,1,0] op_sel_hi:[1,1,1] neg_lo:[0,1,0] neg_hi:[0,1,0]
    v_pk_fma_f32 v[50:51], v[64:65], v[56:57], v[82:83] op_sel:[0,1,0] op_sel_hi:[1,1,1]
    v_pk_fma_f32 v[52:53], v[144:145], v[56:57], v[130:131] op_sel:[0,1,0] op_sel_hi:[1,1,1] neg_lo:[0,1,0] neg_hi:[0,1,0]
    v_pk_fma_f32 v[54:55], v[128:129], v[56:57], v[146:147] op_sel:[0,1,0] op_sel_hi:[1,1,1]
    v_pk_fma_f32 v[40:41], v[64:65], v[56:57], v[48:49] op_sel:[0,0,0] op_sel_hi:[1,0,1]
    v_pk_fma_f32 v[42:43], v[80:81], v[56:57], v[50:51] op_sel:[0,0,0] op_sel_hi:[1,0,1]
    v_pk_fma_f32 v[44:45], v[128:129], v[56:57], v[52:53] op_sel:[0,0,0] op_sel_hi:[1,0,1]
    v_pk_fma_f32 v[46:47], v[144:145], v[56:57], v[54:55] op_sel:[0,0,0] op_sel_hi:[1,0,1]
    v_pk_fma_f32 v[48:49], v[42:43], v[56:57], v[68:69] op_sel:[0,1,0] op_sel_hi:[1,1,1] neg_lo:[0,1,0] neg_hi:[0,1,0]
    v_pk_fma_f32 v[50:51], v[40:41], v[56:57], v[84:85] op_sel:[0,1,0] op_sel_hi:[1,1,1]
    v_pk_fma_f32 v[52:53], v[46:47], v[56:57], v[132:133] op_sel:[0,1,0] op_sel_hi:[1,1,1] neg_lo:[0,1,0] neg_hi:[0,1,0]
    v_pk_fma_f32 v[54:55], v[44:45], v[56:57], v[148:149] op_sel:[0,1,0] op_sel_hi:[1,1,1]
    v_pk_fma_f32 v[40:41], v[40:41], v[56:57], v[48:49] op_sel:[0,0,0] op_sel_hi:[1,0,1]
    v_pk_fma_f32 v[42:43], v[42:43], v[56:57], v[50:51] op_sel:[0,0,0] op_sel_hi:[1,0,1]
    v_pk_fma_f32 v[44:45], v[44:45], v[56:57], v[52:53] op_sel:[0,0,0] op_sel_hi:[1,0,1]
    v_pk_fma_f32 v[46:47], v[46:47], v[56:57], v[54:55] op_sel:[0,0,0] op_sel_hi:[1,0,1]
    v_pk_fma_f32 v[48:49], v[42:43], v[56:57], v[70:71] op_sel:[0,1,0] op_sel_hi:[1,1,1] neg_lo:[0,1,0] neg_hi:[0,1,0]
    v_pk_fma_f32 v[50:51], v[40:41], v[56:57], v[86:87] op_sel:[0,1,0] op_sel_hi:[1,1,1]
    v_pk_fma_f32 v[52:53], v[46:47], v[56:57], v[134:135] op_sel:[0,1,0] op_sel_hi:[1,1,1] neg_lo:[0,1,0] neg_hi:[0,1,0]
    v_pk_fma_f32 v[54:55], v[44:45], v[56:57], v[150:151] op_sel:[0,1,0] op_sel_hi:[1,1,1]
    v_pk_fma_f32 v[40:41], v[40:41], v[56:57], v[48:49] op_sel:[0,0,0] op_sel_hi:[1,0,1]
    v_pk_fma_f32 v[42:43], v[42:43], v[56:57], v[50:51] op_sel:[0,0,0] op_sel_hi:[1,0,1]
    v_pk_fma_f32 v[44:45], v[44:45], v[56:57], v[52:53] op_sel:[0,0,0] op_sel_hi:[1,0,1]
    v_pk_fma_f32 v[46:47], v[46:47], v[56:57], v[54:55] op_sel:[0,0,0] op_sel_hi:[1,0,1]
    v_pk_fma_f32 v[48:49], v[42:43], v[56:57], v[72:73] op_sel:[0,1,0] op_sel_hi:[1,1,1] neg_lo:[0,1,0] neg_hi:[0,1,0]
    v_pk_fma_f32 v[50:51], v[40:41], v[56:57], v[88:89] op_sel:[0,1,0] op_sel_hi:[1,1,1]
    v_pk_fma_f32 v[52:53], v[46:47], v[56:57], v[136:137] op_sel:[0,1,0] op_sel_hi:[1,1,1] neg_lo:[0,1,0] neg_hi:[0,1,0]
    v_pk_fma_f32 v[54:55], v[44:45], v[56:57], v[152:153] op_sel:[0,1,0] op_sel_hi:[1,1,1]
    v_pk_fma_f32 v[40:41], v[40:41], v[56:57], v[48:49] op_sel:[0,0,0] op_sel_hi:[1,0,1]
    v_pk_fma_f32 v[42:43], v[42:43], v[56:57], v[50:51] op_sel:[0,0,0] op_sel_hi:[1,0,1]
    v_pk_fma_f32 v[44:45], v[44:45], v[56:57], v[52:53] op_sel:[0,0,0] op_sel_hi:[1,0,1]
    v_pk_fma_f32 v[46:47], v[46:47], v[56:57], v[54:55] op_sel:[0,0,0] op_sel_hi:[1,0,1]
    v_pk_fma_f32 v[48:49], v[42:43], v[56:57], v[74:75] op_sel:[0,1,0] op_sel_hi:[1,1,1] neg_lo:[0,1,0] neg_hi:[0,1,0]
    v_pk_fma_f32 v[50:51], v[40:41], v[56:57], v[90:91] op_sel:[0,1,0] op_sel_hi:[1,1,1]
    v_pk_fma_f32 v[52:53], v[46:47], v[56:57], v[138:139] op_sel:[0,1,0] op_sel_hi:[1,1,1] neg_lo:[0,1,0] neg_hi:[0,1,0]
    v_pk_fma_f32 v[54:55], v[44:45], v[56:57], v[154:155] op_sel:[0,1,0] op_sel_hi:[1,1,1]
    v_pk_fma_f32 v[40:41], v[40:41], v[56:57], v[48:49] op_sel:[0,0,0] op_sel_hi:[1,0,1]
    v_pk_fma_f32 v[42:43], v[42:43], v[56:57], v[50:51] op_sel:[0,0,0] op_sel_hi:[1,0,1]
    v_pk_fma_f32 v[44:45], v[44:45], v[56:57], v[52:53] op_sel:[0,0,0] op_sel_hi:[1,0,1]
    v_pk_fma_f32 v[46:47], v[46:47], v[56:57], v[54:55] op_sel:[0,0,0] op_sel_hi:[1,0,1]
    v_pk_fma_f32 v[48:49], v[42:43], v[56:57], v[76:77] op_sel:[0,1,0] op_sel_hi:[1,1,1] neg_lo:[0,1,0] neg_hi:[0,1,0]
    v_pk_fma_f32 v[50:51], v[40:41], v[56:57], v[92:93] op_sel:[0,1,0] op_sel_hi:[1,1,1]
    v_pk_fma_f32 v[52:53], v[46:47], v[56:57], v[140:141] op_sel:[0,1,0] op_sel_hi:[1,1,1] neg_lo:[0,1,0] neg_hi:[0,1,0]
    v_pk_fma_f32 v[54:55], v[44:45], v[56:57], v[156:157] op_sel:[0,1,0] op_sel_hi:[1,1,1]
    v_pk_fma_f32 v[40:41], v[40:41], v[56:57], v[48:49] op_sel:[0,0,0] op_sel_hi:[1,0,1]
    v_pk_fma_f32 v[42:43], v[42:43], v[56:57], v[50:51] op_sel:[0,0,0] op_sel_hi:[1,0,1]
    v_pk_fma_f32 v[44:45], v[44:45], v[56:57], v[52:53] op_sel:[0,0,0] op_sel_hi:[1,0,1]
    v_pk_fma_f32 v[46:47], v[46:47], v[56:57], v[54:55] op_sel:[0,0,0] op_sel_hi:[1,0,1]
    v_pk_fma_f32 v[48:49], v[42:43], v[56:57], v[78:79] op_sel:[0,1,0] op_sel_hi:[1,1,1] neg_lo:[0,1,0] neg_hi:[0,1,0]
    v_pk_fma_f32 v[50:51], v[40:41], v[56:57], v[94:95] op_sel:[0,1,0] op_sel_hi:[1,1,1]
    v_pk_fma_f32 v[52:53], v[46:47], v[56:57], v[142:143] op_sel:[0,1,0] op_sel_hi:[1,1,1] neg_lo:[0,1,0] neg_hi:[0,1,0]
    v_pk_fma_f32 v[54:55], v[44:45], v[56:57], v[158:159] op_sel:[0,1,0] op_sel_hi:[1,1,1]
    v_pk_fma_f32 v[40:41], v[40:41], v[56:57], v[48:49] op_sel:[0,0,0] op_sel_hi:[1,0,1]
    v_pk_fma_f32 v[42:43], v[42:43], v[56:57], v[50:51] op_sel:[0,0,0] op_sel_hi:[1,0,1]
    v_pk_fma_f32 v[44:45], v[44:45], v[56:57], v[52:53] op_sel:[0,0,0] op_sel_hi:[1,0,1]
    v_pk_fma_f32 v[46:47], v[46:47], v[56:57], v[54:55] op_sel:[0,0,0] op_sel_hi:[1,0,1]
    v_pk_fma_f32 v[48:49], v[42:43], v[56:57], v[96:97] op_sel:[0,1,0] op_sel_hi:[1,1,1] neg_lo:[0,1,0] neg_hi:[0,1,0]
    v_pk_fma_f32 v[50:51], v[40:41], v[56:57], v[112:113] op_sel:[0,1,0] op_sel_hi:[1,1,1]
    v_pk_fma_f32 v[52:53], v[46:47], v[56:57], v[160:161] op_sel:[0,1,0] op_sel_hi:[1,1,1] neg_lo:[0,1,0] neg_hi:[0,1,0]
    v_pk_fma_f32 v[54:55], v[44:45], v[56:57], v[176:177] op_sel:[0,1,0] op_sel_hi:[1,1,1]
    v_pk_fma_f32 v[40:41], v[40:41], v[56:57], v[48:49] op_sel:[0,0,0] op_sel_hi:[1,0,1]
    v_pk_fma_f32 v[42:43], v[42:43], v[56:57], v[50:51] op_sel:[0,0,0] op_sel_hi:[1,0,1]
    v_pk_fma_f32 v[44:45], v[44:45], v[56:57], v[52:53] op_sel:[0,0,0] op_sel_hi:[1,0,1]
    v_pk_fma_f32 v[46:47], v[46:47], v[56:57], v[54:55] op_sel:[0,0,0] op_sel_hi:[1,0,1]
    v_pk_fma_f32 v[48:49], v[42:43], v[56:57], v[98:99] op_sel:[0,1,0] op_sel_hi:[1,1,1] neg_lo:[0,1,0] neg_hi:[0,1,0]
    v_pk_fma_f32 v[50:51], v[40:41], v[56:57], v[114:115] op_sel:[0,1,0] op_sel_hi:[1,1,1]
    v_pk_fma_f32 v[52:53], v[46:47], v[56:57], v[162:163] op_sel:[0,1,0] op_sel_hi:[1,1,1] neg_lo:[0,1,0] neg_hi:[0,1,0]
    v_pk_fma_f32 v[54:55], v[44:45], v[56:57], v[178:179] op_sel:[0,1,0] op_sel_hi:[1,1,1]
    v_pk_fma_f32 v[40:41], v[40:41], v[56:57], v[48:49] op_sel:[0,0,0] op_sel_hi:[1,0,1]
    v_pk_fma_f32 v[42:43], v[42:43], v[56:57], v[50:51] op_sel:[0,0,0] op_sel_hi:[1,0,1]
    v_pk_fma_f32 v[44:45], v[44:45], v[56:57], v[52:53] op_sel:[0,0,0] op_sel_hi:[1,0,1]
    v_pk_fma_f32 v[46:47], v[46:47], v[56:57], v[54:55] op_sel:[0,0,0] op_sel_hi:[1,0,1]
    v_pk_fma_f32 v[48:49], v[42:43], v[56:57], v[100:101] op_sel:[0,1,0] op_sel_hi:[1,1,1] neg_lo:[0,1,0] neg_hi:[0,1,0]
    v_pk_fma_f32 v[50:51], v[40:41], v[56:57], v[116:117] op_sel:[0,1,0] op_sel_hi:[1,1,1]
    v_pk_fma_f32 v[52:53], v[46:47], v[56:57], v[164:165] op_sel:[0,1,0] op_sel_hi:[1,1,1] neg_lo:[0,1,0] neg_hi:[0,1,0]
    v_pk_fma_f32 v[54:55], v[44:45], v[56:57], v[180:181] op_sel:[0,1,0] op_sel_hi:[1,1,1]
    v_pk_fma_f32 v[40:41], v[40:41], v[56:57], v[48:49] op_sel:[0,0,0] op_sel_hi:[1,0,1]
    v_pk_fma_f32 v[42:43], v[42:43], v[56:57], v[50:51] op_sel:[0,0,0] op_sel_hi:[1,0,1]
    v_pk_fma_f32 v[44:45], v[44:45], v[56:57], v[52:53] op_sel:[0,0,0] op_sel_hi:[1,0,1]
    v_pk_fma_f32 v[46:47], v[46:47], v[56:57], v[54:55] op_sel:[0,0,0] op_sel_hi:[1,0,1]
    v_pk_fma_f32 v[48:49], v[42:43], v[56:57], v[102:103] op_sel:[0,1,0] op_sel_hi:[1,1,1] neg_lo:[0,1,0] neg_hi:[0,1,0]
    v_pk_fma_f32 v[50:51], v[40:41], v[56:57], v[118:119] op_sel:[0,1,0] op_sel_hi:[1,1,1]
    v_pk_fma_f32 v[52:53], v[46:47], v[56:57], v[166:167] op_sel:[0,1,0] op_sel_hi:[1,1,1] neg_lo:[0,1,0] neg_hi:[0,1,0]
    v_pk_fma_f32 v[54:55], v[44:45], v[56:57], v[182:183] op_sel:[0,1,0] op_sel_hi:[1,1,1]
    v_pk_fma_f32 v[40:41], v[40:41], v[56:57], v[48:49] op_sel:[0,0,0] op_sel_hi:[1,0,1]
    v_pk_fma_f32 v[42:43], v[42:43], v[56:57], v[50:51] op_sel:[0,0,0] op_sel_hi:[1,0,1]
    v_pk_fma_f32 v[44:45], v[44:45], v[56:57], v[52:53] op_sel:[0,0,0] op_sel_hi:[1,0,1]
    v_pk_fma_f32 v[46:47], v[46:47], v[56:57], v[54:55] op_sel:[0,0,0] op_sel_hi:[1,0,1]
    v_pk_fma_f32 v[48:49], v[42:43], v[56:57], v[104:105] op_sel:[0,1,0] op_sel_hi:[1,1,1] neg_lo:[0,1,0] neg_hi:[0,1,0]
    v_pk_fma_f32 v[50:51], v[40:41], v[56:57], v[120:121] op_sel:[0,1,0] op_sel_hi:[1,1,1]
    v_pk_fma_f32 v[52:53], v[46:47], v[56:57], v[168:169] op_sel:[0,1,0] op_sel_hi:[1,1,1] neg_lo:[0,1,0] neg_hi:[0,1,0]
    v_pk_fma_f32 v[54:55], v[44:45], v[56:57], v[184:185] op_sel:[0,1,0] op_sel_hi:[1,1,1]
    v_pk_fma_f32 v[40:41], v[40:41], v[56:57], v[48:49] op_sel:[0,0,0] op_sel_hi:[1,0,1]
    v_pk_fma_f32 v[42:43], v[42:43], v[56:57], v[50:51] op_sel:[0,0,0] op_sel_hi:[1,0,1]
    v_pk_fma_f32 v[44:45], v[44:45], v[56:57], v[52:53] op_sel:[0,0,0] op_sel_hi:[1,0,1]
    v_pk_fma_f32 v[46:47], v[46:47], v[56:57], v[54:55] op_sel:[0,0,0] op_sel_hi:[1,0,1]
    v_pk_fma_f32 v[48:49], v[42:43], v[56:57], v[106:107] op_sel:[0,1,0] op_sel_hi:[1,1,1] neg_lo:[0,1,0] neg_hi:[0,1,0]
    v_pk_fma_f32 v[50:51], v[40:41], v[56:57], v[122:123] op_sel:[0,1,0] op_sel_hi:[1,1,1]
    v_pk_fma_f32 v[52:53], v[46:47], v[56:57], v[170:171] op_sel:[0,1,0] op_sel_hi:[1,1,1] neg_lo:[0,1,0] neg_hi:[0,1,0]
    v_pk_fma_f32 v[54:55], v[44:45], v[56:57], v[186:187] op_sel:[0,1,0] op_sel_hi:[1,1,1]
    v_pk_fma_f32 v[40:41], v[40:41], v[56:57], v[48:49] op_sel:[0,0,0] op_sel_hi:[1,0,1]
    v_pk_fma_f32 v[42:43], v[42:43], v[56:57], v[50:51] op_sel:[0,0,0] op_sel_hi:[1,0,1]
    v_pk_fma_f32 v[44:45], v[44:45], v[56:57], v[52:53] op_sel:[0,0,0] op_sel_hi:[1,0,1]
    v_pk_fma_f32 v[46:47], v[46:47], v[56:57], v[54:55] op_sel:[0,0,0] op_sel_hi:[1,0,1]
    v_pk_fma_f32 v[48:49], v[42:43], v[56:57], v[108:109] op_sel:[0,1,0] op_sel_hi:[1,1,1] neg_lo:[0,1,0] neg_hi:[0,1,0]
    v_pk_fma_f32 v[50:51], v[40:41], v[56:57], v[124:125] op_sel:[0,1,0] op_sel_hi:[1,1,1]
    v_pk_fma_f32 v[52:53], v[46:47], v[56:57], v[172:173] op_sel:[0,1,0] op_sel_hi:[1,1,1] neg_lo:[0,1,0] neg_hi:[0,1,0]
    v_pk_fma_f32 v[54:55], v[44:45], v[56:57], v[188:189] op_sel:[0,1,0] op_sel_hi:[1,1,1]
    v_pk_fma_f32 v[40:41], v[40:41], v[56:57], v[48:49] op_sel:[0,0,0] op_sel_hi:[1,0,1]
    v_pk_fma_f32 v[42:43], v[42:43], v[56:57], v[50:51] op_sel:[0,0,0] op_sel_hi:[1,0,1]
    v_pk_fma_f32 v[44:45], v[44:45], v[56:57], v[52:53] op_sel:[0,0,0] op_sel_hi:[1,0,1]
    v_pk_fma_f32 v[46:47], v[46:47], v[56:57], v[54:55] op_sel:[0,0,0] op_sel_hi:[1,0,1]
    v_pk_fma_f32 v[48:49], v[42:43], v[56:57], v[110:111] op_sel:[0,1,0] op_sel_hi:[1,1,1] neg_lo:[0,1,0] neg_hi:[0,1,0]
    v_pk_fma_f32 v[50:51], v[40:41], v[56:57], v[126:127] op_sel:[0,1,0] op_sel_hi:[1,1,1]
    v_pk_fma_f32 v[52:53], v[46:47], v[56:57], v[174:175] op_sel:[0,1,0] op_sel_hi:[1,1,1] neg_lo:[0,1,0] neg_hi:[0,1,0]
    v_pk_fma_f32 v[54:55], v[44:45], v[56:57], v[190:191] op_sel:[0,1,0] op_sel_hi:[1,1,1]
    v_pk_fma_f32 v[40:41], v[40:41], v[56:57], v[48:49] op_sel:[0,0,0] op_sel_hi:[1,0,1]
    v_pk_fma_f32 v[42:43], v[42:43], v[56:57], v[50:51] op_sel:[0,0,0] op_sel_hi:[1,0,1]
    v_pk_fma_f32 v[44:45], v[44:45], v[56:57], v[52:53] op_sel:[0,0,0] op_sel_hi:[1,0,1]
    v_pk_fma_f32 v[46:47], v[46:47], v[56:57], v[54:55] op_sel:[0,0,0] op_sel_hi:[1,0,1]
    v_fma_f32 v14, -v21, v42, v41
    v_fma_f32 v15, v21, v40, v43
    v_fma_f32 v32, v20, v40, v14
    v_fma_f32 v33, v20, v42, v15
    v_fma_f32 v16, -v21, v46, v45
    v_fma_f32 v17, v21, v44, v47
    v_fma_f32 v36, v20, v44, v16
    v_fma_f32 v37, v20, v46, v17
    v_mov_b32 v34, v32
    v_mov_b32 v35, v33
    v_mov_b32 v38, v36
    v_mov_b32 v39, v37
    s_nop 1
    v_permlane32_swap_b32 v32, v34
    v_permlane32_swap_b32 v33, v35
    v_permlane32_swap_b32 v36, v38
    v_permlane32_swap_b32 v37, v39
    s_nop 1
    v_fma_f32 v14, -v25, v33, v34
    v_fma_f32 v15, v25, v32, v35
    v_fma_f32 v40, v24, v32, v14
    v_fma_f32 v41, v24, v33, v15
    v_fma_f32 v14, -v25, v41, v36
    v_fma_f32 v15, v25, v40, v37
    v_fma_f32 v40, v24, v40, v14
    v_fma_f32 v41, v24, v41, v15
    v_fma_f32 v14, -v25, v41, v38
    v_fma_f32 v15, v25, v40, v39
    v_fma_f32 v40, v24, v40, v14
    v_fma_f32 v41, v24, v41, v15
    v_mov_b32 v42, s100
    v_mov_b32 v43, s101
    s_mov_b32 exec_hi, 0
    buffer_store_dwordx4 v[40:43], v29, s[20:23], s43 offen sc1
    s_mov_b64 exec, -1
    s_barrier
    s_mov_b32 s28, s74
    s_and_b32 s29, s75, 0xffff
    s_mov_b32 s30, 524288
    s_mov_b32 s31, 0x00020000
    s_mov_b32 s36, s76
    s_and_b32 s37, s77, 0xffff
    s_mov_b32 s38, 524288
    s_mov_b32 s39, 0x00020000
    s_lshl_b32 s58, s3, 8
    s_lshl_b32 s43, s53, 16
    s_add_u32 s58, s58, s43
    s_mov_b32 s50, 0x05040100
    s_mov_b32 s51, 0x07060302
    v_lshrrev_b32 v14, 3, v1
    v_mul_u32_u24 v14, 1024, v14
    v_and_b32 v15, 7, v1
    v_lshrrev_b32 v16, 4, v1
    v_xor_b32 v15, v15, v16
    v_lshlrev_b32 v15, 4, v15
    v_add_u32 v2, v14, v15
    v_xor_b32 v15, 64, v15
    v_add_u32 v3, v14, v15
    v_and_b32 v14, 31, v1
    v_lshrrev_b32 v15, 1, v14
    v_and_b32 v15, 7, v15
    v_lshrrev_b32 v16, 5, v1
    v_xor_b32 v15, v15, v16
    v_lshlrev_b32 v15, 4, v15
    v_lshl_add_u32 v14, v14, 7, v15
    v_add_u32 v6, s42, v14
    v_xor_b32 v7, 32, v6
    v_xor_b32 v8, 64, v6
    v_xor_b32 v9, 96, v6
    s_mov_b32 s32, s88
    s_and_b32 s33, s89, 0xffff
    s_mov_b32 s34, 5636096
    s_mov_b32 s35, 0x00020000
    s_mul_i32 s61, s3, 6
    s_cmp_eq_u32 s3, 3
    s_cselect_b32 s61, 17, s61
    s_lshl_b32 s61, s61, 18
    s_lshl_b32 s43, s52, 7
    s_add_u32 s61, s61, s43
    v_lshrrev_b32 v14, 3, v1
    v_mul_u32_u24 v14, 4096, v14
    v_and_b32 v15, 7, v1
    v_lshrrev_b32 v16, 2, v1
    v_and_b32 v16, 4, v16
    v_xor_b32 v15, v15, v16
    v_lshl_add_u32 v12, v15, 4, v14
    v_lshrrev_b32 v14, 5, v1
    v_lshlrev_b32 v14, 3, v14
    v_lshrrev_b32 v15, 2, v1
    v_and_b32 v15, 3, v15
    v_add_u32 v14, v14, v15
    v_lshlrev_b32 v14, 7, v14
    v_lshrrev_b32 v16, 4, v1
    v_and_b32 v16, 1, v16
    v_lshlrev_b32 v16, 1, v16
    v_lshrrev_b32 v17, 1, v1
    v_and_b32 v17, 1, v17
    v_add_u32 v16, v16, v17
    v_lshrrev_b32 v15, 1, v15
    v_lshlrev_b32 v15, 2, v15
    v_xor_b32 v16, v16, v15
    v_lshl_add_u32 v14, v16, 4, v14
    v_and_b32 v17, 1, v1
    v_lshl_add_u32 v14, v17, 3, v14
    v_add_u32 v10, s42, v14
    v_xor_b32 v11, 64, v10
    s_cmp_ge_u32 s3, 2
    s_cselect_b32 s63, 0x40000000, 0
    s_add_u32 s63, s63, s61
    v_pk_mul_f32 v[48:49], v[80:81], v[22:23] op_sel:[0,1] op_sel_hi:[1,1]
    v_pk_mul_f32 v[50:51], v[64:65], v[22:23] op_sel:[0,1] op_sel_hi:[1,1]
    v_pk_fma_f32 v[64:65], v[64:65], v[22:23], v[48:49] op_sel:[0,0,0] op_sel_hi:[1,0,1] neg_lo:[0,0,1] neg_hi:[0,0,1]
    v_pk_fma_f32 v[80:81], v[80:81], v[22:23], v[50:51] op_sel:[0,0,0] op_sel_hi:[1,0,1]
    v_pk_mul_f32 v[52:53], v[144:145], v[22:23] op_sel:[0,1] op_sel_hi:[1,1]
    v_pk_mul_f32 v[54:55], v[128:129], v[22:23] op_sel:[0,1] op_sel_hi:[1,1]
    v_pk_fma_f32 v[128:129], v[128:129], v[22:23], v[52:53] op_sel:[0,0,0] op_sel_hi:[1,0,1] neg_lo:[0,0,1] neg_hi:[0,0,1]
    v_pk_fma_f32 v[144:145], v[144:145], v[22:23], v[54:55] op_sel:[0,0,0] op_sel_hi:[1,0,1]
    v_fma_f32 v14, -v21, v80, v65
    v_fma_f32 v15, v21, v64, v81
    v_fma_f32 v65, v20, v64, v14
    v_fma_f32 v81, v20, v80, v15
    v_fma_f32 v16, -v21, v144, v129
    v_fma_f32 v17, v21, v128, v145
    v_fma_f32 v129, v20, v128, v16
    v_fma_f32 v145, v20, v144, v17
    v_pk_mul_f32 v[48:49], v[82:83], v[22:23] op_sel:[0,1] op_sel_hi:[1,1]
    v_pk_mul_f32 v[50:51], v[66:67], v[22:23] op_sel:[0,1] op_sel_hi:[1,1]
    v_pk_fma_f32 v[66:67], v[66:67], v[22:23], v[48:49] op_sel:[0,0,0] op_sel_hi:[1,0,1] neg_lo:[0,0,1] neg_hi:[0,0,1]
    v_pk_fma_f32 v[82:83], v[82:83], v[22:23], v[50:51] op_sel:[0,0,0] op_sel_hi:[1,0,1]
    v_pk_mul_f32 v[52:53], v[146:147], v[22:23] op_sel:[0,1] op_sel_hi:[1,1]
    v_pk_mul_f32 v[54:55], v[130:131], v[22:23] op_sel:[0,1] op_sel_hi:[1,1]
    v_pk_fma_f32 v[130:131], v[130:131], v[22:23], v[52:53] op_sel:[0,0,0] op_sel_hi:[1,0,1] neg_lo:[0,0,1] neg_hi:[0,0,1]
    v_pk_fma_f32 v[146:147], v[146:147], v[22:23], v[54:55] op_sel:[0,0,0] op_sel_hi:[1,0,1]
    v_fma_f32 v14, -v21, v82, v67
    v_fma_f32 v15, v21, v66, v83
    v_fma_f32 v67, v20, v66, v14
    v_fma_f32 v83, v20, v82, v15
    v_fma_f32 v16, -v21, v146, v131
    v_fma_f32 v17, v21, v130, v147
    v_fma_f32 v131, v20, v130, v16
    v_fma_f32 v147, v20, v146, v17
    v_pk_mul_f32 v[48:49], v[84:85], v[22:23] op_sel:[0,1] op_sel_hi:[1,1]
    v_pk_mul_f32 v[50:51], v[68:69], v[22:23] op_sel:[0,1] op_sel_hi:[1,1]
    v_pk_fma_f32 v[68:69], v[68:69], v[22:23], v[48:49] op_sel:[0,0,0] op_sel_hi:[1,0,1] neg_lo:[0,0,1] neg_hi:[0,0,1]
    v_pk_fma_f32 v[84:85], v[84:85], v[22:23], v[50:51] op_sel:[0,0,0] op_sel_hi:[1,0,1]
    v_pk_mul_f32 v[52:53], v[148:149], v[22:23] op_sel:[0,1] op_sel_hi:[1,1]
    v_pk_mul_f32 v[54:55], v[132:133], v[22:23] op_sel:[0,1] op_sel_hi:[1,1]
    v_pk_fma_f32 v[132:133], v[132:133], v[22:23], v[52:53] op_sel:[0,0,0] op_sel_hi:[1,0,1] neg_lo:[0,0,1] neg_hi:[0,0,1]
    v_pk_fma_f32 v[148:149], v[148:149], v[22:23], v[54:55] op_sel:[0,0,0] op_sel_hi:[1,0,1]
    v_fma_f32 v14, -v21, v84, v69
    v_fma_f32 v15, v21, v68, v85
    v_fma_f32 v69, v20, v68, v14
    v_fma_f32 v85, v20, v84, v15
    v_fma_f32 v16, -v21, v148, v133
    v_fma_f32 v17, v21, v132, v149
    v_fma_f32 v133, v20, v132, v16
    v_fma_f32 v149, v20, v148, v17
    v_pk_mul_f32 v[48:49], v[86:87], v[22:23] op_sel:[0,1] op_sel_hi:[1,1]
    v_pk_mul_f32 v[50:51], v[70:71], v[22:23] op_sel:[0,1] op_sel_hi:[1,1]
    v_pk_fma_f32 v[70:71], v[70:71], v[22:23], v[48:49] op_sel:[0,0,0] op_sel_hi:[1,0,1] neg_lo:[0,0,1] neg_hi:[0,0,1]
    v_pk_fma_f32 v[86:87], v[86:87], v[22:23], v[50:51] op_sel:[0,0,0] op_sel_hi:[1,0,1]
    v_pk_mul_f32 v[52:53], v[150:151], v[22:23] op_sel:[0,1] op_sel_hi:[1,1]
    v_pk_mul_f32 v[54:55], v[134:135], v[22:23] op_sel:[0,1] op_sel_hi:[1,1]
    v_pk_fma_f32 v[134:135], v[134:135], v[22:23], v[52:53] op_sel:[0,0,0] op_sel_hi:[1,0,1] neg_lo:[0,0,1] neg_hi:[0,0,1]
    v_pk_fma_f32 v[150:151], v[150:151], v[22:23], v[54:55] op_sel:[0,0,0] op_sel_hi:[1,0,1]
    v_fma_f32 v14, -v21, v86, v71
    v_fma_f32 v15, v21, v70, v87
    v_fma_f32 v71, v20, v70, v14
    v_fma_f32 v87, v20, v86, v15
    v_fma_f32 v16, -v21, v150, v135
    v_fma_f32 v17, v21, v134, v151
    v_fma_f32 v135, v20, v134, v16
    v_fma_f32 v151, v20, v150, v17
    v_pk_mul_f32 v[48:49], v[88:89], v[22:23] op_sel:[0,1] op_sel_hi:[1,1]
    v_pk_mul_f32 v[50:51], v[72:73], v[22:23] op_sel:[0,1] op_sel_hi:[1,1]
    v_pk_fma_f32 v[72:73], v[72:73], v[22:23], v[48:49] op_sel:[0,0,0] op_sel_hi:[1,0,1] neg_lo:[0,0,1] neg_hi:[0,0,1]
    v_pk_fma_f32 v[88:89], v[88:89], v[22:23], v[50:51] op_sel:[0,0,0] op_sel_hi:[1,0,1]
    v_pk_mul_f32 v[52:53], v[152:153], v[22:23] op_sel:[0,1] op_sel_hi:[1,1]
    v_pk_mul_f32 v[54:55], v[136:137], v[22:23] op_sel:[0,1] op_sel_hi:[1,1]
    v_pk_fma_f32 v[136:137], v[136:137], v[22:23], v[52:53] op_sel:[0,0,0] op_sel_hi:[1,0,1] neg_lo:[0,0,1] neg_hi:[0,0,1]
    v_pk_fma_f32 v[152:153], v[152:153], v[22:23], v[54:55] op_sel:[0,0,0] op_sel_hi:[1,0,1]
    v_fma_f32 v14, -v21, v88, v73
    v_fma_f32 v15, v21, v72, v89
    v_fma_f32 v73, v20, v72, v14
    v_fma_f32 v89, v20, v88, v15
    v_fma_f32 v16, -v21, v152, v137
    v_fma_f32 v17, v21, v136, v153
    v_fma_f32 v137, v20, v136, v16
    v_fma_f32 v153, v20, v152, v17
    v_pk_mul_f32 v[48:49], v[90:91], v[22:23] op_sel:[0,1] op_sel_hi:[1,1]
    v_pk_mul_f32 v[50:51], v[74:75], v[22:23] op_sel:[0,1] op_sel_hi:[1,1]
    v_pk_fma_f32 v[74:75], v[74:75], v[22:23], v[48:49] op_sel:[0,0,0] op_sel_hi:[1,0,1] neg_lo:[0,0,1] neg_hi:[0,0,1]
    v_pk_fma_f32 v[90:91], v[90:91], v[22:23], v[50:51] op_sel:[0,0,0] op_sel_hi:[1,0,1]
    v_pk_mul_f32 v[52:53], v[154:155], v[22:23] op_sel:[0,1] op_sel_hi:[1,1]
    v_pk_mul_f32 v[54:55], v[138:139], v[22:23] op_sel:[0,1] op_sel_hi:[1,1]
    v_pk_fma_f32 v[138:139], v[138:139], v[22:23], v[52:53] op_sel:[0,0,0] op_sel_hi:[1,0,1] neg_lo:[0,0,1] neg_hi:[0,0,1]
    v_pk_fma_f32 v[154:155], v[154:155], v[22:23], v[54:55] op_sel:[0,0,0] op_sel_hi:[1,0,1]
    v_fma_f32 v14, -v21, v90, v75
    v_fma_f32 v15, v21, v74, v91
    v_fma_f32 v75, v20, v74, v14
    v_fma_f32 v91, v20, v90, v15
    v_fma_f32 v16, -v21, v154, v139
    v_fma_f32 v17, v21, v138, v155
    v_fma_f32 v139, v20, v138, v16
    v_fma_f32 v155, v20, v154, v17
    v_pk_mul_f32 v[48:49], v[92:93], v[22:23] op_sel:[0,1] op_sel_hi:[1,1]
    v_pk_mul_f32 v[50:51], v[76:77], v[22:23] op_sel:[0,1] op_sel_hi:[1,1]
    v_pk_fma_f32 v[76:77], v[76:77], v[22:23], v[48:49] op_sel:[0,0,0] op_sel_hi:[1,0,1] neg_lo:[0,0,1] neg_hi:[0,0,1]
    v_pk_fma_f32 v[92:93], v[92:93], v[22:23], v[50:51] op_sel:[0,0,0] op_sel_hi:[1,0,1]
    v_pk_mul_f32 v[52:53], v[156:157], v[22:23] op_sel:[0,1] op_sel_hi:[1,1]
    v_pk_mul_f32 v[54:55], v[140:141], v[22:23] op_sel:[0,1] op_sel_hi:[1,1]
    v_pk_fma_f32 v[140:141], v[140:141], v[22:23], v[52:53] op_sel:[0,0,0] op_sel_hi:[1,0,1] neg_lo:[0,0,1] neg_hi:[0,0,1]
    v_pk_fma_f32 v[156:157], v[156:157], v[22:23], v[54:55] op_sel:[0,0,0] op_sel_hi:[1,0,1]
    v_fma_f32 v14, -v21, v92, v77
    v_fma_f32 v15, v21, v76, v93
    v_fma_f32 v77, v20, v76, v14
    v_fma_f32 v93, v20, v92, v15
    v_fma_f32 v16, -v21, v156, v141
    v_fma_f32 v17, v21, v140, v157
    v_fma_f32 v141, v20, v140, v16
    v_fma_f32 v157, v20, v156, v17
    v_pk_mul_f32 v[48:49], v[94:95], v[22:23] op_sel:[0,1] op_sel_hi:[1,1]
    v_pk_mul_f32 v[50:51], v[78:79], v[22:23] op_sel:[0,1] op_sel_hi:[1,1]
    v_pk_fma_f32 v[78:79], v[78:79], v[22:23], v[48:49] op_sel:[0,0,0] op_sel_hi:[1,0,1] neg_lo:[0,0,1] neg_hi:[0,0,1]
    v_pk_fma_f32 v[94:95], v[94:95], v[22:23], v[50:51] op_sel:[0,0,0] op_sel_hi:[1,0,1]
    v_pk_mul_f32 v[52:53], v[158:159], v[22:23] op_sel:[0,1] op_sel_hi:[1,1]
    v_pk_mul_f32 v[54:55], v[142:143], v[22:23] op_sel:[0,1] op_sel_hi:[1,1]
    v_pk_fma_f32 v[142:143], v[142:143], v[22:23], v[52:53] op_sel:[0,0,0] op_sel_hi:[1,0,1] neg_lo:[0,0,1] neg_hi:[0,0,1]
    v_pk_fma_f32 v[158:159], v[158:159], v[22:23], v[54:55] op_sel:[0,0,0] op_sel_hi:[1,0,1]
    v_fma_f32 v14, -v21, v94, v79
    v_fma_f32 v15, v21, v78, v95
    v_fma_f32 v79, v20, v78, v14
    v_fma_f32 v95, v20, v94, v15
    v_fma_f32 v16, -v21, v158, v143
    v_fma_f32 v17, v21, v142, v159
    v_fma_f32 v143, v20, v142, v16
    v_fma_f32 v159, v20, v158, v17
    v_pk_mul_f32 v[48:49], v[112:113], v[22:23] op_sel:[0,1] op_sel_hi:[1,1]
    v_pk_mul_f32 v[50:51], v[96:97], v[22:23] op_sel:[0,1] op_sel_hi:[1,1]
    v_pk_fma_f32 v[96:97], v[96:97], v[22:23], v[48:49] op_sel:[0,0,0] op_sel_hi:[1,0,1] neg_lo:[0,0,1] neg_hi:[0,0,1]
    v_pk_fma_f32 v[112:113], v[112:113], v[22:23], v[50:51] op_sel:[0,0,0] op_sel_hi:[1,0,1]
    v_pk_mul_f32 v[52:53], v[176:177], v[22:23] op_sel:[0,1] op_sel_hi:[1,1]
    v_pk_mul_f32 v[54:55], v[160:161], v[22:23] op_sel:[0,1] op_sel_hi:[1,1]
    v_pk_fma_f32 v[160:161], v[160:161], v[22:23], v[52:53] op_sel:[0,0,0] op_sel_hi:[1,0,1] neg_lo:[0,0,1] neg_hi:[0,0,1]
    v_pk_fma_f32 v[176:177], v[176:177], v[22:23], v[54:55] op_sel:[0,0,0] op_sel_hi:[1,0,1]
    v_fma_f32 v14, -v21, v112, v97
    v_fma_f32 v15, v21, v96, v113
    v_fma_f32 v97, v20, v96, v14
    v_fma_f32 v113, v20, v112, v15
    v_fma_f32 v16, -v21, v176, v161
    v_fma_f32 v17, v21, v160, v177
    v_fma_f32 v161, v20, v160, v16
    v_fma_f32 v177, v20, v176, v17
    v_pk_mul_f32 v[48:49], v[114:115], v[22:23] op_sel:[0,1] op_sel_hi:[1,1]
    v_pk_mul_f32 v[50:51], v[98:99], v[22:23] op_sel:[0,1] op_sel_hi:[1,1]
    v_pk_fma_f32 v[98:99], v[98:99], v[22:23], v[48:49] op_sel:[0,0,0] op_sel_hi:[1,0,1] neg_lo:[0,0,1] neg_hi:[0,0,1]
    v_pk_fma_f32 v[114:115], v[114:115], v[22:23], v[50:51] op_sel:[0,0,0] op_sel_hi:[1,0,1]
    v_pk_mul_f32 v[52:53], v[178:179], v[22:23] op_sel:[0,1] op_sel_hi:[1,1]
    v_pk_mul_f32 v[54:55], v[162:163], v[22:23] op_sel:[0,1] op_sel_hi:[1,1]
    v_pk_fma_f32 v[162:163], v[162:163], v[22:23], v[52:53] op_sel:[0,0,0] op_sel_hi:[1,0,1] neg_lo:[0,0,1] neg_hi:[0,0,1]
    v_pk_fma_f32 v[178:179], v[178:179], v[22:23], v[54:55] op_sel:[0,0,0] op_sel_hi:[1,0,1]
    v_fma_f32 v14, -v21, v114, v99
    v_fma_f32 v15, v21, v98, v115
    v_fma_f32 v99, v20, v98, v14
    v_fma_f32 v115, v20, v114, v15
    v_fma_f32 v16, -v21, v178, v163
    v_fma_f32 v17, v21, v162, v179
    v_fma_f32 v163, v20, v162, v16
    v_fma_f32 v179, v20, v178, v17
    v_pk_mul_f32 v[48:49], v[116:117], v[22:23] op_sel:[0,1] op_sel_hi:[1,1]
    v_pk_mul_f32 v[50:51], v[100:101], v[22:23] op_sel:[0,1] op_sel_hi:[1,1]
    v_pk_fma_f32 v[100:101], v[100:101], v[22:23], v[48:49] op_sel:[0,0,0] op_sel_hi:[1,0,1] neg_lo:[0,0,1] neg_hi:[0,0,1]
    v_pk_fma_f32 v[116:117], v[116:117], v[22:23], v[50:51] op_sel:[0,0,0] op_sel_hi:[1,0,1]
    v_pk_mul_f32 v[52:53], v[180:181], v[22:23] op_sel:[0,1] op_sel_hi:[1,1]
    v_pk_mul_f32 v[54:55], v[164:165], v[22:23] op_sel:[0,1] op_sel_hi:[1,1]
    v_pk_fma_f32 v[164:165], v[164:165], v[22:23], v[52:53] op_sel:[0,0,0] op_sel_hi:[1,0,1] neg_lo:[0,0,1] neg_hi:[0,0,1]
    v_pk_fma_f32 v[180:181], v[180:181], v[22:23], v[54:55] op_sel:[0,0,0] op_sel_hi:[1,0,1]
    v_fma_f32 v14, -v21, v116, v101
    v_fma_f32 v15, v21, v100, v117
    v_fma_f32 v101, v20, v100, v14
    v_fma_f32 v117, v20, v116, v15
    v_fma_f32 v16, -v21, v180, v165
    v_fma_f32 v17, v21, v164, v181
    v_fma_f32 v165, v20, v164, v16
    v_fma_f32 v181, v20, v180, v17
    v_pk_mul_f32 v[48:49], v[118:119], v[22:23] op_sel:[0,1] op_sel_hi:[1,1]
    v_pk_mul_f32 v[50:51], v[102:103], v[22:23] op_sel:[0,1] op_sel_hi:[1,1]
    v_pk_fma_f32 v[102:103], v[102:103], v[22:23], v[48:49] op_sel:[0,0,0] op_sel_hi:[1,0,1] neg_lo:[0,0,1] neg_hi:[0,0,1]
    v_pk_fma_f32 v[118:119], v[118:119], v[22:23], v[50:51] op_sel:[0,0,0] op_sel_hi:[1,0,1]
    v_pk_mul_f32 v[52:53], v[182:183], v[22:23] op_sel:[0,1] op_sel_hi:[1,1]
    v_pk_mul_f32 v[54:55], v[166:167], v[22:23] op_sel:[0,1] op_sel_hi:[1,1]
    v_pk_fma_f32 v[166:167], v[166:167], v[22:23], v[52:53] op_sel:[0,0,0] op_sel_hi:[1,0,1] neg_lo:[0,0,1] neg_hi:[0,0,1]
    v_pk_fma_f32 v[182:183], v[182:183], v[22:23], v[54:55] op_sel:[0,0,0] op_sel_hi:[1,0,1]
    v_fma_f32 v14, -v21, v118, v103
    v_fma_f32 v15, v21, v102, v119
    v_fma_f32 v103, v20, v102, v14
    v_fma_f32 v119, v20, v118, v15
    v_fma_f32 v16, -v21, v182, v167
    v_fma_f32 v17, v21, v166, v183
    v_fma_f32 v167, v20, v166, v16
    v_fma_f32 v183, v20, v182, v17
    v_pk_mul_f32 v[48:49], v[120:121], v[22:23] op_sel:[0,1] op_sel_hi:[1,1]
    v_pk_mul_f32 v[50:51], v[104:105], v[22:23] op_sel:[0,1] op_sel_hi:[1,1]
    v_pk_fma_f32 v[104:105], v[104:105], v[22:23], v[48:49] op_sel:[0,0,0] op_sel_hi:[1,0,1] neg_lo:[0,0,1] neg_hi:[0,0,1]
    v_pk_fma_f32 v[120:121], v[120:121], v[22:23], v[50:51] op_sel:[0,0,0] op_sel_hi:[1,0,1]
    v_pk_mul_f32 v[52:53], v[184:185], v[22:23] op_sel:[0,1] op_sel_hi:[1,1]
    v_pk_mul_f32 v[54:55], v[168:169], v[22:23] op_sel:[0,1] op_sel_hi:[1,1]
    v_pk_fma_f32 v[168:169], v[168:169], v[22:23], v[52:53] op_sel:[0,0,0] op_sel_hi:[1,0,1] neg_lo:[0,0,1] neg_hi:[0,0,1]
    v_pk_fma_f32 v[184:185], v[184:185], v[22:23], v[54:55] op_sel:[0,0,0] op_sel_hi:[1,0,1]
    v_fma_f32 v14, -v21, v120, v105
    v_fma_f32 v15, v21, v104, v121
    v_fma_f32 v105, v20, v104, v14
    v_fma_f32 v121, v20, v120, v15
    v_fma_f32 v16, -v21, v184, v169
    v_fma_f32 v17, v21, v168, v185
    v_fma_f32 v169, v20, v168, v16
    v_fma_f32 v185, v20, v184, v17
    v_pk_mul_f32 v[48:49], v[122:123], v[22:23] op_sel:[0,1] op_sel_hi:[1,1]
    v_pk_mul_f32 v[50:51], v[106:107], v[22:23] op_sel:[0,1] op_sel_hi:[1,1]
    v_pk_fma_f32 v[106:107], v[106:107], v[22:23], v[48:49] op_sel:[0,0,0] op_sel_hi:[1,0,1] neg_lo:[0,0,1] neg_hi:[0,0,1]
    v_pk_fma_f32 v[122:123], v[122:123], v[22:23], v[50:51] op_sel:[0,0,0] op_sel_hi:[1,0,1]
    v_pk_mul_f32 v[52:53], v[186:187], v[22:23] op_sel:[0,1] op_sel_hi:[1,1]
    v_pk_mul_f32 v[54:55], v[170:171], v[22:23] op_sel:[0,1] op_sel_hi:[1,1]
    v_pk_fma_f32 v[170:171], v[170:171], v[22:23], v[52:53] op_sel:[0,0,0] op_sel_hi:[1,0,1] neg_lo:[0,0,1] neg_hi:[0,0,1]
    v_pk_fma_f32 v[186:187], v[186:187], v[22:23], v[54:55] op_sel:[0,0,0] op_sel_hi:[1,0,1]
    v_fma_f32 v14, -v21, v122, v107
    v_fma_f32 v15, v21, v106, v123
    v_fma_f32 v107, v20, v106, v14
    v_fma_f32 v123, v20, v122, v15
    v_fma_f32 v16, -v21, v186, v171
    v_fma_f32 v17, v21, v170, v187
    v_fma_f32 v171, v20, v170, v16
    v_fma_f32 v187, v20, v186, v17
    v_pk_mul_f32 v[48:49], v[124:125], v[22:23] op_sel:[0,1] op_sel_hi:[1,1]
    v_pk_mul_f32 v[50:51], v[108:109], v[22:23] op_sel:[0,1] op_sel_hi:[1,1]
    v_pk_fma_f32 v[108:109], v[108:109], v[22:23], v[48:49] op_sel:[0,0,0] op_sel_hi:[1,0,1] neg_lo:[0,0,1] neg_hi:[0,0,1]
    v_pk_fma_f32 v[124:125], v[124:125], v[22:23], v[50:51] op_sel:[0,0,0] op_sel_hi:[1,0,1]
    v_pk_mul_f32 v[52:53], v[188:189], v[22:23] op_sel:[0,1] op_sel_hi:[1,1]
    v_pk_mul_f32 v[54:55], v[172:173], v[22:23] op_sel:[0,1] op_sel_hi:[1,1]
    v_pk_fma_f32 v[172:173], v[172:173], v[22:23], v[52:53] op_sel:[0,0,0] op_sel_hi:[1,0,1] neg_lo:[0,0,1] neg_hi:[0,0,1]
    v_pk_fma_f32 v[188:189], v[188:189], v[22:23], v[54:55] op_sel:[0,0,0] op_sel_hi:[1,0,1]
    v_fma_f32 v14, -v21, v124, v109
    v_fma_f32 v15, v21, v108, v125
    v_fma_f32 v109, v20, v108, v14
    v_fma_f32 v125, v20, v124, v15
    v_fma_f32 v16, -v21, v188, v173
    v_fma_f32 v17, v21, v172, v189
    v_fma_f32 v173, v20, v172, v16
    v_fma_f32 v189, v20, v188, v17
    v_pk_mul_f32 v[48:49], v[126:127], v[22:23] op_sel:[0,1] op_sel_hi:[1,1]
    v_pk_mul_f32 v[50:51], v[110:111], v[22:23] op_sel:[0,1] op_sel_hi:[1,1]
    v_pk_fma_f32 v[110:111], v[110:111], v[22:23], v[48:49] op_sel:[0,0,0] op_sel_hi:[1,0,1] neg_lo:[0,0,1] neg_hi:[0,0,1]
    v_pk_fma_f32 v[126:127], v[126:127], v[22:23], v[50:51] op_sel:[0,0,0] op_sel_hi:[1,0,1]
    v_pk_mul_f32 v[52:53], v[190:191], v[22:23] op_sel:[0,1] op_sel_hi:[1,1]
    v_pk_mul_f32 v[54:55], v[174:175], v[22:23] op_sel:[0,1] op_sel_hi:[1,1]
    v_pk_fma_f32 v[174:175], v[174:175], v[22:23], v[52:53] op_sel:[0,0,0] op_sel_hi:[1,0,1] neg_lo:[0,0,1] neg_hi:[0,0,1]
    v_pk_fma_f32 v[190:191], v[190:191], v[22:23], v[54:55] op_sel:[0,0,0] op_sel_hi:[1,0,1]
    v_fma_f32 v14, -v21, v126, v111
    v_fma_f32 v15, v21, v110, v127
    v_fma_f32 v111, v20, v110, v14
    v_fma_f32 v127, v20, v126, v15
    v_fma_f32 v16, -v21, v190, v175
    v_fma_f32 v17, v21, v174, v191
    v_fma_f32 v175, v20, v174, v16
    v_fma_f32 v191, v20, v190, v17
    v_mov_b32 v44, v24
    v_mov_b32 v45, v25
    v_mul_f32 v14, v45, v45
    v_mul_f32 v15, v44, v45
    v_fma_f32 v44, v44, v44, -v14
    v_add_f32 v45, v15, v15
    v_mul_f32 v14, v45, v45
    v_mul_f32 v15, v44, v45
    v_fma_f32 v44, v44, v44, -v14
    v_add_f32 v45, v15, v15
    v_mov_b32 v42, 0
    v_mov_b32 v43, 0
    s_cmp_eq_u32 s55, 0
    s_cbranch_scc1 L_a_nocarry
    s_mov_b32 s60, 20000
    s_lshl_b32 s44, s55, 13
    s_sub_u32 s44, s44, 8192
L_aep:
    s_min_u32 s43, s44, 0
    buffer_load_dwordx4 v[192:195], v29, s[20:23], s43 offen sc1
    s_min_u32 s43, s44, 8192
    buffer_load_dwordx4 v[196:199], v29, s[20:23], s43 offen sc1
    s_min_u32 s43, s44, 16384
    buffer_load_dwordx4 v[200:203], v29, s[20:23], s43 offen sc1
    s_min_u32 s43, s44, 24576
    buffer_load_dwordx4 v[204:207], v29, s[20:23], s43 offen sc1
    s_min_u32 s43, s44, 32768
    buffer_load_dwordx4 v[208:211], v29, s[20:23], s43 offen sc1
    s_min_u32 s43, s44, 40960
    buffer_load_dwordx4 v[212:215], v29, s[20:23], s43 offen sc1
    s_min_u32 s43, s44, 49152
    buffer_load_dwordx4 v[216:219], v29, s[20:23], s43 offen sc1
    s_min_u32 s43, s44, 57344
    buffer_load_dwordx4 v[220:223], v29, s[20:23], s43 offen sc1
    s_min_u32 s43, s44, 65536
    buffer_load_dwordx4 v[224:227], v29, s[20:23], s43 offen sc1
    s_min_u32 s43, s44, 73728
    buffer_load_dwordx4 v[228:231], v29, s[20:23], s43 offen sc1
    s_min_u32 s43, s44, 81920
    buffer_load_dwordx4 v[232:235], v29, s[20:23], s43 offen sc1
    s_min_u32 s43, s44, 90112
    buffer_load_dwordx4 v[236:239], v29, s[20:23], s43 offen sc1
    s_min_u32 s43, s44, 98304
    buffer_load_dwordx4 v[240:243], v29, s[20:23], s43 offen sc1
    s_min_u32 s43, s44, 106496
    buffer_load_dwordx4 v[244:247], v29, s[20:23], s43 offen sc1
    s_min_u32 s43, s44, 114688
    buffer_load_dwordx4 v[248:251], v29, s[20:23], s43 offen sc1
    s_waitcnt vmcnt(0)
    v_cmp_ne_u64 vcc, s[100:101], v[194:195]
    v_cmp_ne_u64 s[48:49], s[100:101], v[198:199]
    s_or_b64 vcc, vcc, s[48:49]
    v_cmp_ne_u64 s[48:49], s[100:101], v[202:203]
    s_or_b64 vcc, vcc, s[48:49]
    v_cmp_ne_u64 s[48:49], s[100:101], v[206:207]
    s_or_b64 vcc, vcc, s[48:49]
    v_cmp_ne_u64 s[48:49], s[100:101], v[210:211]
    s_or_b64 vcc, vcc, s[48:49]
    v_cmp_ne_u64 s[48:49], s[100:101], v[214:215]
    s_or_b64 vcc, vcc, s[48:49]
    v_cmp_ne_u64 s[48:49], s[100:101], v[218:219]
    s_or_b64 vcc, vcc, s[48:49]
    v_cmp_ne_u64 s[48:49], s[100:101], v[222:223]
    s_or_b64 vcc, vcc, s[48:49]
    v_cmp_ne_u64 s[48:49], s[100:101], v[226:227]
    s_or_b64 vcc, vcc, s[48:49]
    v_cmp_ne_u64 s[48:49], s[100:101], v[230:231]
    s_or_b64 vcc, vcc, s[48:49]
    v_cmp_ne_u64 s[48:49], s[100:101], v[234:235]
    s_or_b64 vcc, vcc, s[48:49]
    v_cmp_ne_u64 s[48:49], s[100:101], v[238:239]
    s_or_b64 vcc, vcc, s[48:49]
    v_cmp_ne_u64 s[48:49], s[100:101], v[242:243]
    s_or_b64 vcc, vcc, s[48:49]
    v_cmp_ne_u64 s[48:49], s[100:101], v[246:247]
    s_or_b64 vcc, vcc, s[48:49]
    v_cmp_ne_u64 s[48:49], s[100:101], v[250:251]
    s_or_b64 vcc, vcc, s[48:49]
    s_cbranch_vccz L_aepd
    s_sub_u32 s60, s60, 1
    s_cmp_lg_u32 s60, 0
    s_cbranch_scc1 L_aep
L_aepd:
    s_cmp_le_u32 s55, 0
    s_cbranch_scc1 L_a_nocarry
    v_fma_f32 v14, -v45, v43, v192
    v_fma_f32 v15, v45, v42, v193
    v_fma_f32 v42, v44, v42, v14
    v_fma_f32 v43, v44, v43, v15
    s_cmp_le_u32 s55, 1
    s_cbranch_scc1 L_a_nocarry
    v_fma_f32 v14, -v45, v43, v196
    v_fma_f32 v15, v45, v42, v197
    v_fma_f32 v42, v44, v42, v14
    v_fma_f32 v43, v44, v43, v15
    s_cmp_le_u32 s55, 2
    s_cbranch_scc1 L_a_nocarry
    v_fma_f32 v14, -v45, v43, v200
    v_fma_f32 v15, v45, v42, v201
    v_fma_f32 v42, v44, v42, v14
    v_fma_f32 v43, v44, v43, v15
    s_cmp_le_u32 s55, 3
    s_cbranch_scc1 L_a_nocarry
    v_fma_f32 v14, -v45, v43, v204
    v_fma_f32 v15, v45, v42, v205
    v_fma_f32 v42, v44, v42, v14
    v_fma_f32 v43, v44, v43, v15
    s_cmp_le_u32 s55, 4
    s_cbranch_scc1 L_a_nocarry
    v_fma_f32 v14, -v45, v43, v208
    v_fma_f32 v15, v45, v42, v209
    v_fma_f32 v42, v44, v42, v14
    v_fma_f32 v43, v44, v43, v15
    s_cmp_le_u32 s55, 5
    s_cbranch_scc1 L_a_nocarry
    v_fma_f32 v14, -v45, v43, v212
    v_fma_f32 v15, v45, v42, v213
    v_fma_f32 v42, v44, v42, v14
    v_fma_f32 v43, v44, v43, v15
    s_cmp_le_u32 s55, 6
    s_cbranch_scc1 L_a_nocarry
    v_fma_f32 v14, -v45, v43, v216
    v_fma_f32 v15, v45, v42, v217
    v_fma_f32 v42, v44, v42, v14
    v_fma_f32 v43, v44, v43, v15
    s_cmp_le_u32 s55, 7
    s_cbranch_scc1 L_a_nocarry
    v_fma_f32 v14, -v45, v43, v220
    v_fma_f32 v15, v45, v42, v221
    v_fma_f32 v42, v44, v42, v14
    v_fma_f32 v43, v44, v43, v15
    s_cmp_le_u32 s55, 8
    s_cbranch_scc1 L_a_nocarry
    v_fma_f32 v14, -v45, v43, v224
    v_fma_f32 v15, v45, v42, v225
    v_fma_f32 v42, v44, v42, v14
    v_fma_f32 v43, v44, v43, v15
    s_cmp_le_u32 s55, 9
    s_cbranch_scc1 L_a_nocarry
    v_fma_f32 v14, -v45, v43, v228
    v_fma_f32 v15, v45, v42, v229
    v_fma_f32 v42, v44, v42, v14
    v_fma_f32 v43, v44, v43, v15
    s_cmp_le_u32 s55, 10
    s_cbranch_scc1 L_a_nocarry
    v_fma_f32 v14, -v45, v43, v232
    v_fma_f32 v15, v45, v42, v233
    v_fma_f32 v42, v44, v42, v14
    v_fma_f32 v43, v44, v43, v15
    s_cmp_le_u32 s55, 11
    s_cbranch_scc1 L_a_nocarry
    v_fma_f32 v14, -v45, v43, v236
    v_fma_f32 v15, v45, v42, v237
    v_fma_f32 v42, v44, v42, v14
    v_fma_f32 v43, v44, v43, v15
    s_cmp_le_u32 s55, 12
    s_cbranch_scc1 L_a_nocarry
    v_fma_f32 v14, -v45, v43, v240
    v_fma_f32 v15, v45, v42, v241
    v_fma_f32 v42, v44, v42, v14
    v_fma_f32 v43, v44, v43, v15
    s_cmp_le_u32 s55, 13
    s_cbranch_scc1 L_a_nocarry
    v_fma_f32 v14, -v45, v43, v244
    v_fma_f32 v15, v45, v42, v245
    v_fma_f32 v42, v44, v42, v14
    v_fma_f32 v43, v44, v43, v15
    s_cmp_le_u32 s55, 14
    s_cbranch_scc1 L_a_nocarry
    v_fma_f32 v14, -v45, v43, v248
    v_fma_f32 v15, v45, v42, v249
    v_fma_f32 v42, v44, v42, v14
    v_fma_f32 v43, v44, v43, v15
L_a_nocarry:
    v_fma_f32 v14, -v25, v43, v32
    v_fma_f32 v15, v25, v42, v33
    v_fma_f32 v46, v24, v42, v14
    v_fma_f32 v47, v24, v43, v15
    v_fma_f32 v14, -v25, v47, v34
    v_fma_f32 v15, v25, v46, v35
    v_fma_f32 v48, v24, v46, v14
    v_fma_f32 v49, v24, v47, v15
    v_fma_f32 v14, -v25, v49, v36
    v_fma_f32 v15, v25, v48, v37
    v_fma_f32 v50, v24, v48, v14
    v_fma_f32 v51, v24, v49, v15
    v_cmp_lt_u32 vcc, 31, v1
    s_nop 1
    v_cndmask_b32 v52, v42, v46, vcc
    v_cndmask_b32 v53, v43, v47, vcc
    v_cndmask_b32 v54, v48, v50, vcc
    v_cndmask_b32 v55, v49, v51, vcc
    v_mul_f32 v14, v23, v53
    v_mul_f32 v15, v23, v52
    v_fma_f32 v33, v22, v52, -v14
    v_fma_f32 v35, v22, v53, v15
    v_mul_f32 v14, v23, v55
    v_mul_f32 v15, v23, v54
    v_fma_f32 v37, v22, v54, -v14
    v_fma_f32 v39, v22, v55, v15
    s_add_u32 s24, s98, 8388608
    s_addc_u32 s25, s99, 0
    s_and_b32 s25, s25, 0xffff
    s_mov_b32 s26, 4194304
    s_mov_b32 s27, 0x00020000
    v_lshrrev_b32 v14, 5, v1
    v_lshlrev_b32 v29, 2, v30
    v_lshl_add_u32 v29, v14, 16, v29
    s_lshl_b32 s43, s55, 18
    v_pk_fma_f32 v[64:65], v[60:61], v[34:35], v[64:65] op_sel:[0,1,0] op_sel_hi:[1,1,1] neg_lo:[0,1,0] neg_hi:[0,1,0]
    v_pk_fma_f32 v[80:81], v[60:61], v[32:33], v[80:81] op_sel:[0,1,0] op_sel_hi:[1,1,1]
    v_pk_fma_f32 v[128:129], v[60:61], v[38:39], v[128:129] op_sel:[0,1,0] op_sel_hi:[1,1,1] neg_lo:[0,1,0] neg_hi:[0,1,0]
    v_pk_fma_f32 v[144:145], v[60:61], v[36:37], v[144:145] op_sel:[0,1,0] op_sel_hi:[1,1,1]
    v_pk_fma_f32 v[64:65], v[58:59], v[32:33], v[64:65] op_sel:[0,1,0] op_sel_hi:[1,1,1]
    s_add_u32 m0, s42, 0
    s_add_u32 s59, s61, 0
    buffer_load_dwordx4 v12, s[32:35], s59 offen lds
    v_pk_fma_f32 v[80:81], v[58:59], v[34:35], v[80:81] op_sel:[0,1,0] op_sel_hi:[1,1,1]
    v_pk_fma_f32 v[128:129], v[58:59], v[36:37], v[128:129] op_sel:[0,1,0] op_sel_hi:[1,1,1]
    v_pk_fma_f32 v[144:145], v[58:59], v[38:39], v[144:145] op_sel:[0,1,0] op_sel_hi:[1,1,1]
    v_pk_fma_f32 v[66:67], v[60:61], v[80:81], v[66:67] op_sel:[0,1,0] op_sel_hi:[1,1,1] neg_lo:[0,1,0] neg_hi:[0,1,0]
    v_pk_fma_f32 v[82:83], v[60:61], v[64:65], v[82:83] op_sel:[0,1,0] op_sel_hi:[1,1,1]
    s_add_u32 m0, s42, 1024
    s_add_u32 s59, s61, 32768
    buffer_load_dwordx4 v12, s[32:35], s59 offen lds
    v_pk_fma_f32 v[130:131], v[60:61], v[144:145], v[130:131] op_sel:[0,1,0] op_sel_hi:[1,1,1] neg_lo:[0,1,0] neg_hi:[0,1,0]
    v_pk_fma_f32 v[146:147], v[60:61], v[128:129], v[146:147] op_sel:[0,1,0] op_sel_hi:[1,1,1]
    v_pk_fma_f32 v[66:67], v[58:59], v[64:65], v[66:67] op_sel:[0,1,0] op_sel_hi:[1,1,1]
    v_pk_fma_f32 v[82:83], v[58:59], v[80:81], v[82:83] op_sel:[0,1,0] op_sel_hi:[1,1,1]
    v_pk_fma_f32 v[130:131], v[58:59], v[128:129], v[130:131] op_sel:[0,1,0] op_sel_hi:[1,1,1]
    s_add_u32 m0, s42, 2048
    s_add_u32 s59, s61, 65536
    buffer_load_dwordx4 v12, s[32:35], s59 offen lds
    v_pk_fma_f32 v[146:147], v[58:59], v[144:145], v[146:147] op_sel:[0,1,0] op_sel_hi:[1,1,1]
    s_add_u32 s44, s43, 0
    v_cvt_pk_bf16_f32 v40, v64, -v80
    buffer_store_dword v40, v29, s[24:27], s44 offen offset:0 sc1
    v_cvt_pk_bf16_f32 v41, v65, -v81
    s_add_u32 m0, s42, 3072
    s_add_u32 s59, s61, 98304
    buffer_load_dwordx4 v12, s[32:35], s59 offen lds
    buffer_store_dword v41, v29, s[24:27], s44 offen offset:2048 sc1
    s_add_u32 s45, s43, 131072
    v_cvt_pk_bf16_f32 v42, v128, -v144
    buffer_store_dword v42, v29, s[24:27], s45 offen offset:0 sc1
    v_cvt_pk_bf16_f32 v43, v129, -v145
    s_add_u32 m0, s42, 4096
    s_add_u32 s59, s61, 131072
    buffer_load_dwordx4 v12, s[32:35], s59 offen lds
    buffer_store_dword v43, v29, s[24:27], s45 offen offset:2048 sc1
    v_pk_fma_f32 v[68:69], v[60:61], v[82:83], v[68:69] op_sel:[0,1,0] op_sel_hi:[1,1,1] neg_lo:[0,1,0] neg_hi:[0,1,0]
    v_pk_fma_f32 v[84:85], v[60:61], v[66:67], v[84:85] op_sel:[0,1,0] op_sel_hi:[1,1,1]
    v_pk_fma_f32 v[132:133], v[60:61], v[146:147], v[132:133] op_sel:[0,1,0] op_sel_hi:[1,1,1] neg_lo:[0,1,0] neg_hi:[0,1,0]
    v_pk_fma_f32 v[148:149], v[60:61], v[130:131], v[148:149] op_sel:[0,1,0] op_sel_hi:[1,1,1]
    s_add_u32 m0, s42, 5120
    s_add_u32 s59, s61, 163840
    buffer_load_dwordx4 v12, s[32:35], s59 offen lds
    v_pk_fma_f32 v[68:69], v[58:59], v[66:67], v[68:69] op_sel:[0,1,0] op_sel_hi:[1,1,1]
    v_pk_fma_f32 v[84:85], v[58:59], v[82:83], v[84:85] op_sel:[0,1,0] op_sel_hi:[1,1,1]
    v_pk_fma_f32 v[132:133], v[58:59], v[130:131], v[132:133] op_sel:[0,1,0] op_sel_hi:[1,1,1]
    v_pk_fma_f32 v[148:149], v[58:59], v[146:147], v[148:149] op_sel:[0,1,0] op_sel_hi:[1,1,1]
    s_add_u32 s44, s43, 4096
    v_cvt_pk_bf16_f32 v44, v66, -v82
    s_add_u32 m0, s42, 6144
    s_add_u32 s59, s61, 196608
    buffer_load_dwordx4 v12, s[32:35], s59 offen lds
    buffer_store_dword v44, v29, s[24:27], s44 offen offset:0 sc1
    v_cvt_pk_bf16_f32 v45, v67, -v83
    buffer_store_dword v45, v29, s[24:27], s44 offen offset:2048 sc1
    s_add_u32 s45, s43, 135168
    v_cvt_pk_bf16_f32 v46, v130, -v146
    s_add_u32 m0, s42, 7168
    s_add_u32 s59, s61, 229376
    buffer_load_dwordx4 v12, s[32:35], s59 offen lds
    buffer_store_dword v46, v29, s[24:27], s45 offen offset:0 sc1
    v_cvt_pk_bf16_f32 v47, v131, -v147
    buffer_store_dword v47, v29, s[24:27], s45 offen offset:2048 sc1
    v_pk_fma_f32 v[70:71], v[60:61], v[84:85], v[70:71] op_sel:[0,1,0] op_sel_hi:[1,1,1] neg_lo:[0,1,0] neg_hi:[0,1,0]
    v_pk_fma_f32 v[86:87], v[60:61], v[68:69], v[86:87] op_sel:[0,1,0] op_sel_hi:[1,1,1]
    s_add_u32 m0, s42, 8192
    s_add_u32 s59, s61, 262144
    buffer_load_dwordx4 v12, s[32:35], s59 offen lds
    v_pk_fma_f32 v[134:135], v[60:61], v[148:149], v[134:135] op_sel:[0,1,0] op_sel_hi:[1,1,1] neg_lo:[0,1,0] neg_hi:[0,1,0]
    v_pk_fma_f32 v[150:151], v[60:61], v[132:133], v[150:151] op_sel:[0,1,0] op_sel_hi:[1,1,1]
    v_pk_fma_f32 v[70:71], v[58:59], v[68:69], v[70:71] op_sel:[0,1,0] op_sel_hi:[1,1,1]
    v_pk_fma_f32 v[86:87], v[58:59], v[84:85], v[86:87] op_sel:[0,1,0] op_sel_hi:[1,1,1]
    v_pk_fma_f32 v[134:135], v[58:59], v[132:133], v[134:135] op_sel:[0,1,0] op_sel_hi:[1,1,1]
    s_add_u32 m0, s42, 9216
    s_add_u32 s59, s61, 294912
    buffer_load_dwordx4 v12, s[32:35], s59 offen lds
    v_pk_fma_f32 v[150:151], v[58:59], v[148:149], v[150:151] op_sel:[0,1,0] op_sel_hi:[1,1,1]
    s_add_u32 s44, s43, 8192
    v_cvt_pk_bf16_f32 v40, v68, -v84
    buffer_store_dword v40, v29, s[24:27], s44 offen offset:0 sc1
    v_cvt_pk_bf16_f32 v41, v69, -v85
    s_add_u32 m0, s42, 10240
    s_add_u32 s59, s61, 327680
    buffer_load_dwordx4 v12, s[32:35], s59 offen lds
    buffer_store_dword v41, v29, s[24:27], s44 offen offset:2048 sc1
    s_add_u32 s45, s43, 139264
    v_cvt_pk_bf16_f32 v42, v132, -v148
    buffer_store_dword v42, v29, s[24:27], s45 offen offset:0 sc1
    v_cvt_pk_bf16_f32 v43, v133, -v149
    s_add_u32 m0, s42, 11264
    s_add_u32 s59, s61, 360448
    buffer_load_dwordx4 v12, s[32:35], s59 offen lds
    buffer_store_dword v43, v29, s[24:27], s45 offen offset:2048 sc1
    v_pk_fma_f32 v[72:73], v[60:61], v[86:87], v[72:73] op_sel:[0,1,0] op_sel_hi:[1,1,1] neg_lo:[0,1,0] neg_hi:[0,1,0]
    v_pk_fma_f32 v[88:89], v[60:61], v[70:71], v[88:89] op_sel:[0,1,0] op_sel_hi:[1,1,1]
    v_pk_fma_f32 v[136:137], v[60:61], v[150:151], v[136:137] op_sel:[0,1,0] op_sel_hi:[1,1,1] neg_lo:[0,1,0] neg_hi:[0,1,0]
    v_pk_fma_f32 v[152:153], v[60:61], v[134:135], v[152:153] op_sel:[0,1,0] op_sel_hi:[1,1,1]
    s_add_u32 m0, s42, 12288
    s_add_u32 s59, s61, 393216
    buffer_load_dwordx4 v12, s[32:35], s59 offen lds
    v_pk_fma_f32 v[72:73], v[58:59], v[70:71], v[72:73] op_sel:[0,1,0] op_sel_hi:[1,1,1]
    v_pk_fma_f32 v[88:89], v[58:59], v[86:87], v[88:89] op_sel:[0,1,0] op_sel_hi:[1,1,1]
    v_pk_fma_f32 v[136:137], v[58:59], v[134:135], v[136:137] op_sel:[0,1,0] op_sel_hi:[1,1,1]
    v_pk_fma_f32 v[152:153], v[58:59], v[150:151], v[152:153] op_sel:[0,1,0] op_sel_hi:[1,1,1]
    s_add_u32 s44, s43, 12288
    v_cvt_pk_bf16_f32 v44, v70, -v86
    s_add_u32 m0, s42, 13312
    s_add_u32 s59, s61, 425984
    buffer_load_dwordx4 v12, s[32:35], s59 offen lds
    buffer_store_dword v44, v29, s[24:27], s44 offen offset:0 sc1
    v_cvt_pk_bf16_f32 v45, v71, -v87
    buffer_store_dword v45, v29, s[24:27], s44 offen offset:2048 sc1
    s_add_u32 s45, s43, 143360
    v_cvt_pk_bf16_f32 v46, v134, -v150
    s_add_u32 m0, s42, 14336
    s_add_u32 s59, s61, 458752
    buffer_load_dwordx4 v12, s[32:35], s59 offen lds
    buffer_store_dword v46, v29, s[24:27], s45 offen offset:0 sc1
    v_cvt_pk_bf16_f32 v47, v135, -v151
    buffer_store_dword v47, v29, s[24:27], s45 offen offset:2048 sc1
    v_pk_fma_f32 v[74:75], v[60:61], v[88:89], v[74:75] op_sel:[0,1,0] op_sel_hi:[1,1,1] neg_lo:[0,1,0] neg_hi:[0,1,0]
    v_pk_fma_f32 v[90:91], v[60:61], v[72:73], v[90:91] op_sel:[0,1,0] op_sel_hi:[1,1,1]
    s_add_u32 m0, s42, 15360
    s_add_u32 s59, s61, 491520
    buffer_load_dwordx4 v12, s[32:35], s59 offen lds
    v_pk_fma_f32 v[138:139], v[60:61], v[152:153], v[138:139] op_sel:[0,1,0] op_sel_hi:[1,1,1] neg_lo:[0,1,0] neg_hi:[0,1,0]
    v_pk_fma_f32 v[154:155], v[60:61], v[136:137], v[154:155] op_sel:[0,1,0] op_sel_hi:[1,1,1]
    v_pk_fma_f32 v[74:75], v[58:59], v[72:73], v[74:75] op_sel:[0,1,0] op_sel_hi:[1,1,1]
    v_pk_fma_f32 v[90:91], v[58:59], v[88:89], v[90:91] op_sel:[0,1,0] op_sel_hi:[1,1,1]
    v_pk_fma_f32 v[138:139], v[58:59], v[136:137], v[138:139] op_sel:[0,1,0] op_sel_hi:[1,1,1]
    v_pk_fma_f32 v[154:155], v[58:59], v[152:153], v[154:155] op_sel:[0,1,0] op_sel_hi:[1,1,1]
    s_add_u32 s44, s43, 16384
    v_cvt_pk_bf16_f32 v40, v72, -v88
    buffer_store_dword v40, v29, s[24:27], s44 offen offset:0 sc1
    v_cvt_pk_bf16_f32 v41, v73, -v89
    buffer_store_dword v41, v29, s[24:27], s44 offen offset:2048 sc1
    s_add_u32 s45, s43, 147456
    v_cvt_pk_bf16_f32 v42, v136, -v152
    buffer_store_dword v42, v29, s[24:27], s45 offen offset:0 sc1
    v_cvt_pk_bf16_f32 v43, v137, -v153
    buffer_store_dword v43, v29, s[24:27], s45 offen offset:2048 sc1
    v_pk_fma_f32 v[76:77], v[60:61], v[90:91], v[76:77] op_sel:[0,1,0] op_sel_hi:[1,1,1] neg_lo:[0,1,0] neg_hi:[0,1,0]
    v_pk_fma_f32 v[92:93], v[60:61], v[74:75], v[92:93] op_sel:[0,1,0] op_sel_hi:[1,1,1]
    v_pk_fma_f32 v[140:141], v[60:61], v[154:155], v[140:141] op_sel:[0,1,0] op_sel_hi:[1,1,1] neg_lo:[0,1,0] neg_hi:[0,1,0]
    v_pk_fma_f32 v[156:157], v[60:61], v[138:139], v[156:157] op_sel:[0,1,0] op_sel_hi:[1,1,1]
    v_pk_fma_f32 v[76:77], v[58:59], v[74:75], v[76:77] op_sel:[0,1,0] op_sel_hi:[1,1,1]
    v_pk_fma_f32 v[92:93], v[58:59], v[90:91], v[92:93] op_sel:[0,1,0] op_sel_hi:[1,1,1]
    v_pk_fma_f32 v[140:141], v[58:59], v[138:139], v[140:141] op_sel:[0,1,0] op_sel_hi:[1,1,1]
    v_pk_fma_f32 v[156:157], v[58:59], v[154:155], v[156:157] op_sel:[0,1,0] op_sel_hi:[1,1,1]
    s_add_u32 s44, s43, 20480
    v_cvt_pk_bf16_f32 v44, v74, -v90
    buffer_store_dword v44, v29, s[24:27], s44 offen offset:0 sc1
    v_cvt_pk_bf16_f32 v45, v75, -v91
    buffer_store_dword v45, v29, s[24:27], s44 offen offset:2048 sc1
    s_add_u32 s45, s43, 151552
    v_cvt_pk_bf16_f32 v46, v138, -v154
    buffer_store_dword v46, v29, s[24:27], s45 offen offset:0 sc1
    v_cvt_pk_bf16_f32 v47, v139, -v155
    buffer_store_dword v47, v29, s[24:27], s45 offen offset:2048 sc1
    v_pk_fma_f32 v[78:79], v[60:61], v[92:93], v[78:79] op_sel:[0,1,0] op_sel_hi:[1,1,1] neg_lo:[0,1,0] neg_hi:[0,1,0]
    v_pk_fma_f32 v[94:95], v[60:61], v[76:77], v[94:95] op_sel:[0,1,0] op_sel_hi:[1,1,1]
    v_pk_fma_f32 v[142:143], v[60:61], v[156:157], v[142:143] op_sel:[0,1,0] op_sel_hi:[1,1,1] neg_lo:[0,1,0] neg_hi:[0,1,0]
    v_pk_fma_f32 v[158:159], v[60:61], v[140:141], v[158:159] op_sel:[0,1,0] op_sel_hi:[1,1,1]
    v_pk_fma_f32 v[78:79], v[58:59], v[76:77], v[78:79] op_sel:[0,1,0] op_sel_hi:[1,1,1]
    v_pk_fma_f32 v[94:95], v[58:59], v[92:93], v[94:95] op_sel:[0,1,0] op_sel_hi:[1,1,1]
    v_pk_fma_f32 v[142:143], v[58:59], v[140:141], v[142:143] op_sel:[0,1,0] op_sel_hi:[1,1,1]
    v_pk_fma_f32 v[158:159], v[58:59], v[156:157], v[158:159] op_sel:[0,1,0] op_sel_hi:[1,1,1]
    s_add_u32 s44, s43, 24576
    v_cvt_pk_bf16_f32 v40, v76, -v92
    buffer_store_dword v40, v29, s[24:27], s44 offen offset:0 sc1
    v_cvt_pk_bf16_f32 v41, v77, -v93
    buffer_store_dword v41, v29, s[24:27], s44 offen offset:2048 sc1
    s_add_u32 s45, s43, 155648
    v_cvt_pk_bf16_f32 v42, v140, -v156
    buffer_store_dword v42, v29, s[24:27], s45 offen offset:0 sc1
    v_cvt_pk_bf16_f32 v43, v141, -v157
    buffer_store_dword v43, v29, s[24:27], s45 offen offset:2048 sc1
    v_pk_fma_f32 v[96:97], v[60:61], v[94:95], v[96:97] op_sel:[0,1,0] op_sel_hi:[1,1,1] neg_lo:[0,1,0] neg_hi:[0,1,0]
    v_pk_fma_f32 v[112:113], v[60:61], v[78:79], v[112:113] op_sel:[0,1,0] op_sel_hi:[1,1,1]
    v_pk_fma_f32 v[160:161], v[60:61], v[158:159], v[160:161] op_sel:[0,1,0] op_sel_hi:[1,1,1] neg_lo:[0,1,0] neg_hi:[0,1,0]
    v_pk_fma_f32 v[176:177], v[60:61], v[142:143], v[176:177] op_sel:[0,1,0] op_sel_hi:[1,1,1]
    v_pk_fma_f32 v[96:97], v[58:59], v[78:79], v[96:97] op_sel:[0,1,0] op_sel_hi:[1,1,1]
    v_pk_fma_f32 v[112:113], v[58:59], v[94:95], v[112:113] op_sel:[0,1,0] op_sel_hi:[1,1,1]
    v_pk_fma_f32 v[160:161], v[58:59], v[142:143], v[160:161] op_sel:[0,1,0] op_sel_hi:[1,1,1]
    v_pk_fma_f32 v[176:177], v[58:59], v[158:159], v[176:177] op_sel:[0,1,0] op_sel_hi:[1,1,1]
    s_add_u32 s44, s43, 28672
    v_cvt_pk_bf16_f32 v44, v78, -v94
    buffer_store_dword v44, v29, s[24:27], s44 offen offset:0 sc1
    v_cvt_pk_bf16_f32 v45, v79, -v95
    buffer_store_dword v45, v29, s[24:27], s44 offen offset:2048 sc1
    s_add_u32 s45, s43, 159744
    v_cvt_pk_bf16_f32 v46, v142, -v158
    buffer_store_dword v46, v29, s[24:27], s45 offen offset:0 sc1
    v_cvt_pk_bf16_f32 v47, v143, -v159
    buffer_store_dword v47, v29, s[24:27], s45 offen offset:2048 sc1
    v_pk_fma_f32 v[98:99], v[60:61], v[112:113], v[98:99] op_sel:[0,1,0] op_sel_hi:[1,1,1] neg_lo:[0,1,0] neg_hi:[0,1,0]
    v_pk_fma_f32 v[114:115], v[60:61], v[96:97], v[114:115] op_sel:[0,1,0] op_sel_hi:[1,1,1]
    v_pk_fma_f32 v[162:163], v[60:61], v[176:177], v[162:163] op_sel:[0,1,0] op_sel_hi:[1,1,1] neg_lo:[0,1,0] neg_hi:[0,1,0]
    v_pk_fma_f32 v[178:179], v[60:61], v[160:161], v[178:179] op_sel:[0,1,0] op_sel_hi:[1,1,1]
    v_pk_fma_f32 v[98:99], v[58:59], v[96:97], v[98:99] op_sel:[0,1,0] op_sel_hi:[1,1,1]
    v_pk_fma_f32 v[114:115], v[58:59], v[112:113], v[114:115] op_sel:[0,1,0] op_sel_hi:[1,1,1]
    v_pk_fma_f32 v[162:163], v[58:59], v[160:161], v[162:163] op_sel:[0,1,0] op_sel_hi:[1,1,1]
    v_pk_fma_f32 v[178:179], v[58:59], v[176:177], v[178:179] op_sel:[0,1,0] op_sel_hi:[1,1,1]
    s_add_u32 s44, s43, 32768
    v_cvt_pk_bf16_f32 v40, v96, -v112
    buffer_store_dword v40, v29, s[24:27], s44 offen offset:0 sc1
    v_cvt_pk_bf16_f32 v41, v97, -v113
    buffer_store_dword v41, v29, s[24:27], s44 offen offset:2048 sc1
    s_add_u32 s45, s43, 163840
    v_cvt_pk_bf16_f32 v42, v160, -v176
    buffer_store_dword v42, v29, s[24:27], s45 offen offset:0 sc1
    v_cvt_pk_bf16_f32 v43, v161, -v177
    buffer_store_dword v43, v29, s[24:27], s45 offen offset:2048 sc1
    v_pk_fma_f32 v[100:101], v[60:61], v[114:115], v[100:101] op_sel:[0,1,0] op_sel_hi:[1,1,1] neg_lo:[0,1,0] neg_hi:[0,1,0]
    v_pk_fma_f32 v[116:117], v[60:61], v[98:99], v[116:117] op_sel:[0,1,0] op_sel_hi:[1,1,1]
    v_pk_fma_f32 v[164:165], v[60:61], v[178:179], v[164:165] op_sel:[0,1,0] op_sel_hi:[1,1,1] neg_lo:[0,1,0] neg_hi:[0,1,0]
    v_pk_fma_f32 v[180:181], v[60:61], v[162:163], v[180:181] op_sel:[0,1,0] op_sel_hi:[1,1,1]
    v_pk_fma_f32 v[100:101], v[58:59], v[98:99], v[100:101] op_sel:[0,1,0] op_sel_hi:[1,1,1]
    v_pk_fma_f32 v[116:117], v[58:59], v[114:115], v[116:117] op_sel:[0,1,0] op_sel_hi:[1,1,1]
    v_pk_fma_f32 v[164:165], v[58:59], v[162:163], v[164:165] op_sel:[0,1,0] op_sel_hi:[1,1,1]
    v_pk_fma_f32 v[180:181], v[58:59], v[178:179], v[180:181] op_sel:[0,1,0] op_sel_hi:[1,1,1]
    s_add_u32 s44, s43, 36864
    v_cvt_pk_bf16_f32 v44, v98, -v114
    buffer_store_dword v44, v29, s[24:27], s44 offen offset:0 sc1
    v_cvt_pk_bf16_f32 v45, v99, -v115
    buffer_store_dword v45, v29, s[24:27], s44 offen offset:2048 sc1
    s_add_u32 s45, s43, 167936
    v_cvt_pk_bf16_f32 v46, v162, -v178
    buffer_store_dword v46, v29, s[24:27], s45 offen offset:0 sc1
    v_cvt_pk_bf16_f32 v47, v163, -v179
    buffer_store_dword v47, v29, s[24:27], s45 offen offset:2048 sc1
    v_pk_fma_f32 v[102:103], v[60:61], v[116:117], v[102:103] op_sel:[0,1,0] op_sel_hi:[1,1,1] neg_lo:[0,1,0] neg_hi:[0,1,0]
    v_pk_fma_f32 v[118:119], v[60:61], v[100:101], v[118:119] op_sel:[0,1,0] op_sel_hi:[1,1,1]
    v_pk_fma_f32 v[166:167], v[60:61], v[180:181], v[166:167] op_sel:[0,1,0] op_sel_hi:[1,1,1] neg_lo:[0,1,0] neg_hi:[0,1,0]
    v_pk_fma_f32 v[182:183], v[60:61], v[164:165], v[182:183] op_sel:[0,1,0] op_sel_hi:[1,1,1]
    v_pk_fma_f32 v[102:103], v[58:59], v[100:101], v[102:103] op_sel:[0,1,0] op_sel_hi:[1,1,1]
    v_pk_fma_f32 v[118:119], v[58:59], v[116:117], v[118:119] op_sel:[0,1,0] op_sel_hi:[1,1,1]
    v_pk_fma_f32 v[166:167], v[58:59], v[164:165], v[166:167] op_sel:[0,1,0] op_sel_hi:[1,1,1]
    v_pk_fma_f32 v[182:183], v[58:59], v[180:181], v[182:183] op_sel:[0,1,0] op_sel_hi:[1,1,1]
    s_add_u32 s44, s43, 40960
    v_cvt_pk_bf16_f32 v40, v100, -v116
    buffer_store_dword v40, v29, s[24:27], s44 offen offset:0 sc1
    v_cvt_pk_bf16_f32 v41, v101, -v117
    buffer_store_dword v41, v29, s[24:27], s44 offen offset:2048 sc1
    s_add_u32 s45, s43, 172032
    v_cvt_pk_bf16_f32 v42, v164, -v180
    buffer_store_dword v42, v29, s[24:27], s45 offen offset:0 sc1
    v_cvt_pk_bf16_f32 v43, v165, -v181
    buffer_store_dword v43, v29, s[24:27], s45 offen offset:2048 sc1
    v_pk_fma_f32 v[104:105], v[60:61], v[118:119], v[104:105] op_sel:[0,1,0] op_sel_hi:[1,1,1] neg_lo:[0,1,0] neg_hi:[0,1,0]
    v_pk_fma_f32 v[120:121], v[60:61], v[102:103], v[120:121] op_sel:[0,1,0] op_sel_hi:[1,1,1]
    v_pk_fma_f32 v[168:169], v[60:61], v[182:183], v[168:169] op_sel:[0,1,0] op_sel_hi:[1,1,1] neg_lo:[0,1,0] neg_hi:[0,1,0]
    v_pk_fma_f32 v[184:185], v[60:61], v[166:167], v[184:185] op_sel:[0,1,0] op_sel_hi:[1,1,1]
    v_pk_fma_f32 v[104:105], v[58:59], v[102:103], v[104:105] op_sel:[0,1,0] op_sel_hi:[1,1,1]
    v_pk_fma_f32 v[120:121], v[58:59], v[118:119], v[120:121] op_sel:[0,1,0] op_sel_hi:[1,1,1]
    v_pk_fma_f32 v[168:169], v[58:59], v[166:167], v[168:169] op_sel:[0,1,0] op_sel_hi:[1,1,1]
    v_pk_fma_f32 v[184:185], v[58:59], v[182:183], v[184:185] op_sel:[0,1,0] op_sel_hi:[1,1,1]
    s_add_u32 s44, s43, 45056
    v_cvt_pk_bf16_f32 v44, v102, -v118
    buffer_store_dword v44, v29, s[24:27], s44 offen offset:0 sc1
    v_cvt_pk_bf16_f32 v45, v103, -v119
    buffer_store_dword v45, v29, s[24:27], s44 offen offset:2048 sc1
    s_add_u32 s45, s43, 176128
    v_cvt_pk_bf16_f32 v46, v166, -v182
    buffer_store_dword v46, v29, s[24:27], s45 offen offset:0 sc1
    v_cvt_pk_bf16_f32 v47, v167, -v183
    buffer_store_dword v47, v29, s[24:27], s45 offen offset:2048 sc1
    v_pk_fma_f32 v[106:107], v[60:61], v[120:121], v[106:107] op_sel:[0,1,0] op_sel_hi:[1,1,1] neg_lo:[0,1,0] neg_hi:[0,1,0]
    v_pk_fma_f32 v[122:123], v[60:61], v[104:105], v[122:123] op_sel:[0,1,0] op_sel_hi:[1,1,1]
    v_pk_fma_f32 v[170:171], v[60:61], v[184:185], v[170:171] op_sel:[0,1,0] op_sel_hi:[1,1,1] neg_lo:[0,1,0] neg_hi:[0,1,0]
    v_pk_fma_f32 v[186:187], v[60:61], v[168:169], v[186:187] op_sel:[0,1,0] op_sel_hi:[1,1,1]
    v_pk_fma_f32 v[106:107], v[58:59], v[104:105], v[106:107] op_sel:[0,1,0] op_sel_hi:[1,1,1]
    v_pk_fma_f32 v[122:123], v[58:59], v[120:121], v[122:123] op_sel:[0,1,0] op_sel_hi:[1,1,1]
    v_pk_fma_f32 v[170:171], v[58:59], v[168:169], v[170:171] op_sel:[0,1,0] op_sel_hi:[1,1,1]
    v_pk_fma_f32 v[186:187], v[58:59], v[184:185], v[186:187] op_sel:[0,1,0] op_sel_hi:[1,1,1]
    s_add_u32 s44, s43, 49152
    v_cvt_pk_bf16_f32 v40, v104, -v120
    buffer_store_dword v40, v29, s[24:27], s44 offen offset:0 sc1
    v_cvt_pk_bf16_f32 v41, v105, -v121
    buffer_store_dword v41, v29, s[24:27], s44 offen offset:2048 sc1
    s_add_u32 s45, s43, 180224
    v_cvt_pk_bf16_f32 v42, v168, -v184
    buffer_store_dword v42, v29, s[24:27], s45 offen offset:0 sc1
    v_cvt_pk_bf16_f32 v43, v169, -v185
    buffer_store_dword v43, v29, s[24:27], s45 offen offset:2048 sc1
    v_pk_fma_f32 v[108:109], v[60:61], v[122:123], v[108:109] op_sel:[0,1,0] op_sel_hi:[1,1,1] neg_lo:[0,1,0] neg_hi:[0,1,0]
    v_pk_fma_f32 v[124:125], v[60:61], v[106:107], v[124:125] op_sel:[0,1,0] op_sel_hi:[1,1,1]
    v_pk_fma_f32 v[172:173], v[60:61], v[186:187], v[172:173] op_sel:[0,1,0] op_sel_hi:[1,1,1] neg_lo:[0,1,0] neg_hi:[0,1,0]
    v_pk_fma_f32 v[188:189], v[60:61], v[170:171], v[188:189] op_sel:[0,1,0] op_sel_hi:[1,1,1]
    v_pk_fma_f32 v[108:109], v[58:59], v[106:107], v[108:109] op_sel:[0,1,0] op_sel_hi:[1,1,1]
    v_pk_fma_f32 v[124:125], v[58:59], v[122:123], v[124:125] op_sel:[0,1,0] op_sel_hi:[1,1,1]
    v_pk_fma_f32 v[172:173], v[58:59], v[170:171], v[172:173] op_sel:[0,1,0] op_sel_hi:[1,1,1]
    v_pk_fma_f32 v[188:189], v[58:59], v[186:187], v[188:189] op_sel:[0,1,0] op_sel_hi:[1,1,1]
    s_add_u32 s44, s43, 53248
    v_cvt_pk_bf16_f32 v44, v106, -v122
    buffer_store_dword v44, v29, s[24:27], s44 offen offset:0 sc1
    v_cvt_pk_bf16_f32 v45, v107, -v123
    buffer_store_dword v45, v29, s[24:27], s44 offen offset:2048 sc1
    s_add_u32 s45, s43, 184320
    v_cvt_pk_bf16_f32 v46, v170, -v186
    buffer_store_dword v46, v29, s[24:27], s45 offen offset:0 sc1
    v_cvt_pk_bf16_f32 v47, v171, -v187
    buffer_store_dword v47, v29, s[24:27], s45 offen offset:2048 sc1
    v_pk_fma_f32 v[110:111], v[60:61], v[124:125], v[110:111] op_sel:[0,1,0] op_sel_hi:[1,1,1] neg_lo:[0,1,0] neg_hi:[0,1,0]
    v_pk_fma_f32 v[126:127], v[60:61], v[108:109], v[126:127] op_sel:[0,1,0] op_sel_hi:[1,1,1]
    v_pk_fma_f32 v[174:175], v[60:61], v[188:189], v[174:175] op_sel:[0,1,0] op_sel_hi:[1,1,1] neg_lo:[0,1,0] neg_hi:[0,1,0]
    v_pk_fma_f32 v[190:191], v[60:61], v[172:173], v[190:191] op_sel:[0,1,0] op_sel_hi:[1,1,1]
    v_pk_fma_f32 v[110:111], v[58:59], v[108:109], v[110:111] op_sel:[0,1,0] op_sel_hi:[1,1,1]
    v_pk_fma_f32 v[126:127], v[58:59], v[124:125], v[126:127] op_sel:[0,1,0] op_sel_hi:[1,1,1]
    v_pk_fma_f32 v[174:175], v[58:59], v[172:173], v[174:175] op_sel:[0,1,0] op_sel_hi:[1,1,1]
    v_pk_fma_f32 v[190:191], v[58:59], v[188:189], v[190:191] op_sel:[0,1,0] op_sel_hi:[1,1,1]
    s_add_u32 s44, s43, 57344
    v_cvt_pk_bf16_f32 v40, v108, -v124
    buffer_store_dword v40, v29, s[24:27], s44 offen offset:0 sc1
    v_cvt_pk_bf16_f32 v41, v109, -v125
    buffer_store_dword v41, v29, s[24:27], s44 offen offset:2048 sc1
    s_add_u32 s45, s43, 188416
    v_cvt_pk_bf16_f32 v42, v172, -v188
    buffer_store_dword v42, v29, s[24:27], s45 offen offset:0 sc1
    v_cvt_pk_bf16_f32 v43, v173, -v189
    buffer_store_dword v43, v29, s[24:27], s45 offen offset:2048 sc1
    s_add_u32 s44, s43, 61440
    v_cvt_pk_bf16_f32 v44, v110, -v126
    buffer_store_dword v44, v29, s[24:27], s44 offen offset:0 sc1
    v_cvt_pk_bf16_f32 v45, v111, -v127
    buffer_store_dword v45, v29, s[24:27], s44 offen offset:2048 sc1
    s_add_u32 s45, s43, 192512
    v_cvt_pk_bf16_f32 v46, v174, -v190
    buffer_store_dword v46, v29, s[24:27], s45 offen offset:0 sc1
    v_cvt_pk_bf16_f32 v47, v175, -v191
    buffer_store_dword v47, v29, s[24:27], s45 offen offset:2048 sc1
    s_waitcnt vmcnt(0)
    s_mov_b64 exec, 1
    s_lshl_b32 s60, s54, 5
    s_add_u32 s60, s60, 32768
    v_mov_b32 v14, s100
    v_mov_b32 v15, s101
    buffer_store_dwordx2 v[14:15], off, s[4:7], s60 sc1
    s_mov_b64 exec, -1
    s_add_u32 s8, s98, 8388608
    s_addc_u32 s9, s99, 0
    s_and_b32 s9, s9, 0xffff
    s_mov_b32 s10, 4194304
    s_mov_b32 s11, 0x00020000
    s_add_u32 s12, s98, 4194304
    s_addc_u32 s13, s99, 0
    s_and_b32 s13, s13, 0xffff
    s_mov_b32 s14, 1441792
    s_mov_b32 s15, 0x00020000
    s_lshl_b32 s57, s52, 17
    s_lshl_b32 s43, s3, 9
    s_add_u32 s57, s57, s43
    s_mul_i32 s83, s3, 6
    s_cmp_eq_u32 s3, 3
    s_cselect_b32 s83, 17, s83
    s_lshl_b32 s83, s83, 13
    s_mul_i32 s43, s53, 180224
    s_add_u32 s83, s83, s43
    s_cmp_ge_u32 s3, 2
    s_cselect_b32 s82, 0x40000000, 0
    s_add_u32 s82, s82, s83
    v_lshrrev_b32 v14, 3, v1
    v_mul_u32_u24 v14, 2048, v14
    v_and_b32 v15, 7, v1
    v_lshrrev_b32 v16, 4, v1
    v_xor_b32 v15, v15, v16
    v_lshlrev_b32 v15, 4, v15
    v_add_u32 v28, v14, v15
    v_xor_b32 v15, 64, v15
    v_add_u32 v29, v14, v15
    v_and_b32 v14, 31, v1
    v_lshrrev_b32 v15, 1, v14
    v_and_b32 v15, 7, v15
    v_lshrrev_b32 v16, 5, v1
    v_lshlrev_b32 v16, 1, v16
    v_xor_b32 v15, v15, v16
    v_lshlrev_b32 v15, 4, v15
    v_lshl_add_u32 v14, v14, 7, v15
    v_add_u32 v24, s42, v14
    v_xor_b32 v25, 16, v24
    v_xor_b32 v26, 64, v24
    v_xor_b32 v27, 80, v24
    s_lshr_b32 s43, s52, 1
    s_lshl_b32 s43, s43, 2
    s_add_u32 s43, s43, s3
    s_lshl_b32 s43, s43, 7
    s_add_u32 s43, s43, 32768
    v_lshl_add_u32 v14, v1, 5, s43
    s_mov_b64 exec, 15
    buffer_load_dwordx2 v[18:19], v14, s[4:7], 0 offen sc1
    s_mov_b64 exec, -1
    s_add_u32 m0, s42, 16384
    s_add_u32 s59, s61, 524288
    buffer_load_dwordx4 v12, s[32:35], s59 offen lds
    s_add_u32 m0, s42, 17408
    s_add_u32 s59, s61, 557056
    buffer_load_dwordx4 v12, s[32:35], s59 offen lds
    s_add_u32 m0, s42, 18432
    s_add_u32 s59, s61, 589824
    buffer_load_dwordx4 v12, s[32:35], s59 offen lds
    s_add_u32 m0, s42, 19456
    s_add_u32 s59, s61, 622592
    buffer_load_dwordx4 v12, s[32:35], s59 offen lds
    s_add_u32 m0, s42, 20480
    s_add_u32 s59, s61, 655360
    buffer_load_dwordx4 v12, s[32:35], s59 offen lds
    s_add_u32 m0, s42, 21504
    s_add_u32 s59, s61, 688128
    buffer_load_dwordx4 v12, s[32:35], s59 offen lds
    s_add_u32 m0, s42, 22528
    s_add_u32 s59, s61, 720896
    buffer_load_dwordx4 v12, s[32:35], s59 offen lds
    s_add_u32 m0, s42, 23552
    s_add_u32 s59, s61, 753664
    buffer_load_dwordx4 v12, s[32:35], s59 offen lds
    s_add_u32 m0, s42, 24576
    s_add_u32 s59, s61, 786432
    buffer_load_dwordx4 v12, s[32:35], s59 offen lds
    s_add_u32 m0, s42, 25600
    s_add_u32 s59, s61, 819200
    buffer_load_dwordx4 v12, s[32:35], s59 offen lds
    s_add_u32 m0, s42, 26624
    s_add_u32 s59, s61, 851968
    buffer_load_dwordx4 v12, s[32:35], s59 offen lds
    s_add_u32 m0, s42, 27648
    s_add_u32 s59, s61, 884736
    buffer_load_dwordx4 v12, s[32:35], s59 offen lds
    s_add_u32 m0, s42, 28672
    s_add_u32 s59, s61, 917504
    buffer_load_dwordx4 v12, s[32:35], s59 offen lds
    s_add_u32 m0, s42, 29696
    s_add_u32 s59, s61, 950272
    buffer_load_dwordx4 v12, s[32:35], s59 offen lds
    s_add_u32 m0, s42, 30720
    s_add_u32 s59, s61, 983040
    buffer_load_dwordx4 v12, s[32:35], s59 offen lds
    s_add_u32 m0, s42, 31744
    s_add_u32 s59, s61, 1015808
    buffer_load_dwordx4 v12, s[32:35], s59 offen lds
    s_add_u32 m0, s42, 32768
    s_add_u32 s59, s61, 1048576
    buffer_load_dwordx4 v12, s[32:35], s59 offen lds
    s_add_u32 m0, s42, 33792
    s_add_u32 s59, s61, 1081344
    buffer_load_dwordx4 v12, s[32:35], s59 offen lds
    s_add_u32 m0, s42, 34816
    s_add_u32 s59, s61, 1114112
    buffer_load_dwordx4 v12, s[32:35], s59 offen lds
    s_add_u32 m0, s42, 35840
    s_add_u32 s59, s61, 1146880
    buffer_load_dwordx4 v12, s[32:35], s59 offen lds
    s_add_u32 m0, s42, 36864
    s_add_u32 s59, s61, 1179648
    buffer_load_dwordx4 v12, s[32:35], s59 offen lds
    s_add_u32 m0, s42, 37888
    s_add_u32 s59, s61, 1212416
    buffer_load_dwordx4 v12, s[32:35], s59 offen lds
    s_add_u32 m0, s42, 38912
    s_add_u32 s59, s61, 1245184
    buffer_load_dwordx4 v12, s[32:35], s59 offen lds
    s_add_u32 m0, s42, 39936
    s_add_u32 s59, s61, 1277952
    buffer_load_dwordx4 v12, s[32:35], s59 offen lds
    ds_read_b64_tr_b16 a[0:1], v10 offset:0
    ds_read_b64_tr_b16 a[2:3], v10 offset:512
    ds_read_b64_tr_b16 a[4:5], v11 offset:0
    ds_read_b64_tr_b16 a[6:7], v11 offset:512
    ds_read_b64_tr_b16 a[8:9], v10 offset:2048
    ds_read_b64_tr_b16 a[10:11], v10 offset:2560
    ds_read_b64_tr_b16 a[12:13], v11 offset:2048
    ds_read_b64_tr_b16 a[14:15], v11 offset:2560
    ds_read_b64_tr_b16 a[16:17], v10 offset:4096
    ds_read_b64_tr_b16 a[18:19], v10 offset:4608
    ds_read_b64_tr_b16 a[20:21], v11 offset:4096
    ds_read_b64_tr_b16 a[22:23], v11 offset:4608
    ds_read_b64_tr_b16 a[24:25], v10 offset:6144
    ds_read_b64_tr_b16 a[26:27], v10 offset:6656
    ds_read_b64_tr_b16 a[28:29], v11 offset:6144
    ds_read_b64_tr_b16 a[30:31], v11 offset:6656
    s_waitcnt lgkmcnt(0)
    s_add_u32 m0, s42, 0
    s_add_u32 s59, s63, 1310720
    buffer_load_dwordx4 v12, s[32:35], s59 offen lds
    s_add_u32 m0, s42, 1024
    s_add_u32 s59, s63, 1343488
    buffer_load_dwordx4 v12, s[32:35], s59 offen lds
    s_add_u32 m0, s42, 2048
    s_add_u32 s59, s63, 1376256
    buffer_load_dwordx4 v12, s[32:35], s59 offen lds
    s_add_u32 m0, s42, 3072
    s_add_u32 s59, s63, 1409024
    buffer_load_dwordx4 v12, s[32:35], s59 offen lds
    s_add_u32 m0, s42, 4096
    s_add_u32 s59, s63, 1441792
    buffer_load_dwordx4 v12, s[32:35], s59 offen lds
    s_add_u32 m0, s42, 5120
    s_add_u32 s59, s63, 1474560
    buffer_load_dwordx4 v12, s[32:35], s59 offen lds
    s_add_u32 m0, s42, 6144
    s_add_u32 s59, s63, 1507328
    buffer_load_dwordx4 v12, s[32:35], s59 offen lds
    s_add_u32 m0, s42, 7168
    s_add_u32 s59, s63, 1540096
    buffer_load_dwordx4 v12, s[32:35], s59 offen lds
    ds_read_b64_tr_b16 a[32:33], v10 offset:8192
    ds_read_b64_tr_b16 a[34:35], v10 offset:8704
    ds_read_b64_tr_b16 a[36:37], v11 offset:8192
    ds_read_b64_tr_b16 a[38:39], v11 offset:8704
    ds_read_b64_tr_b16 a[40:41], v10 offset:10240
    ds_read_b64_tr_b16 a[42:43], v10 offset:10752
    ds_read_b64_tr_b16 a[44:45], v11 offset:10240
    ds_read_b64_tr_b16 a[46:47], v11 offset:10752
    ds_read_b64_tr_b16 a[48:49], v10 offset:12288
    ds_read_b64_tr_b16 a[50:51], v10 offset:12800
    ds_read_b64_tr_b16 a[52:53], v11 offset:12288
    ds_read_b64_tr_b16 a[54:55], v11 offset:12800
    ds_read_b64_tr_b16 a[56:57], v10 offset:14336
    ds_read_b64_tr_b16 a[58:59], v10 offset:14848
    ds_read_b64_tr_b16 a[60:61], v11 offset:14336
    ds_read_b64_tr_b16 a[62:63], v11 offset:14848
    s_waitcnt lgkmcnt(0)
    s_add_u32 m0, s42, 8192
    s_add_u32 s59, s58, 0
    buffer_load_dwordx4 v2, s[28:31], s59 offen lds
    s_add_u32 m0, s42, 9216
    s_add_u32 s59, s58, 8192
    buffer_load_dwordx4 v3, s[28:31], s59 offen lds
    s_add_u32 m0, s42, 10240
    s_add_u32 s59, s58, 16384
    buffer_load_dwordx4 v2, s[28:31], s59 offen lds
    s_add_u32 m0, s42, 11264
    s_add_u32 s59, s58, 24576
    buffer_load_dwordx4 v3, s[28:31], s59 offen lds
    s_add_u32 m0, s42, 12288
    s_add_u32 s59, s58, 32768
    buffer_load_dwordx4 v2, s[28:31], s59 offen lds
    s_add_u32 m0, s42, 13312
    s_add_u32 s59, s58, 40960
    buffer_load_dwordx4 v3, s[28:31], s59 offen lds
    s_add_u32 m0, s42, 14336
    s_add_u32 s59, s58, 49152
    buffer_load_dwordx4 v2, s[28:31], s59 offen lds
    s_add_u32 m0, s42, 15360
    s_add_u32 s59, s58, 57344
    buffer_load_dwordx4 v3, s[28:31], s59 offen lds
    s_waitcnt vmcnt(32)
    ds_read_b64_tr_b16 a[64:65], v10 offset:16384
    ds_read_b64_tr_b16 a[66:67], v10 offset:16896
    ds_read_b64_tr_b16 a[68:69], v11 offset:16384
    ds_read_b64_tr_b16 a[70:71], v11 offset:16896
    ds_read_b64_tr_b16 a[72:73], v10 offset:18432
    ds_read_b64_tr_b16 a[74:75], v10 offset:18944
    ds_read_b64_tr_b16 a[76:77], v11 offset:18432
    ds_read_b64_tr_b16 a[78:79], v11 offset:18944
    ds_read_b64_tr_b16 a[80:81], v10 offset:20480
    ds_read_b64_tr_b16 a[82:83], v10 offset:20992
    ds_read_b64_tr_b16 a[84:85], v11 offset:20480
    ds_read_b64_tr_b16 a[86:87], v11 offset:20992
    ds_read_b64_tr_b16 a[88:89], v10 offset:22528
    ds_read_b64_tr_b16 a[90:91], v10 offset:23040
    ds_read_b64_tr_b16 a[92:93], v11 offset:22528
    ds_read_b64_tr_b16 a[94:95], v11 offset:23040
    s_waitcnt lgkmcnt(0)
    s_add_u32 m0, s42, 16384
    s_add_u32 s59, s58, 0
    buffer_load_dwordx4 v2, s[36:39], s59 offen lds
    s_add_u32 m0, s42, 17408
    s_add_u32 s59, s58, 8192
    buffer_load_dwordx4 v3, s[36:39], s59 offen lds
    s_add_u32 m0, s42, 18432
    s_add_u32 s59, s58, 16384
    buffer_load_dwordx4 v2, s[36:39], s59 offen lds
    s_add_u32 m0, s42, 19456
    s_add_u32 s59, s58, 24576
    buffer_load_dwordx4 v3, s[36:39], s59 offen lds
    s_add_u32 m0, s42, 20480
    s_add_u32 s59, s58, 32768
    buffer_load_dwordx4 v2, s[36:39], s59 offen lds
    s_add_u32 m0, s42, 21504
    s_add_u32 s59, s58, 40960
    buffer_load_dwordx4 v3, s[36:39], s59 offen lds
    s_add_u32 m0, s42, 22528
    s_add_u32 s59, s58, 49152
    buffer_load_dwordx4 v2, s[36:39], s59 offen lds
    s_add_u32 m0, s42, 23552
    s_add_u32 s59, s58, 57344
    buffer_load_dwordx4 v3, s[36:39], s59 offen lds
    s_waitcnt vmcnt(32)
    ds_read_b64_tr_b16 a[96:97], v10 offset:24576
    ds_read_b64_tr_b16 a[98:99], v10 offset:25088
    ds_read_b64_tr_b16 a[100:101], v11 offset:24576
    ds_read_b64_tr_b16 a[102:103], v11 offset:25088
    ds_read_b64_tr_b16 a[104:105], v10 offset:26624
    ds_read_b64_tr_b16 a[106:107], v10 offset:27136
    ds_read_b64_tr_b16 a[108:109], v11 offset:26624
    ds_read_b64_tr_b16 a[110:111], v11 offset:27136
    ds_read_b64_tr_b16 a[112:113], v10 offset:28672
    ds_read_b64_tr_b16 a[114:115], v10 offset:29184
    ds_read_b64_tr_b16 a[116:117], v11 offset:28672
    ds_read_b64_tr_b16 a[118:119], v11 offset:29184
    ds_read_b64_tr_b16 a[120:121], v10 offset:30720
    ds_read_b64_tr_b16 a[122:123], v10 offset:31232
    ds_read_b64_tr_b16 a[124:125], v11 offset:30720
    ds_read_b64_tr_b16 a[126:127], v11 offset:31232
    s_waitcnt lgkmcnt(0)
    s_add_u32 m0, s42, 24576
    s_add_u32 s59, s58, 128
    buffer_load_dwordx4 v2, s[28:31], s59 offen lds
    s_add_u32 m0, s42, 25600
    s_add_u32 s59, s58, 8320
    buffer_load_dwordx4 v3, s[28:31], s59 offen lds
    s_add_u32 m0, s42, 26624
    s_add_u32 s59, s58, 16512
    buffer_load_dwordx4 v2, s[28:31], s59 offen lds
    s_add_u32 m0, s42, 27648
    s_add_u32 s59, s58, 24704
    buffer_load_dwordx4 v3, s[28:31], s59 offen lds
    s_add_u32 m0, s42, 28672
    s_add_u32 s59, s58, 32896
    buffer_load_dwordx4 v2, s[28:31], s59 offen lds
    s_add_u32 m0, s42, 29696
    s_add_u32 s59, s58, 41088
    buffer_load_dwordx4 v3, s[28:31], s59 offen lds
    s_add_u32 m0, s42, 30720
    s_add_u32 s59, s58, 49280
    buffer_load_dwordx4 v2, s[28:31], s59 offen lds
    s_add_u32 m0, s42, 31744
    s_add_u32 s59, s58, 57472
    buffer_load_dwordx4 v3, s[28:31], s59 offen lds
    s_waitcnt vmcnt(32)
    ds_read_b64_tr_b16 a[128:129], v10 offset:32768
    ds_read_b64_tr_b16 a[130:131], v10 offset:33280
    ds_read_b64_tr_b16 a[132:133], v11 offset:32768
    ds_read_b64_tr_b16 a[134:135], v11 offset:33280
    ds_read_b64_tr_b16 a[136:137], v10 offset:34816
    ds_read_b64_tr_b16 a[138:139], v10 offset:35328
    ds_read_b64_tr_b16 a[140:141], v11 offset:34816
    ds_read_b64_tr_b16 a[142:143], v11 offset:35328
    ds_read_b64_tr_b16 a[144:145], v10 offset:36864
    ds_read_b64_tr_b16 a[146:147], v10 offset:37376
    ds_read_b64_tr_b16 a[148:149], v11 offset:36864
    ds_read_b64_tr_b16 a[150:151], v11 offset:37376
    ds_read_b64_tr_b16 a[152:153], v10 offset:38912
    ds_read_b64_tr_b16 a[154:155], v10 offset:39424
    ds_read_b64_tr_b16 a[156:157], v11 offset:38912
    ds_read_b64_tr_b16 a[158:159], v11 offset:39424
    s_waitcnt lgkmcnt(0)
    s_add_u32 m0, s42, 32768
    s_add_u32 s59, s58, 128
    buffer_load_dwordx4 v2, s[36:39], s59 offen lds
    s_add_u32 m0, s42, 33792
    s_add_u32 s59, s58, 8320
    buffer_load_dwordx4 v3, s[36:39], s59 offen lds
    s_add_u32 m0, s42, 34816
    s_add_u32 s59, s58, 16512
    buffer_load_dwordx4 v2, s[36:39], s59 offen lds
    s_add_u32 m0, s42, 35840
    s_add_u32 s59, s58, 24704
    buffer_load_dwordx4 v3, s[36:39], s59 offen lds
    s_add_u32 m0, s42, 36864
    s_add_u32 s59, s58, 32896
    buffer_load_dwordx4 v2, s[36:39], s59 offen lds
    s_add_u32 m0, s42, 37888
    s_add_u32 s59, s58, 41088
    buffer_load_dwordx4 v3, s[36:39], s59 offen lds
    s_add_u32 m0, s42, 38912
    s_add_u32 s59, s58, 49280
    buffer_load_dwordx4 v2, s[36:39], s59 offen lds
    s_add_u32 m0, s42, 39936
    s_add_u32 s59, s58, 57472
    buffer_load_dwordx4 v3, s[36:39], s59 offen lds
    s_waitcnt vmcnt(32)
    s_cmp_ge_u32 s3, 2
    s_cbranch_scc1 L_co_75
    ds_read_b64_tr_b16 a[160:161], v10 offset:0
    ds_read_b64_tr_b16 a[162:163], v10 offset:512
    ds_read_b64_tr_b16 a[164:165], v11 offset:0
    ds_read_b64_tr_b16 a[166:167], v11 offset:512
    ds_read_b64_tr_b16 a[168:169], v10 offset:2048
    ds_read_b64_tr_b16 a[170:171], v10 offset:2560
    ds_read_b64_tr_b16 a[172:173], v11 offset:2048
    ds_read_b64_tr_b16 a[174:175], v11 offset:2560
    ds_read_b64_tr_b16 a[176:177], v10 offset:4096
    ds_read_b64_tr_b16 a[178:179], v10 offset:4608
    ds_read_b64_tr_b16 a[180:181], v11 offset:4096
    ds_read_b64_tr_b16 a[182:183], v11 offset:4608
    ds_read_b64_tr_b16 a[184:185], v10 offset:6144
    ds_read_b64_tr_b16 a[186:187], v10 offset:6656
    ds_read_b64_tr_b16 a[188:189], v11 offset:6144
    ds_read_b64_tr_b16 a[190:191], v11 offset:6656
    s_waitcnt lgkmcnt(0)
L_co_75:
    s_lshr_b32 s43, s52, 1
    s_lshl_b32 s43, s43, 2
    s_add_u32 s43, s43, s3
    s_lshl_b32 s43, s43, 7
    s_add_u32 s43, s43, 32768
    v_lshl_add_u32 v14, v1, 5, s43
    s_mov_b64 exec, 15
    s_mov_b32 s60, 20000
    s_branch L_pollc_77
L_poll_76:
    buffer_load_dwordx2 v[18:19], v14, s[4:7], 0 offen sc1
    s_waitcnt vmcnt(0)
L_pollc_77:
    v_cmp_ne_u64 vcc, s[100:101], v[18:19]
    s_cbranch_vccz L_polld_78
    s_sleep 4
    s_sub_u32 s60, s60, 1
    s_cmp_lg_u32 s60, 0
    s_cbranch_scc1 L_poll_76
L_polld_78:
    s_mov_b64 exec, -1
    s_add_u32 m0, s42, 0
    s_add_u32 s59, s57, 0
    buffer_load_dwordx4 v28, s[8:11], s59 offen lds
    s_add_u32 m0, s42, 1024
    s_add_u32 s59, s57, 16384
    buffer_load_dwordx4 v29, s[8:11], s59 offen lds
    s_add_u32 m0, s42, 2048
    s_add_u32 s59, s57, 32768
    buffer_load_dwordx4 v28, s[8:11], s59 offen lds
    s_add_u32 m0, s42, 3072
    s_add_u32 s59, s57, 49152
    buffer_load_dwordx4 v29, s[8:11], s59 offen lds
    s_add_u32 m0, s42, 4096
    s_add_u32 s59, s57, 65536
    buffer_load_dwordx4 v28, s[8:11], s59 offen lds
    s_add_u32 m0, s42, 5120
    s_add_u32 s59, s57, 81920
    buffer_load_dwordx4 v29, s[8:11], s59 offen lds
    s_add_u32 m0, s42, 6144
    s_add_u32 s59, s57, 98304
    buffer_load_dwordx4 v28, s[8:11], s59 offen lds
    s_add_u32 m0, s42, 7168
    s_add_u32 s59, s57, 114688
    buffer_load_dwordx4 v29, s[8:11], s59 offen lds
    s_waitcnt vmcnt(24)
    ds_read_b128 v[32:35], v6 offset:8192
    ds_read_b128 v[36:39], v6 offset:12288
    ds_read_b128 v[40:43], v6 offset:16384
    ds_read_b128 v[44:47], v6 offset:20480
    ds_read_b128 v[48:51], v7 offset:8192
    ds_read_b128 v[52:55], v7 offset:12288
    ds_read_b128 v[56:59], v7 offset:16384
    ds_read_b128 v[60:63], v7 offset:20480
    s_waitcnt lgkmcnt(4)
    v_perm_b32 v128, v40, v32, s50
    v_perm_b32 v129, v40, v32, s51
    v_perm_b32 v130, v41, v33, s50
    v_perm_b32 v131, v41, v33, s51
    v_perm_b32 v136, v42, v34, s50
    v_perm_b32 v137, v42, v34, s51
    v_perm_b32 v138, v43, v35, s50
    v_perm_b32 v139, v43, v35, s51
    v_perm_b32 v132, v44, v36, s50
    v_perm_b32 v133, v44, v36, s51
    v_perm_b32 v134, v45, v37, s50
    v_perm_b32 v135, v45, v37, s51
    v_perm_b32 v140, v46, v38, s50
    v_perm_b32 v141, v46, v38, s51
    v_perm_b32 v142, v47, v39, s50
    v_perm_b32 v143, v47, v39, s51
    s_waitcnt lgkmcnt(0)
    v_perm_b32 v144, v56, v48, s50
    v_perm_b32 v145, v56, v48, s51
    v_perm_b32 v146, v57, v49, s50
    v_perm_b32 v147, v57, v49, s51
    v_perm_b32 v152, v58, v50, s50
    v_perm_b32 v153, v58, v50, s51
    v_perm_b32 v154, v59, v51, s50
    v_perm_b32 v155, v59, v51, s51
    v_perm_b32 v148, v60, v52, s50
    v_perm_b32 v149, v60, v52, s51
    v_perm_b32 v150, v61, v53, s50
    v_perm_b32 v151, v61, v53, s51
    v_perm_b32 v156, v62, v54, s50
    v_perm_b32 v157, v62, v54, s51
    v_perm_b32 v158, v63, v55, s50
    v_perm_b32 v159, v63, v55, s51
    ds_read_b128 v[32:35], v8 offset:8192
    ds_read_b128 v[36:39], v8 offset:12288
    ds_read_b128 v[40:43], v8 offset:16384
    ds_read_b128 v[44:47], v8 offset:20480
    ds_read_b128 v[48:51], v9 offset:8192
    ds_read_b128 v[52:55], v9 offset:12288
    ds_read_b128 v[56:59], v9 offset:16384
    ds_read_b128 v[60:63], v9 offset:20480
    s_waitcnt lgkmcnt(4)
    v_perm_b32 v160, v40, v32, s50
    v_perm_b32 v161, v40, v32, s51
    v_perm_b32 v162, v41, v33, s50
    v_perm_b32 v163, v41, v33, s51
    v_perm_b32 v168, v42, v34, s50
    v_perm_b32 v169, v42, v34, s51
    v_perm_b32 v170, v43, v35, s50
    v_perm_b32 v171, v43, v35, s51
    v_perm_b32 v164, v44, v36, s50
    v_perm_b32 v165, v44, v36, s51
    v_perm_b32 v166, v45, v37, s50
    v_perm_b32 v167, v45, v37, s51
    v_perm_b32 v172, v46, v38, s50
    v_perm_b32 v173, v46, v38, s51
    v_perm_b32 v174, v47, v39, s50
    v_perm_b32 v175, v47, v39, s51
    s_waitcnt lgkmcnt(0)
    v_perm_b32 v176, v56, v48, s50
    v_perm_b32 v177, v56, v48, s51
    v_perm_b32 v178, v57, v49, s50
    v_perm_b32 v179, v57, v49, s51
    v_perm_b32 v184, v58, v50, s50
    v_perm_b32 v185, v58, v50, s51
    v_perm_b32 v186, v59, v51, s50
    v_perm_b32 v187, v59, v51, s51
    v_perm_b32 v180, v60, v52, s50
    v_perm_b32 v181, v60, v52, s51
    v_perm_b32 v182, v61, v53, s50
    v_perm_b32 v183, v61, v53, s51
    v_perm_b32 v188, v62, v54, s50
    v_perm_b32 v189, v62, v54, s51
    v_perm_b32 v190, v63, v55, s50
    v_perm_b32 v191, v63, v55, s51
    s_add_u32 m0, s42, 8192
    s_add_u32 s59, s57, 128
    buffer_load_dwordx4 v28, s[8:11], s59 offen lds
    s_add_u32 m0, s42, 9216
    s_add_u32 s59, s57, 16512
    buffer_load_dwordx4 v29, s[8:11], s59 offen lds
    s_add_u32 m0, s42, 10240
    s_add_u32 s59, s57, 32896
    buffer_load_dwordx4 v28, s[8:11], s59 offen lds
    s_add_u32 m0, s42, 11264
    s_add_u32 s59, s57, 49280
    buffer_load_dwordx4 v29, s[8:11], s59 offen lds
    s_add_u32 m0, s42, 12288
    s_add_u32 s59, s57, 65664
    buffer_load_dwordx4 v28, s[8:11], s59 offen lds
    s_add_u32 m0, s42, 13312
    s_add_u32 s59, s57, 82048
    buffer_load_dwordx4 v29, s[8:11], s59 offen lds
    s_add_u32 m0, s42, 14336
    s_add_u32 s59, s57, 98432
    buffer_load_dwordx4 v28, s[8:11], s59 offen lds
    s_add_u32 m0, s42, 15360
    s_add_u32 s59, s57, 114816
    buffer_load_dwordx4 v29, s[8:11], s59 offen lds
    s_add_u32 m0, s42, 16384
    s_add_u32 s59, s57, 256
    buffer_load_dwordx4 v28, s[8:11], s59 offen lds
    s_add_u32 m0, s42, 17408
    s_add_u32 s59, s57, 16640
    buffer_load_dwordx4 v29, s[8:11], s59 offen lds
    s_add_u32 m0, s42, 18432
    s_add_u32 s59, s57, 33024
    buffer_load_dwordx4 v28, s[8:11], s59 offen lds
    s_add_u32 m0, s42, 19456
    s_add_u32 s59, s57, 49408
    buffer_load_dwordx4 v29, s[8:11], s59 offen lds
    s_add_u32 m0, s42, 20480
    s_add_u32 s59, s57, 65792
    buffer_load_dwordx4 v28, s[8:11], s59 offen lds
    s_add_u32 m0, s42, 21504
    s_add_u32 s59, s57, 82176
    buffer_load_dwordx4 v29, s[8:11], s59 offen lds
    s_add_u32 m0, s42, 22528
    s_add_u32 s59, s57, 98560
    buffer_load_dwordx4 v28, s[8:11], s59 offen lds
    s_add_u32 m0, s42, 23552
    s_add_u32 s59, s57, 114944
    buffer_load_dwordx4 v29, s[8:11], s59 offen lds
    s_waitcnt vmcnt(24)
    ds_read_b128 v[32:35], v6 offset:24576
    ds_read_b128 v[36:39], v6 offset:28672
    ds_read_b128 v[40:43], v6 offset:32768
    ds_read_b128 v[44:47], v6 offset:36864
    ds_read_b128 v[48:51], v7 offset:24576
    ds_read_b128 v[52:55], v7 offset:28672
    ds_read_b128 v[56:59], v7 offset:32768
    ds_read_b128 v[60:63], v7 offset:36864
    s_waitcnt lgkmcnt(4)
    v_perm_b32 v192, v40, v32, s50
    v_perm_b32 v193, v40, v32, s51
    v_perm_b32 v194, v41, v33, s50
    v_perm_b32 v195, v41, v33, s51
    v_perm_b32 v200, v42, v34, s50
    v_perm_b32 v201, v42, v34, s51
    v_perm_b32 v202, v43, v35, s50
    v_perm_b32 v203, v43, v35, s51
    v_perm_b32 v196, v44, v36, s50
    v_perm_b32 v197, v44, v36, s51
    v_perm_b32 v198, v45, v37, s50
    v_perm_b32 v199, v45, v37, s51
    v_perm_b32 v204, v46, v38, s50
    v_perm_b32 v205, v46, v38, s51
    v_perm_b32 v206, v47, v39, s50
    v_perm_b32 v207, v47, v39, s51
    s_waitcnt lgkmcnt(0)
    v_perm_b32 v208, v56, v48, s50
    v_perm_b32 v209, v56, v48, s51
    v_perm_b32 v210, v57, v49, s50
    v_perm_b32 v211, v57, v49, s51
    v_perm_b32 v216, v58, v50, s50
    v_perm_b32 v217, v58, v50, s51
    v_perm_b32 v218, v59, v51, s50
    v_perm_b32 v219, v59, v51, s51
    v_perm_b32 v212, v60, v52, s50
    v_perm_b32 v213, v60, v52, s51
    v_perm_b32 v214, v61, v53, s50
    v_perm_b32 v215, v61, v53, s51
    v_perm_b32 v220, v62, v54, s50
    v_perm_b32 v221, v62, v54, s51
    v_perm_b32 v222, v63, v55, s50
    v_perm_b32 v223, v63, v55, s51
    ds_read_b128 v[32:35], v8 offset:24576
    ds_read_b128 v[36:39], v8 offset:28672
    ds_read_b128 v[40:43], v8 offset:32768
    ds_read_b128 v[44:47], v8 offset:36864
    ds_read_b128 v[48:51], v9 offset:24576
    ds_read_b128 v[52:55], v9 offset:28672
    ds_read_b128 v[56:59], v9 offset:32768
    ds_read_b128 v[60:63], v9 offset:36864
    s_waitcnt lgkmcnt(4)
    v_perm_b32 v224, v40, v32, s50
    v_perm_b32 v225, v40, v32, s51
    v_perm_b32 v226, v41, v33, s50
    v_perm_b32 v227, v41, v33, s51
    v_perm_b32 v232, v42, v34, s50
    v_perm_b32 v233, v42, v34, s51
    v_perm_b32 v234, v43, v35, s50
    v_perm_b32 v235, v43, v35, s51
    v_perm_b32 v228, v44, v36, s50
    v_perm_b32 v229, v44, v36, s51
    v_perm_b32 v230, v45, v37, s50
    v_perm_b32 v231, v45, v37, s51
    v_perm_b32 v236, v46, v38, s50
    v_perm_b32 v237, v46, v38, s51
    v_perm_b32 v238, v47, v39, s50
    v_perm_b32 v239, v47, v39, s51
    s_waitcnt lgkmcnt(0)
    v_perm_b32 v240, v56, v48, s50
    v_perm_b32 v241, v56, v48, s51
    v_perm_b32 v242, v57, v49, s50
    v_perm_b32 v243, v57, v49, s51
    v_perm_b32 v248, v58, v50, s50
    v_perm_b32 v249, v58, v50, s51
    v_perm_b32 v250, v59, v51, s50
    v_perm_b32 v251, v59, v51, s51
    v_perm_b32 v244, v60, v52, s50
    v_perm_b32 v245, v60, v52, s51
    v_perm_b32 v246, v61, v53, s50
    v_perm_b32 v247, v61, v53, s51
    v_perm_b32 v252, v62, v54, s50
    v_perm_b32 v253, v62, v54, s51
    v_perm_b32 v254, v63, v55, s50
    v_perm_b32 v255, v63, v55, s51
    s_add_u32 m0, s42, 24576
    s_add_u32 s59, s57, 384
    buffer_load_dwordx4 v28, s[8:11], s59 offen lds
    s_add_u32 m0, s42, 25600
    s_add_u32 s59, s57, 16768
    buffer_load_dwordx4 v29, s[8:11], s59 offen lds
    s_add_u32 m0, s42, 26624
    s_add_u32 s59, s57, 33152
    buffer_load_dwordx4 v28, s[8:11], s59 offen lds
    s_add_u32 m0, s42, 27648
    s_add_u32 s59, s57, 49536
    buffer_load_dwordx4 v29, s[8:11], s59 offen lds
    s_add_u32 m0, s42, 28672
    s_add_u32 s59, s57, 65920
    buffer_load_dwordx4 v28, s[8:11], s59 offen lds
    s_add_u32 m0, s42, 29696
    s_add_u32 s59, s57, 82304
    buffer_load_dwordx4 v29, s[8:11], s59 offen lds
    s_add_u32 m0, s42, 30720
    s_add_u32 s59, s57, 98688
    buffer_load_dwordx4 v28, s[8:11], s59 offen lds
    s_add_u32 m0, s42, 31744
    s_add_u32 s59, s57, 115072
    buffer_load_dwordx4 v29, s[8:11], s59 offen lds
    s_waitcnt vmcnt(24)
    ds_read_b128 v[32:35], v24 offset:0
    ds_read_b128 v[36:39], v24 offset:4096
    ds_read_b128 v[40:43], v25 offset:0
    ds_read_b128 v[44:47], v25 offset:4096
    s_waitcnt lgkmcnt(2)
    v_mfma_f32_32x32x16_bf16 a[192:207], v[128:131], v[32:35], 0
    ds_read_b128 v[48:51], v26 offset:0
    v_mfma_f32_32x32x16_bf16 a[208:223], v[128:131], v[36:39], 0
    v_mfma_f32_32x32x16_bf16 a[224:239], v[132:135], v[32:35], 0
    ds_read_b128 v[52:55], v26 offset:4096
    v_mfma_f32_32x32x16_bf16 a[240:255], v[132:135], v[36:39], 0
    s_waitcnt lgkmcnt(2)
    s_mul_i32 s44, s3, 6
    s_cmp_eq_u32 s3, 3
    s_cselect_b32 s44, 17, s44
    s_mul_i32 s43, s53, 22
    s_add_u32 s43, s43, s44
    s_lshl_b32 s43, s43, 7
    s_add_u32 s43, s43, 8192
    v_lshl_add_u32 v14, v1, 5, s43
    s_cmp_ge_u32 s3, 2
    s_cselect_b32 s44, 20, 24
    s_bfm_b32 exec_lo, s44, 0
    s_mov_b32 exec_hi, 0
    buffer_load_dwordx2 v[18:19], v14, s[4:7], 0 offen sc1
    s_mov_b64 exec, -1
    v_mfma_f32_32x32x16_bf16 a[192:207], v[136:139], v[40:43], a[192:207]
    ds_read_b128 v[56:59], v27 offset:0
    v_mfma_f32_32x32x16_bf16 a[208:223], v[136:139], v[44:47], a[208:223]
    v_mfma_f32_32x32x16_bf16 a[224:239], v[140:143], v[40:43], a[224:239]
    ds_read_b128 v[60:63], v27 offset:4096
    v_mfma_f32_32x32x16_bf16 a[240:255], v[140:143], v[44:47], a[240:255]
    s_waitcnt vmcnt(17)
    s_waitcnt lgkmcnt(2)
    v_mfma_f32_32x32x16_bf16 a[192:207], v[144:147], v[48:51], a[192:207]
    ds_read_b128 v[32:35], v24 offset:8192
    v_mfma_f32_32x32x16_bf16 a[208:223], v[144:147], v[52:55], a[208:223]
    v_mfma_f32_32x32x16_bf16 a[224:239], v[148:151], v[48:51], a[224:239]
    ds_read_b128 v[36:39], v24 offset:12288
    v_mfma_f32_32x32x16_bf16 a[240:255], v[148:151], v[52:55], a[240:255]
    s_waitcnt lgkmcnt(2)
    v_mfma_f32_32x32x16_bf16 a[192:207], v[152:155], v[56:59], a[192:207]
    ds_read_b128 v[40:43], v25 offset:8192
    v_mfma_f32_32x32x16_bf16 a[208:223], v[152:155], v[60:63], a[208:223]
    v_mfma_f32_32x32x16_bf16 a[224:239], v[156:159], v[56:59], a[224:239]
    ds_read_b128 v[44:47], v25 offset:12288
    v_mfma_f32_32x32x16_bf16 a[240:255], v[156:159], v[60:63], a[240:255]
    s_waitcnt lgkmcnt(2)
    s_waitcnt vmcnt(0)
    s_mul_i32 s44, s3, 6
    s_cmp_eq_u32 s3, 3
    s_cselect_b32 s44, 17, s44
    s_mul_i32 s43, s53, 22
    s_add_u32 s43, s43, s44
    s_lshl_b32 s43, s43, 7
    s_add_u32 s43, s43, 8192
    v_lshl_add_u32 v14, v1, 5, s43
    s_cmp_ge_u32 s3, 2
    s_cselect_b32 s44, 20, 24
    s_bfm_b32 exec_lo, s44, 0
    s_mov_b32 exec_hi, 0
    s_mov_b32 s60, 20000
    s_branch L_pollc_80
L_poll_79:
    buffer_load_dwordx2 v[18:19], v14, s[4:7], 0 offen sc1
    s_waitcnt vmcnt(0)
L_pollc_80:
    v_cmp_ne_u64 vcc, s[100:101], v[18:19]
    s_cbranch_vccz L_polld_81
    s_sleep 4
    s_sub_u32 s60, s60, 1
    s_cmp_lg_u32 s60, 0
    s_cbranch_scc1 L_poll_79
L_polld_81:
    s_mov_b64 exec, -1
    v_lshrrev_b32 v14, 3, v1
    v_mul_u32_u24 v14, 64, v14
    v_and_b32 v15, 7, v1
    v_lshrrev_b32 v16, 4, v1
    v_xor_b32 v15, v15, v16
    v_and_b32 v16, 3, v15
    v_lshrrev_b32 v15, 2, v15
    v_lshlrev_b32 v15, 12, v15
    v_lshl_add_u32 v15, v16, 4, v15
    v_add_u32 v2, v14, v15
    v_xor_b32 v15, 4096, v15
    v_add_u32 v3, v14, v15
    v_mfma_f32_32x32x16_bf16 a[192:207], v[160:163], v[32:35], a[192:207]
    ds_read_b128 v[48:51], v26 offset:8192
    s_add_u32 m0, s42, 32768
    s_add_u32 s59, s83, 0
    buffer_load_dwordx4 v2, s[12:15], s59 offen lds
    v_mfma_f32_32x32x16_bf16 a[208:223], v[160:163], v[36:39], a[208:223]
    s_add_u32 m0, s42, 33792
    s_add_u32 s59, s83, 512
    buffer_load_dwordx4 v3, s[12:15], s59 offen lds
    v_mfma_f32_32x32x16_bf16 a[224:239], v[164:167], v[32:35], a[224:239]
    ds_read_b128 v[52:55], v26 offset:12288
    s_add_u32 m0, s42, 34816
    s_add_u32 s59, s83, 1024
    buffer_load_dwordx4 v2, s[12:15], s59 offen lds
    v_mfma_f32_32x32x16_bf16 a[240:255], v[164:167], v[36:39], a[240:255]
    s_add_u32 m0, s42, 35840
    s_add_u32 s59, s83, 1536
    buffer_load_dwordx4 v3, s[12:15], s59 offen lds
    s_waitcnt lgkmcnt(2)
    v_mfma_f32_32x32x16_bf16 a[192:207], v[168:171], v[40:43], a[192:207]
    ds_read_b128 v[56:59], v27 offset:8192
    s_add_u32 m0, s42, 36864
    s_add_u32 s59, s83, 2048
    buffer_load_dwordx4 v2, s[12:15], s59 offen lds
    v_mfma_f32_32x32x16_bf16 a[208:223], v[168:171], v[44:47], a[208:223]
    s_add_u32 m0, s42, 37888
    s_add_u32 s59, s83, 2560
    buffer_load_dwordx4 v3, s[12:15], s59 offen lds
    v_mfma_f32_32x32x16_bf16 a[224:239], v[172:175], v[40:43], a[224:239]
    ds_read_b128 v[60:63], v27 offset:12288
    s_add_u32 m0, s42, 38912
    s_add_u32 s59, s83, 3072
    buffer_load_dwordx4 v2, s[12:15], s59 offen lds
    v_mfma_f32_32x32x16_bf16 a[240:255], v[172:175], v[44:47], a[240:255]
    s_add_u32 m0, s42, 39936
    s_add_u32 s59, s83, 3584
    buffer_load_dwordx4 v3, s[12:15], s59 offen lds
    s_waitcnt lgkmcnt(2)
    v_mfma_f32_32x32x16_bf16 a[192:207], v[176:179], v[48:51], a[192:207]
    ds_read_b128 v[32:35], v24 offset:16384
    s_add_u32 m0, s42, 0
    s_add_u32 s59, s83, 8192
    buffer_load_dwordx4 v2, s[12:15], s59 offen lds
    v_mfma_f32_32x32x16_bf16 a[208:223], v[176:179], v[52:55], a[208:223]
    s_add_u32 m0, s42, 1024
    s_add_u32 s59, s83, 8704
    buffer_load_dwordx4 v3, s[12:15], s59 offen lds
    v_mfma_f32_32x32x16_bf16 a[224:239], v[180:183], v[48:51], a[224:239]
    ds_read_b128 v[36:39], v24 offset:20480
    s_add_u32 m0, s42, 2048
    s_add_u32 s59, s83, 9216
    buffer_load_dwordx4 v2, s[12:15], s59 offen lds
    v_mfma_f32_32x32x16_bf16 a[240:255], v[180:183], v[52:55], a[240:255]
    s_add_u32 m0, s42, 3072
    s_add_u32 s59, s83, 9728
    buffer_load_dwordx4 v3, s[12:15], s59 offen lds
    s_waitcnt lgkmcnt(2)
    v_mfma_f32_32x32x16_bf16 a[192:207], v[184:187], v[56:59], a[192:207]
    ds_read_b128 v[40:43], v25 offset:16384
    s_add_u32 m0, s42, 4096
    s_add_u32 s59, s83, 10240
    buffer_load_dwordx4 v2, s[12:15], s59 offen lds
    v_mfma_f32_32x32x16_bf16 a[208:223], v[184:187], v[60:63], a[208:223]
    s_add_u32 m0, s42, 5120
    s_add_u32 s59, s83, 10752
    buffer_load_dwordx4 v3, s[12:15], s59 offen lds
    v_mfma_f32_32x32x16_bf16 a[224:239], v[188:191], v[56:59], a[224:239]
    ds_read_b128 v[44:47], v25 offset:20480
    s_add_u32 m0, s42, 6144
    s_add_u32 s59, s83, 11264
    buffer_load_dwordx4 v2, s[12:15], s59 offen lds
    v_mfma_f32_32x32x16_bf16 a[240:255], v[188:191], v[60:63], a[240:255]
    s_add_u32 m0, s42, 7168
    s_add_u32 s59, s83, 11776
    buffer_load_dwordx4 v3, s[12:15], s59 offen lds
    s_waitcnt lgkmcnt(2)
    v_mfma_f32_32x32x16_bf16 a[192:207], v[192:195], v[32:35], a[192:207]
    ds_read_b128 v[48:51], v26 offset:16384
    v_mfma_f32_32x32x16_bf16 a[208:223], v[192:195], v[36:39], a[208:223]
    s_add_u32 m0, s42, 8192
    s_add_u32 s59, s83, 16384
    buffer_load_dwordx4 v2, s[12:15], s59 offen lds
    v_mfma_f32_32x32x16_bf16 a[224:239], v[196:199], v[32:35], a[224:239]
    ds_read_b128 v[52:55], v26 offset:20480
    v_mfma_f32_32x32x16_bf16 a[240:255], v[196:199], v[36:39], a[240:255]
    s_add_u32 m0, s42, 9216
    s_add_u32 s59, s83, 16896
    buffer_load_dwordx4 v3, s[12:15], s59 offen lds
    s_waitcnt lgkmcnt(2)
    v_mfma_f32_32x32x16_bf16 a[192:207], v[200:203], v[40:43], a[192:207]
    ds_read_b128 v[56:59], v27 offset:16384
    v_mfma_f32_32x32x16_bf16 a[208:223], v[200:203], v[44:47], a[208:223]
    s_add_u32 m0, s42, 10240
    s_add_u32 s59, s83, 17408
    buffer_load_dwordx4 v2, s[12:15], s59 offen lds
    v_mfma_f32_32x32x16_bf16 a[224:239], v[204:207], v[40:43], a[224:239]
    ds_read_b128 v[60:63], v27 offset:20480
    v_mfma_f32_32x32x16_bf16 a[240:255], v[204:207], v[44:47], a[240:255]
    s_add_u32 m0, s42, 11264
    s_add_u32 s59, s83, 17920
    buffer_load_dwordx4 v3, s[12:15], s59 offen lds
    s_waitcnt lgkmcnt(2)
    v_mfma_f32_32x32x16_bf16 a[192:207], v[208:211], v[48:51], a[192:207]
    ds_read_b128 v[32:35], v24 offset:24576
    v_mfma_f32_32x32x16_bf16 a[208:223], v[208:211], v[52:55], a[208:223]
    s_add_u32 m0, s42, 12288
    s_add_u32 s59, s83, 18432
    buffer_load_dwordx4 v2, s[12:15], s59 offen lds
    v_mfma_f32_32x32x16_bf16 a[224:239], v[212:215], v[48:51], a[224:239]
    ds_read_b128 v[36:39], v24 offset:28672
    v_mfma_f32_32x32x16_bf16 a[240:255], v[212:215], v[52:55], a[240:255]
    s_add_u32 m0, s42, 13312
    s_add_u32 s59, s83, 18944
    buffer_load_dwordx4 v3, s[12:15], s59 offen lds
    s_waitcnt lgkmcnt(2)
    v_mfma_f32_32x32x16_bf16 a[192:207], v[216:219], v[56:59], a[192:207]
    ds_read_b128 v[40:43], v25 offset:24576
    v_mfma_f32_32x32x16_bf16 a[208:223], v[216:219], v[60:63], a[208:223]
    s_add_u32 m0, s42, 14336
    s_add_u32 s59, s83, 19456
    buffer_load_dwordx4 v2, s[12:15], s59 offen lds
    v_mfma_f32_32x32x16_bf16 a[224:239], v[220:223], v[56:59], a[224:239]
    ds_read_b128 v[44:47], v25 offset:28672
    v_mfma_f32_32x32x16_bf16 a[240:255], v[220:223], v[60:63], a[240:255]
    s_add_u32 m0, s42, 15360
    s_add_u32 s59, s83, 19968
    buffer_load_dwordx4 v3, s[12:15], s59 offen lds
    s_waitcnt lgkmcnt(2)
    v_mfma_f32_32x32x16_bf16 a[192:207], v[224:227], v[32:35], a[192:207]
    ds_read_b128 v[48:51], v26 offset:24576
    v_mfma_f32_32x32x16_bf16 a[208:223], v[224:227], v[36:39], a[208:223]
    s_add_u32 m0, s42, 16384
    s_add_u32 s59, s83, 24576
    buffer_load_dwordx4 v2, s[12:15], s59 offen lds
    v_mfma_f32_32x32x16_bf16 a[224:239], v[228:231], v[32:35], a[224:239]
    ds_read_b128 v[52:55], v26 offset:28672
    v_mfma_f32_32x32x16_bf16 a[240:255], v[228:231], v[36:39], a[240:255]
    s_add_u32 m0, s42, 17408
    s_add_u32 s59, s83, 25088
    buffer_load_dwordx4 v3, s[12:15], s59 offen lds
    s_waitcnt lgkmcnt(2)
    v_mfma_f32_32x32x16_bf16 a[192:207], v[232:235], v[40:43], a[192:207]
    ds_read_b128 v[56:59], v27 offset:24576
    v_mfma_f32_32x32x16_bf16 a[208:223], v[232:235], v[44:47], a[208:223]
    s_add_u32 m0, s42, 18432
    s_add_u32 s59, s83, 25600
    buffer_load_dwordx4 v2, s[12:15], s59 offen lds
    v_mfma_f32_32x32x16_bf16 a[224:239], v[236:239], v[40:43], a[224:239]
    ds_read_b128 v[60:63], v27 offset:28672
    v_mfma_f32_32x32x16_bf16 a[240:255], v[236:239], v[44:47], a[240:255]
    s_add_u32 m0, s42, 19456
    s_add_u32 s59, s83, 26112
    buffer_load_dwordx4 v3, s[12:15], s59 offen lds
    s_waitcnt vmcnt(20)
    s_waitcnt lgkmcnt(2)
    v_mfma_f32_32x32x16_bf16 a[192:207], v[240:243], v[48:51], a[192:207]
    ds_read_b128 v[32:35], v6 offset:32768
    v_mfma_f32_32x32x16_bf16 a[208:223], v[240:243], v[52:55], a[208:223]
    s_add_u32 m0, s42, 20480
    s_add_u32 s59, s83, 26624
    buffer_load_dwordx4 v2, s[12:15], s59 offen lds
    v_mfma_f32_32x32x16_bf16 a[224:239], v[244:247], v[48:51], a[224:239]
    ds_read_b128 v[36:39], v6 offset:36864
    v_mfma_f32_32x32x16_bf16 a[240:255], v[244:247], v[52:55], a[240:255]
    s_add_u32 m0, s42, 21504
    s_add_u32 s59, s83, 27136
    buffer_load_dwordx4 v3, s[12:15], s59 offen lds
    s_waitcnt lgkmcnt(2)
    v_mfma_f32_32x32x16_bf16 a[192:207], v[248:251], v[56:59], a[192:207]
    ds_read_b128 v[40:43], v7 offset:32768
    v_mfma_f32_32x32x16_bf16 a[208:223], v[248:251], v[60:63], a[208:223]
    s_add_u32 m0, s42, 22528
    s_add_u32 s59, s83, 27648
    buffer_load_dwordx4 v2, s[12:15], s59 offen lds
    v_mfma_f32_32x32x16_bf16 a[224:239], v[252:255], v[56:59], a[224:239]
    ds_read_b128 v[44:47], v7 offset:36864
    v_mfma_f32_32x32x16_bf16 a[240:255], v[252:255], v[60:63], a[240:255]
    s_add_u32 m0, s42, 23552
    s_add_u32 s59, s83, 28160
    buffer_load_dwordx4 v3, s[12:15], s59 offen lds
    s_waitcnt lgkmcnt(2)
    v_mfma_f32_32x32x16_bf16 v[64:79], v[32:35], a[0:3], 0
    ds_read_b128 v[48:51], v8 offset:32768
    v_mfma_f32_32x32x16_bf16 v[80:95], v[32:35], a[4:7], 0
    s_add_u32 m0, s42, 24576
    s_add_u32 s59, s83, 32768
    buffer_load_dwordx4 v2, s[12:15], s59 offen lds
    v_mfma_f32_32x32x16_bf16 v[96:111], v[36:39], a[0:3], 0
    ds_read_b128 v[52:55], v8 offset:36864
    v_mfma_f32_32x32x16_bf16 v[112:127], v[36:39], a[4:7], 0
    s_add_u32 m0, s42, 25600
    s_add_u32 s59, s83, 33280
    buffer_load_dwordx4 v3, s[12:15], s59 offen lds
    s_waitcnt lgkmcnt(2)
    v_mfma_f32_32x32x16_bf16 v[64:79], v[40:43], a[8:11], v[64:79]
    ds_read_b128 v[56:59], v9 offset:32768
    v_mfma_f32_32x32x16_bf16 v[80:95], v[40:43], a[12:15], v[80:95]
    s_add_u32 m0, s42, 26624
    s_add_u32 s59, s83, 33792
    buffer_load_dwordx4 v2, s[12:15], s59 offen lds
    v_mfma_f32_32x32x16_bf16 v[96:111], v[44:47], a[8:11], v[96:111]
    ds_read_b128 v[60:63], v9 offset:36864
    v_mfma_f32_32x32x16_bf16 v[112:127], v[44:47], a[12:15], v[112:127]
    s_add_u32 m0, s42, 27648
    s_add_u32 s59, s83, 34304
    buffer_load_dwordx4 v3, s[12:15], s59 offen lds
    s_waitcnt vmcnt(20)
    s_waitcnt lgkmcnt(2)
    v_mfma_f32_32x32x16_bf16 v[64:79], v[48:51], a[16:19], v[64:79]
    ds_read_b128 v[32:35], v6 offset:0
    v_mfma_f32_32x32x16_bf16 v[80:95], v[48:51], a[20:23], v[80:95]
    s_add_u32 m0, s42, 28672
    s_add_u32 s59, s83, 34816
    buffer_load_dwordx4 v2, s[12:15], s59 offen lds
    v_mfma_f32_32x32x16_bf16 v[96:111], v[52:55], a[16:19], v[96:111]
    ds_read_b128 v[36:39], v6 offset:4096
    v_mfma_f32_32x32x16_bf16 v[112:127], v[52:55], a[20:23], v[112:127]
    s_add_u32 m0, s42, 29696
    s_add_u32 s59, s83, 35328
    buffer_load_dwordx4 v3, s[12:15], s59 offen lds
    s_waitcnt lgkmcnt(2)
    v_mfma_f32_32x32x16_bf16 v[64:79], v[56:59], a[24:27], v[64:79]
    ds_read_b128 v[40:43], v7 offset:0
    v_mfma_f32_32x32x16_bf16 v[80:95], v[56:59], a[28:31], v[80:95]
    s_add_u32 m0, s42, 30720
    s_add_u32 s59, s83, 35840
    buffer_load_dwordx4 v2, s[12:15], s59 offen lds
    v_mfma_f32_32x32x16_bf16 v[96:111], v[60:63], a[24:27], v[96:111]
    ds_read_b128 v[44:47], v7 offset:4096
    v_mfma_f32_32x32x16_bf16 v[112:127], v[60:63], a[28:31], v[112:127]
    s_add_u32 m0, s42, 31744
    s_add_u32 s59, s83, 36352
    buffer_load_dwordx4 v3, s[12:15], s59 offen lds
    s_waitcnt lgkmcnt(2)
    v_mfma_f32_32x32x16_bf16 v[64:79], v[32:35], a[32:35], v[64:79]
    ds_read_b128 v[48:51], v8 offset:0
    v_mfma_f32_32x32x16_bf16 v[80:95], v[32:35], a[36:39], v[80:95]
    s_add_u32 m0, s42, 32768
    s_add_u32 s59, s82, 40960
    buffer_load_dwordx4 v2, s[12:15], s59 offen lds
    v_mfma_f32_32x32x16_bf16 v[96:111], v[36:39], a[32:35], v[96:111]
    ds_read_b128 v[52:55], v8 offset:4096
    v_mfma_f32_32x32x16_bf16 v[112:127], v[36:39], a[36:39], v[112:127]
    s_add_u32 m0, s42, 33792
    s_add_u32 s59, s82, 41472
    buffer_load_dwordx4 v3, s[12:15], s59 offen lds
    s_waitcnt lgkmcnt(2)
    v_mfma_f32_32x32x16_bf16 v[64:79], v[40:43], a[40:43], v[64:79]
    ds_read_b128 v[56:59], v9 offset:0
    v_mfma_f32_32x32x16_bf16 v[80:95], v[40:43], a[44:47], v[80:95]
    s_add_u32 m0, s42, 34816
    s_add_u32 s59, s82, 41984
    buffer_load_dwordx4 v2, s[12:15], s59 offen lds
    v_mfma_f32_32x32x16_bf16 v[96:111], v[44:47], a[40:43], v[96:111]
    ds_read_b128 v[60:63], v9 offset:4096
    v_mfma_f32_32x32x16_bf16 v[112:127], v[44:47], a[44:47], v[112:127]
    s_add_u32 m0, s42, 35840
    s_add_u32 s59, s82, 42496
    buffer_load_dwordx4 v3, s[12:15], s59 offen lds
    s_waitcnt vmcnt(20)
    s_waitcnt lgkmcnt(2)
    v_mfma_f32_32x32x16_bf16 v[64:79], v[48:51], a[48:51], v[64:79]
    ds_read_b128 v[32:35], v6 offset:8192
    v_mfma_f32_32x32x16_bf16 v[80:95], v[48:51], a[52:55], v[80:95]
    s_add_u32 m0, s42, 36864
    s_add_u32 s59, s82, 43008
    buffer_load_dwordx4 v2, s[12:15], s59 offen lds
    v_mfma_f32_32x32x16_bf16 v[96:111], v[52:55], a[48:51], v[96:111]
    ds_read_b128 v[36:39], v6 offset:12288
    v_mfma_f32_32x32x16_bf16 v[112:127], v[52:55], a[52:55], v[112:127]
    s_add_u32 m0, s42, 37888
    s_add_u32 s59, s82, 43520
    buffer_load_dwordx4 v3, s[12:15], s59 offen lds
    s_waitcnt lgkmcnt(2)
    v_mfma_f32_32x32x16_bf16 v[64:79], v[56:59], a[56:59], v[64:79]
    ds_read_b128 v[40:43], v7 offset:8192
    v_mfma_f32_32x32x16_bf16 v[80:95], v[56:59], a[60:63], v[80:95]
    s_add_u32 m0, s42, 38912
    s_add_u32 s59, s82, 44032
    buffer_load_dwordx4 v2, s[12:15], s59 offen lds
    v_mfma_f32_32x32x16_bf16 v[96:111], v[60:63], a[56:59], v[96:111]
    ds_read_b128 v[44:47], v7 offset:12288
    v_mfma_f32_32x32x16_bf16 v[112:127], v[60:63], a[60:63], v[112:127]
    s_add_u32 m0, s42, 39936
    s_add_u32 s59, s82, 44544
    buffer_load_dwordx4 v3, s[12:15], s59 offen lds
    s_waitcnt lgkmcnt(2)
    v_mfma_f32_32x32x16_bf16 v[64:79], v[32:35], a[64:67], v[64:79]
    ds_read_b128 v[48:51], v8 offset:8192
    v_mfma_f32_32x32x16_bf16 v[80:95], v[32:35], a[68:71], v[80:95]
    v_mfma_f32_32x32x16_bf16 v[96:111], v[36:39], a[64:67], v[96:111]
    ds_read_b128 v[52:55], v8 offset:12288
    v_mfma_f32_32x32x16_bf16 v[112:127], v[36:39], a[68:71], v[112:127]
    s_waitcnt lgkmcnt(2)
    s_mov_b32 s16, s64
    s_and_b32 s17, s65, 0xffff
    s_mov_b32 s18, 2097152
    s_mov_b32 s19, 0x00020000
    s_mov_b32 s20, s80
    s_and_b32 s21, s81, 0xffff
    s_mov_b32 s22, 1024
    s_mov_b32 s23, 0x00020000
    s_mov_b32 s24, s90
    s_and_b32 s25, s91, 0xffff
    s_mov_b32 s26, 4096
    s_mov_b32 s27, 0x00020000
    s_add_u32 s28, s98, 2097152
    s_addc_u32 s29, s99, 0
    s_and_b32 s29, s29, 0xffff
    s_mov_b32 s30, 98304
    s_mov_b32 s31, 0x00020000
    s_mov_b32 s32, s94
    s_and_b32 s33, s95, 0xffff
    s_mov_b32 s34, 4194304
    s_mov_b32 s35, 0x00020000
    v_and_b32 v20, 31, v1
    s_lshl_b32 s43, s52, 1
    s_and_b32 s44, s3, 1
    s_add_u32 s43, s43, s44
    s_lshl_b32 s43, s43, 5
    v_add_u32 v20, s43, v20
    v_lshrrev_b32 v21, 5, v1
    s_lshl_b32 s43, s53, 1
    s_lshr_b32 s44, s3, 1
    s_add_u32 s43, s43, s44
    s_lshl_b32 s43, s43, 5
    v_lshl_add_u32 v21, v21, 2, s43
    v_lshl_add_u32 v22, v20, 9, v21
    v_lshlrev_b32 v23, 1, v22
    buffer_load_dwordx2 v[192:193], v23, s[16:19], 0 offen offset:0
    buffer_load_dwordx2 v[194:195], v23, s[16:19], 0 offen offset:16
    buffer_load_dwordx2 v[196:197], v23, s[16:19], 0 offen offset:32
    buffer_load_dwordx2 v[198:199], v23, s[16:19], 0 offen offset:48
    v_lshlrev_b32 v23, 1, v21
    buffer_load_dwordx2 v[200:201], v23, s[20:23], 0 offen offset:0
    buffer_load_dwordx2 v[202:203], v23, s[20:23], 0 offen offset:16
    buffer_load_dwordx2 v[204:205], v23, s[20:23], 0 offen offset:32
    buffer_load_dwordx2 v[206:207], v23, s[20:23], 0 offen offset:48
    v_lshlrev_b32 v23, 1, v20
    buffer_load_ushort v208, v23, s[24:27], 0 offen
    v_lshrrev_b32 v23, 2, v20
    v_and_b32 v19, 3, v20
    v_lshlrev_b32 v19, 2, v19
    v_lshl_add_u32 v23, v23, 7, v19
    buffer_load_dword v209, v23, s[28:31], 0 offen sc1
    v_lshl_add_u32 v212, v1, 4, s42
    v_mfma_f32_32x32x16_bf16 v[64:79], v[40:43], a[72:75], v[64:79]
    ds_read_b128 v[56:59], v9 offset:8192
    v_mfma_f32_32x32x16_bf16 v[80:95], v[40:43], a[76:79], v[80:95]
    v_mfma_f32_32x32x16_bf16 v[96:111], v[44:47], a[72:75], v[96:111]
    ds_read_b128 v[60:63], v9 offset:12288
    v_mfma_f32_32x32x16_bf16 v[112:127], v[44:47], a[76:79], v[112:127]
    s_waitcnt vmcnt(26)
    s_waitcnt lgkmcnt(2)
    v_mfma_f32_32x32x16_bf16 v[64:79], v[48:51], a[80:83], v[64:79]
    ds_read_b128 v[32:35], v6 offset:16384
    v_mfma_f32_32x32x16_bf16 v[80:95], v[48:51], a[84:87], v[80:95]
    v_mfma_f32_32x32x16_bf16 v[96:111], v[52:55], a[80:83], v[96:111]
    ds_read_b128 v[36:39], v6 offset:20480
    v_mfma_f32_32x32x16_bf16 v[112:127], v[52:55], a[84:87], v[112:127]
    s_waitcnt lgkmcnt(2)
    v_mfma_f32_32x32x16_bf16 v[64:79], v[56:59], a[88:91], v[64:79]
    ds_read_b128 v[40:43], v7 offset:16384
    v_mfma_f32_32x32x16_bf16 v[80:95], v[56:59], a[92:95], v[80:95]
    v_mfma_f32_32x32x16_bf16 v[96:111], v[60:63], a[88:91], v[96:111]
    ds_read_b128 v[44:47], v7 offset:20480
    v_mfma_f32_32x32x16_bf16 v[112:127], v[60:63], a[92:95], v[112:127]
    s_waitcnt lgkmcnt(2)
    s_cmp_eq_u32 s3, 0
    s_cbranch_scc1 L_xw_82
    ds_write_b128 v212, a[192:195] offset:0
    ds_write_b128 v212, a[196:199] offset:1024
    ds_write_b128 v212, a[200:203] offset:2048
    ds_write_b128 v212, a[204:207] offset:3072
L_xw_82:
    v_mfma_f32_32x32x16_bf16 v[64:79], v[32:35], a[96:99], v[64:79]
    ds_read_b128 v[48:51], v8 offset:16384
    v_mfma_f32_32x32x16_bf16 v[80:95], v[32:35], a[100:103], v[80:95]
    v_mfma_f32_32x32x16_bf16 v[96:111], v[36:39], a[96:99], v[96:111]
    ds_read_b128 v[52:55], v8 offset:20480
    v_mfma_f32_32x32x16_bf16 v[112:127], v[36:39], a[100:103], v[112:127]
    s_waitcnt lgkmcnt(2)
    s_cmp_eq_u32 s3, 1
    s_cbranch_scc1 L_xw_83
    ds_write_b128 v212, a[208:211] offset:4096
    ds_write_b128 v212, a[212:215] offset:5120
    ds_write_b128 v212, a[216:219] offset:6144
    ds_write_b128 v212, a[220:223] offset:7168
L_xw_83:
    v_mfma_f32_32x32x16_bf16 v[64:79], v[40:43], a[104:107], v[64:79]
    ds_read_b128 v[56:59], v9 offset:16384
    v_mfma_f32_32x32x16_bf16 v[80:95], v[40:43], a[108:111], v[80:95]
    v_mfma_f32_32x32x16_bf16 v[96:111], v[44:47], a[104:107], v[96:111]
    ds_read_b128 v[60:63], v9 offset:20480
    v_mfma_f32_32x32x16_bf16 v[112:127], v[44:47], a[108:111], v[112:127]
    s_waitcnt vmcnt(18)
    s_waitcnt lgkmcnt(2)
    s_cmp_eq_u32 s3, 2
    s_cbranch_scc1 L_xw_84
    ds_write_b128 v212, a[224:227] offset:8192
    ds_write_b128 v212, a[228:231] offset:9216
    ds_write_b128 v212, a[232:235] offset:10240
    ds_write_b128 v212, a[236:239] offset:11264
L_xw_84:
    v_mfma_f32_32x32x16_bf16 v[64:79], v[48:51], a[112:115], v[64:79]
    ds_read_b128 v[32:35], v6 offset:24576
    v_mfma_f32_32x32x16_bf16 v[80:95], v[48:51], a[116:119], v[80:95]
    v_mfma_f32_32x32x16_bf16 v[96:111], v[52:55], a[112:115], v[96:111]
    ds_read_b128 v[36:39], v6 offset:28672
    v_mfma_f32_32x32x16_bf16 v[112:127], v[52:55], a[116:119], v[112:127]
    s_waitcnt lgkmcnt(2)
    s_cmp_eq_u32 s3, 3
    s_cbranch_scc1 L_xw_85
    ds_write_b128 v212, a[240:243] offset:12288
    ds_write_b128 v212, a[244:247] offset:13312
    ds_write_b128 v212, a[248:251] offset:14336
    ds_write_b128 v212, a[252:255] offset:15360
L_xw_85:
    v_mfma_f32_32x32x16_bf16 v[64:79], v[56:59], a[120:123], v[64:79]
    ds_read_b128 v[40:43], v7 offset:24576
    v_mfma_f32_32x32x16_bf16 v[80:95], v[56:59], a[124:127], v[80:95]
    v_mfma_f32_32x32x16_bf16 v[96:111], v[60:63], a[120:123], v[96:111]
    ds_read_b128 v[44:47], v7 offset:28672
    v_mfma_f32_32x32x16_bf16 v[112:127], v[60:63], a[124:127], v[112:127]
    s_waitcnt lgkmcnt(2)
    s_cmp_ge_u32 s3, 2
    s_cselect_b32 s43, 1, 0
    s_lshl_b32 s43, s43, 1
    s_and_b32 s44, s3, 1
    s_add_u32 s43, s43, s44
    s_lshl_b32 s43, s43, 12
    s_add_u32 s44, s3, 1
    s_and_b32 s44, s44, 3
    s_mul_i32 s44, s44, 40960
    s_add_u32 s44, s44, s43
    v_lshl_add_u32 v213, v1, 4, s44
    s_add_u32 s44, s3, 2
    s_and_b32 s44, s44, 3
    s_mul_i32 s44, s44, 40960
    s_add_u32 s44, s44, s43
    v_lshl_add_u32 v214, v1, 4, s44
    s_add_u32 s44, s3, 3
    s_and_b32 s44, s44, 3
    s_mul_i32 s44, s44, 40960
    s_add_u32 s44, s44, s43
    v_lshl_add_u32 v215, v1, 4, s44
    v_mfma_f32_32x32x16_bf16 v[64:79], v[32:35], a[128:131], v[64:79]
    ds_read_b128 v[48:51], v8 offset:24576
    v_mfma_f32_32x32x16_bf16 v[80:95], v[32:35], a[132:135], v[80:95]
    v_mfma_f32_32x32x16_bf16 v[96:111], v[36:39], a[128:131], v[96:111]
    ds_read_b128 v[52:55], v8 offset:28672
    v_mfma_f32_32x32x16_bf16 v[112:127], v[36:39], a[132:135], v[112:127]
    s_waitcnt lgkmcnt(2)
    s_cmp_eq_u32 s3, 1
    s_cbranch_scc1 L_ow_88
    s_cmp_eq_u32 s3, 2
    s_cbranch_scc1 L_ow_89
    s_cmp_eq_u32 s3, 3
    s_cbranch_scc1 L_ow_90
L_ow_87:
    v_accvgpr_read_b32 v224, a192
    v_accvgpr_read_b32 v225, a193
    v_accvgpr_read_b32 v226, a194
    v_accvgpr_read_b32 v227, a195
    v_accvgpr_read_b32 v228, a196
    v_accvgpr_read_b32 v229, a197
    v_accvgpr_read_b32 v230, a198
    v_accvgpr_read_b32 v231, a199
    v_accvgpr_read_b32 v232, a200
    v_accvgpr_read_b32 v233, a201
    v_accvgpr_read_b32 v234, a202
    v_accvgpr_read_b32 v235, a203
    v_accvgpr_read_b32 v236, a204
    v_accvgpr_read_b32 v237, a205
    v_accvgpr_read_b32 v238, a206
    v_accvgpr_read_b32 v239, a207
    s_branch L_oe_86
L_ow_88:
    v_accvgpr_read_b32 v224, a208
    v_accvgpr_read_b32 v225, a209
    v_accvgpr_read_b32 v226, a210
    v_accvgpr_read_b32 v227, a211
    v_accvgpr_read_b32 v228, a212
    v_accvgpr_read_b32 v229, a213
    v_accvgpr_read_b32 v230, a214
    v_accvgpr_read_b32 v231, a215
    v_accvgpr_read_b32 v232, a216
    v_accvgpr_read_b32 v233, a217
    v_accvgpr_read_b32 v234, a218
    v_accvgpr_read_b32 v235, a219
    v_accvgpr_read_b32 v236, a220
    v_accvgpr_read_b32 v237, a221
    v_accvgpr_read_b32 v238, a222
    v_accvgpr_read_b32 v239, a223
    s_branch L_oe_86
L_ow_89:
    v_accvgpr_read_b32 v224, a224
    v_accvgpr_read_b32 v225, a225
    v_accvgpr_read_b32 v226, a226
    v_accvgpr_read_b32 v227, a227
    v_accvgpr_read_b32 v228, a228
    v_accvgpr_read_b32 v229, a229
    v_accvgpr_read_b32 v230, a230
    v_accvgpr_read_b32 v231, a231
    v_accvgpr_read_b32 v232, a232
    v_accvgpr_read_b32 v233, a233
    v_accvgpr_read_b32 v234, a234
    v_accvgpr_read_b32 v235, a235
    v_accvgpr_read_b32 v236, a236
    v_accvgpr_read_b32 v237, a237
    v_accvgpr_read_b32 v238, a238
    v_accvgpr_read_b32 v239, a239
    s_branch L_oe_86
L_ow_90:
    v_accvgpr_read_b32 v224, a240
    v_accvgpr_read_b32 v225, a241
    v_accvgpr_read_b32 v226, a242
    v_accvgpr_read_b32 v227, a243
    v_accvgpr_read_b32 v228, a244
    v_accvgpr_read_b32 v229, a245
    v_accvgpr_read_b32 v230, a246
    v_accvgpr_read_b32 v231, a247
    v_accvgpr_read_b32 v232, a248
    v_accvgpr_read_b32 v233, a249
    v_accvgpr_read_b32 v234, a250
    v_accvgpr_read_b32 v235, a251
    v_accvgpr_read_b32 v236, a252
    v_accvgpr_read_b32 v237, a253
    v_accvgpr_read_b32 v238, a254
    v_accvgpr_read_b32 v239, a255
L_oe_86:
    v_mfma_f32_32x32x16_bf16 v[64:79], v[40:43], a[136:139], v[64:79]
    ds_read_b128 v[56:59], v9 offset:24576
    v_mfma_f32_32x32x16_bf16 v[80:95], v[40:43], a[140:143], v[80:95]
    v_mfma_f32_32x32x16_bf16 v[96:111], v[44:47], a[136:139], v[96:111]
    ds_read_b128 v[60:63], v9 offset:28672
    v_mfma_f32_32x32x16_bf16 v[112:127], v[44:47], a[140:143], v[112:127]
    s_waitcnt vmcnt(10)
    s_waitcnt lgkmcnt(2)
    v_mfma_f32_32x32x16_bf16 v[64:79], v[48:51], a[144:147], v[64:79]
    ds_read_b128 v[32:35], v6 offset:32768
    v_mfma_f32_32x32x16_bf16 v[80:95], v[48:51], a[148:151], v[80:95]
    v_mfma_f32_32x32x16_bf16 v[96:111], v[52:55], a[144:147], v[96:111]
    ds_read_b128 v[36:39], v6 offset:36864
    v_mfma_f32_32x32x16_bf16 v[112:127], v[52:55], a[148:151], v[112:127]
    s_waitcnt lgkmcnt(2)
    v_mfma_f32_32x32x16_bf16 v[64:79], v[56:59], a[152:155], v[64:79]
    ds_read_b128 v[40:43], v7 offset:32768
    v_mfma_f32_32x32x16_bf16 v[80:95], v[56:59], a[156:159], v[80:95]
    v_mfma_f32_32x32x16_bf16 v[96:111], v[60:63], a[152:155], v[96:111]
    ds_read_b128 v[44:47], v7 offset:36864
    v_mfma_f32_32x32x16_bf16 v[112:127], v[60:63], a[156:159], v[112:127]
    s_cmp_ge_u32 s3, 2
    s_cbranch_scc1 L_sk_91
    s_waitcnt lgkmcnt(2)
    v_mfma_f32_32x32x16_bf16 v[64:79], v[32:35], a[160:163], v[64:79]
    ds_read_b128 v[48:51], v8 offset:32768
    v_mfma_f32_32x32x16_bf16 v[80:95], v[32:35], a[164:167], v[80:95]
    v_mfma_f32_32x32x16_bf16 v[96:111], v[36:39], a[160:163], v[96:111]
    ds_read_b128 v[52:55], v8 offset:36864
    v_mfma_f32_32x32x16_bf16 v[112:127], v[36:39], a[164:167], v[112:127]
    s_waitcnt lgkmcnt(2)
    v_mfma_f32_32x32x16_bf16 v[64:79], v[40:43], a[168:171], v[64:79]
    ds_read_b128 v[56:59], v9 offset:32768
    v_mfma_f32_32x32x16_bf16 v[80:95], v[40:43], a[172:175], v[80:95]
    v_mfma_f32_32x32x16_bf16 v[96:111], v[44:47], a[168:171], v[96:111]
    ds_read_b128 v[60:63], v9 offset:36864
    v_mfma_f32_32x32x16_bf16 v[112:127], v[44:47], a[172:175], v[112:127]
    s_waitcnt lgkmcnt(2)
    v_mfma_f32_32x32x16_bf16 v[64:79], v[48:51], a[176:179], v[64:79]
    v_mfma_f32_32x32x16_bf16 v[80:95], v[48:51], a[180:183], v[80:95]
    v_mfma_f32_32x32x16_bf16 v[96:111], v[52:55], a[176:179], v[96:111]
    v_mfma_f32_32x32x16_bf16 v[112:127], v[52:55], a[180:183], v[112:127]
    s_waitcnt lgkmcnt(0)
    v_mfma_f32_32x32x16_bf16 v[64:79], v[56:59], a[184:187], v[64:79]
    v_mfma_f32_32x32x16_bf16 v[80:95], v[56:59], a[188:191], v[80:95]
    v_mfma_f32_32x32x16_bf16 v[96:111], v[60:63], a[184:187], v[96:111]
    v_mfma_f32_32x32x16_bf16 v[112:127], v[60:63], a[188:191], v[112:127]
L_sk_91:
    s_waitcnt lgkmcnt(0)
    s_nop 7
    s_nop 7
    s_cmp_eq_u32 s3, 0
    s_cbranch_scc1 L_xw_92
    ds_write_b128 v212, v[64:67] offset:16384
    ds_write_b128 v212, v[68:71] offset:17408
    ds_write_b128 v212, v[72:75] offset:18432
    ds_write_b128 v212, v[76:79] offset:19456
L_xw_92:
    s_cmp_eq_u32 s3, 1
    s_cbranch_scc1 L_xw_93
    ds_write_b128 v212, v[80:83] offset:20480
    ds_write_b128 v212, v[84:87] offset:21504
    ds_write_b128 v212, v[88:91] offset:22528
    ds_write_b128 v212, v[92:95] offset:23552
L_xw_93:
    s_cmp_eq_u32 s3, 2
    s_cbranch_scc1 L_xw_94
    ds_write_b128 v212, v[96:99] offset:24576
    ds_write_b128 v212, v[100:103] offset:25600
    ds_write_b128 v212, v[104:107] offset:26624
    ds_write_b128 v212, v[108:111] offset:27648
L_xw_94:
    s_cmp_eq_u32 s3, 3
    s_cbranch_scc1 L_xw_95
    ds_write_b128 v212, v[112:115] offset:28672
    ds_write_b128 v212, v[116:119] offset:29696
    ds_write_b128 v212, v[120:123] offset:30720
    ds_write_b128 v212, v[124:127] offset:31744
L_xw_95:
    s_cmp_ge_u32 s3, 2
    s_cselect_b32 s43, 3, 2
    s_lshl_b32 s43, s43, 1
    s_and_b32 s44, s3, 1
    s_add_u32 s43, s43, s44
    s_lshl_b32 s43, s43, 12
    s_add_u32 s44, s3, 1
    s_and_b32 s44, s44, 3
    s_mul_i32 s44, s44, 40960
    s_add_u32 s44, s44, s43
    v_lshl_add_u32 v216, v1, 4, s44
    s_add_u32 s44, s3, 2
    s_and_b32 s44, s44, 3
    s_mul_i32 s44, s44, 40960
    s_add_u32 s44, s44, s43
    v_lshl_add_u32 v217, v1, 4, s44
    s_add_u32 s44, s3, 3
    s_and_b32 s44, s44, 3
    s_mul_i32 s44, s44, 40960
    s_add_u32 s44, s44, s43
    v_lshl_add_u32 v218, v1, 4, s44
    s_cmp_eq_u32 s3, 1
    s_cbranch_scc1 L_ow_98
    s_cmp_eq_u32 s3, 2
    s_cbranch_scc1 L_ow_99
    s_cmp_eq_u32 s3, 3
    s_cbranch_scc1 L_ow_100
L_ow_97:
    v_mov_b32 v240, v64
    v_mov_b32 v241, v65
    v_mov_b32 v242, v66
    v_mov_b32 v243, v67
    v_mov_b32 v244, v68
    v_mov_b32 v245, v69
    v_mov_b32 v246, v70
    v_mov_b32 v247, v71
    v_mov_b32 v248, v72
    v_mov_b32 v249, v73
    v_mov_b32 v250, v74
    v_mov_b32 v251, v75
    v_mov_b32 v252, v76
    v_mov_b32 v253, v77
    v_mov_b32 v254, v78
    v_mov_b32 v255, v79
    s_branch L_oe_96
L_ow_98:
    v_mov_b32 v240, v80
    v_mov_b32 v241, v81
    v_mov_b32 v242, v82
    v_mov_b32 v243, v83
    v_mov_b32 v244, v84
    v_mov_b32 v245, v85
    v_mov_b32 v246, v86
    v_mov_b32 v247, v87
    v_mov_b32 v248, v88
    v_mov_b32 v249, v89
    v_mov_b32 v250, v90
    v_mov_b32 v251, v91
    v_mov_b32 v252, v92
    v_mov_b32 v253, v93
    v_mov_b32 v254, v94
    v_mov_b32 v255, v95
    s_branch L_oe_96
L_ow_99:
    v_mov_b32 v240, v96
    v_mov_b32 v241, v97
    v_mov_b32 v242, v98
    v_mov_b32 v243, v99
    v_mov_b32 v244, v100
    v_mov_b32 v245, v101
    v_mov_b32 v246, v102
    v_mov_b32 v247, v103
    v_mov_b32 v248, v104
    v_mov_b32 v249, v105
    v_mov_b32 v250, v106
    v_mov_b32 v251, v107
    v_mov_b32 v252, v108
    v_mov_b32 v253, v109
    v_mov_b32 v254, v110
    v_mov_b32 v255, v111
    s_branch L_oe_96
L_ow_100:
    v_mov_b32 v240, v112
    v_mov_b32 v241, v113
    v_mov_b32 v242, v114
    v_mov_b32 v243, v115
    v_mov_b32 v244, v116
    v_mov_b32 v245, v117
    v_mov_b32 v246, v118
    v_mov_b32 v247, v119
    v_mov_b32 v248, v120
    v_mov_b32 v249, v121
    v_mov_b32 v250, v122
    v_mov_b32 v251, v123
    v_mov_b32 v252, v124
    v_mov_b32 v253, v125
    v_mov_b32 v254, v126
    v_mov_b32 v255, v127
L_oe_96:
    s_waitcnt lgkmcnt(0)
    s_barrier
    ds_read_b128 v[128:131], v213 offset:0
    ds_read_b128 v[132:135], v213 offset:1024
    ds_read_b128 v[136:139], v213 offset:2048
    ds_read_b128 v[140:143], v213 offset:3072
    ds_read_b128 v[144:147], v214 offset:0
    ds_read_b128 v[148:151], v214 offset:1024
    ds_read_b128 v[152:155], v214 offset:2048
    ds_read_b128 v[156:159], v214 offset:3072
    ds_read_b128 v[160:163], v215 offset:0
    ds_read_b128 v[164:167], v215 offset:1024
    ds_read_b128 v[168:171], v215 offset:2048
    ds_read_b128 v[172:175], v215 offset:3072
    ds_read_b128 v[64:67], v216 offset:0
    ds_read_b128 v[68:71], v216 offset:1024
    ds_read_b128 v[72:75], v216 offset:2048
    ds_read_b128 v[76:79], v216 offset:3072
    ds_read_b128 v[80:83], v217 offset:0
    ds_read_b128 v[84:87], v217 offset:1024
    ds_read_b128 v[88:91], v217 offset:2048
    ds_read_b128 v[92:95], v217 offset:3072
    ds_read_b128 v[96:99], v218 offset:0
    ds_read_b128 v[100:103], v218 offset:1024
    ds_read_b128 v[104:107], v218 offset:2048
    ds_read_b128 v[108:111], v218 offset:3072
    s_waitcnt lgkmcnt(12)
    v_add_f32 v224, v224, v128
    v_add_f32 v144, v144, v160
    v_add_f32 v225, v225, v129
    v_add_f32 v145, v145, v161
    v_add_f32 v226, v226, v130
    v_add_f32 v146, v146, v162
    v_add_f32 v227, v227, v131
    v_add_f32 v147, v147, v163
    v_add_f32 v228, v228, v132
    v_add_f32 v148, v148, v164
    v_add_f32 v229, v229, v133
    v_add_f32 v149, v149, v165
    v_add_f32 v230, v230, v134
    v_add_f32 v150, v150, v166
    v_add_f32 v231, v231, v135
    v_add_f32 v151, v151, v167
    v_add_f32 v232, v232, v136
    v_add_f32 v152, v152, v168
    v_add_f32 v233, v233, v137
    v_add_f32 v153, v153, v169
    v_add_f32 v234, v234, v138
    v_add_f32 v154, v154, v170
    v_add_f32 v235, v235, v139
    v_add_f32 v155, v155, v171
    v_add_f32 v236, v236, v140
    v_add_f32 v156, v156, v172
    v_add_f32 v237, v237, v141
    v_add_f32 v157, v157, v173
    v_add_f32 v238, v238, v142
    v_add_f32 v158, v158, v174
    v_add_f32 v239, v239, v143
    v_add_f32 v159, v159, v175
    v_add_f32 v224, v224, v144
    v_add_f32 v225, v225, v145
    v_add_f32 v226, v226, v146
    v_add_f32 v227, v227, v147
    v_add_f32 v228, v228, v148
    v_add_f32 v229, v229, v149
    v_add_f32 v230, v230, v150
    v_add_f32 v231, v231, v151
    v_add_f32 v232, v232, v152
    v_add_f32 v233, v233, v153
    v_add_f32 v234, v234, v154
    v_add_f32 v235, v235, v155
    v_add_f32 v236, v236, v156
    v_add_f32 v237, v237, v157
    v_add_f32 v238, v238, v158
    v_add_f32 v239, v239, v159
    s_waitcnt lgkmcnt(0)
    v_add_f32 v240, v240, v64
    v_add_f32 v80, v80, v96
    v_add_f32 v241, v241, v65
    v_add_f32 v81, v81, v97
    v_add_f32 v242, v242, v66
    v_add_f32 v82, v82, v98
    v_add_f32 v243, v243, v67
    v_add_f32 v83, v83, v99
    v_add_f32 v244, v244, v68
    v_add_f32 v84, v84, v100
    v_add_f32 v245, v245, v69
    v_add_f32 v85, v85, v101
    v_add_f32 v246, v246, v70
    v_add_f32 v86, v86, v102
    v_add_f32 v247, v247, v71
    v_add_f32 v87, v87, v103
    v_add_f32 v248, v248, v72
    v_add_f32 v88, v88, v104
    v_add_f32 v249, v249, v73
    v_add_f32 v89, v89, v105
    v_add_f32 v250, v250, v74
    v_add_f32 v90, v90, v106
    v_add_f32 v251, v251, v75
    v_add_f32 v91, v91, v107
    v_add_f32 v252, v252, v76
    v_add_f32 v92, v92, v108
    v_add_f32 v253, v253, v77
    v_add_f32 v93, v93, v109
    v_add_f32 v254, v254, v78
    v_add_f32 v94, v94, v110
    v_add_f32 v255, v255, v79
    v_add_f32 v95, v95, v111
    v_add_f32 v240, v240, v80
    v_add_f32 v241, v241, v81
    v_add_f32 v242, v242, v82
    v_add_f32 v243, v243, v83
    v_add_f32 v244, v244, v84
    v_add_f32 v245, v245, v85
    v_add_f32 v246, v246, v86
    v_add_f32 v247, v247, v87
    v_add_f32 v248, v248, v88
    v_add_f32 v249, v249, v89
    v_add_f32 v250, v250, v90
    v_add_f32 v251, v251, v91
    v_add_f32 v252, v252, v92
    v_add_f32 v253, v253, v93
    v_add_f32 v254, v254, v94
    v_add_f32 v255, v255, v95
    s_waitcnt vmcnt(0)
    v_lshlrev_b32 v208, 16, v208
    v_sub_f32 v210, 1.0, v209
    v_cvt_pk_bf16_f32 v210, v210, v210
    v_lshlrev_b32 v210, 16, v210
    v_lshlrev_b32 v23, 2, v22
    v_cvt_pk_bf16_f32 v32, v240, v241
    v_lshlrev_b32 v33, 16, v32
    v_and_b32 v32, 0xffff0000, v32
    v_add_f32 v33, v33, v208
    v_add_f32 v32, v32, v208
    v_cvt_pk_bf16_f32 v32, v33, v32
    v_lshlrev_b32 v33, 16, v32
    v_and_b32 v32, 0xffff0000, v32
    v_mul_f32 v33, v33, v210
    v_mul_f32 v32, v32, v210
    v_cvt_pk_bf16_f32 v32, v33, v32
    v_lshlrev_b32 v240, 16, v32
    v_and_b32 v241, 0xffff0000, v32
    v_lshlrev_b32 v33, 16, v192
    v_and_b32 v32, 0xffff0000, v192
    v_lshlrev_b32 v34, 16, v200
    v_and_b32 v35, 0xffff0000, v200
    v_mul_f32 v33, v33, v34
    v_mul_f32 v32, v32, v35
    v_cvt_pk_bf16_f32 v32, v33, v32
    v_lshlrev_b32 v33, 16, v32
    v_and_b32 v32, 0xffff0000, v32
    v_fma_f32 v33, 2.0, v224, v33
    v_fma_f32 v32, 2.0, v225, v32
    v_mul_f32 v33, v33, v209
    v_mul_f32 v32, v32, v209
    v_add_f32 v240, v240, v33
    v_add_f32 v241, v241, v32
    v_cvt_pk_bf16_f32 v32, v242, v243
    v_lshlrev_b32 v33, 16, v32
    v_and_b32 v32, 0xffff0000, v32
    v_add_f32 v33, v33, v208
    v_add_f32 v32, v32, v208
    v_cvt_pk_bf16_f32 v32, v33, v32
    v_lshlrev_b32 v33, 16, v32
    v_and_b32 v32, 0xffff0000, v32
    v_mul_f32 v33, v33, v210
    v_mul_f32 v32, v32, v210
    v_cvt_pk_bf16_f32 v32, v33, v32
    v_lshlrev_b32 v242, 16, v32
    v_and_b32 v243, 0xffff0000, v32
    v_lshlrev_b32 v33, 16, v193
    v_and_b32 v32, 0xffff0000, v193
    v_lshlrev_b32 v34, 16, v201
    v_and_b32 v35, 0xffff0000, v201
    v_mul_f32 v33, v33, v34
    v_mul_f32 v32, v32, v35
    v_cvt_pk_bf16_f32 v32, v33, v32
    v_lshlrev_b32 v33, 16, v32
    v_and_b32 v32, 0xffff0000, v32
    v_fma_f32 v33, 2.0, v226, v33
    v_fma_f32 v32, 2.0, v227, v32
    v_mul_f32 v33, v33, v209
    v_mul_f32 v32, v32, v209
    v_add_f32 v242, v242, v33
    v_add_f32 v243, v243, v32
    buffer_store_dwordx4 v[240:243], v23, s[32:35], 0 offen offset:0
    v_cvt_pk_bf16_f32 v32, v244, v245
    v_lshlrev_b32 v33, 16, v32
    v_and_b32 v32, 0xffff0000, v32
    v_add_f32 v33, v33, v208
    v_add_f32 v32, v32, v208
    v_cvt_pk_bf16_f32 v32, v33, v32
    v_lshlrev_b32 v33, 16, v32
    v_and_b32 v32, 0xffff0000, v32
    v_mul_f32 v33, v33, v210
    v_mul_f32 v32, v32, v210
    v_cvt_pk_bf16_f32 v32, v33, v32
    v_lshlrev_b32 v244, 16, v32
    v_and_b32 v245, 0xffff0000, v32
    v_lshlrev_b32 v33, 16, v194
    v_and_b32 v32, 0xffff0000, v194
    v_lshlrev_b32 v34, 16, v202
    v_and_b32 v35, 0xffff0000, v202
    v_mul_f32 v33, v33, v34
    v_mul_f32 v32, v32, v35
    v_cvt_pk_bf16_f32 v32, v33, v32
    v_lshlrev_b32 v33, 16, v32
    v_and_b32 v32, 0xffff0000, v32
    v_fma_f32 v33, 2.0, v228, v33
    v_fma_f32 v32, 2.0, v229, v32
    v_mul_f32 v33, v33, v209
    v_mul_f32 v32, v32, v209
    v_add_f32 v244, v244, v33
    v_add_f32 v245, v245, v32
    v_cvt_pk_bf16_f32 v32, v246, v247
    v_lshlrev_b32 v33, 16, v32
    v_and_b32 v32, 0xffff0000, v32
    v_add_f32 v33, v33, v208
    v_add_f32 v32, v32, v208
    v_cvt_pk_bf16_f32 v32, v33, v32
    v_lshlrev_b32 v33, 16, v32
    v_and_b32 v32, 0xffff0000, v32
    v_mul_f32 v33, v33, v210
    v_mul_f32 v32, v32, v210
    v_cvt_pk_bf16_f32 v32, v33, v32
    v_lshlrev_b32 v246, 16, v32
    v_and_b32 v247, 0xffff0000, v32
    v_lshlrev_b32 v33, 16, v195
    v_and_b32 v32, 0xffff0000, v195
    v_lshlrev_b32 v34, 16, v203
    v_and_b32 v35, 0xffff0000, v203
    v_mul_f32 v33, v33, v34
    v_mul_f32 v32, v32, v35
    v_cvt_pk_bf16_f32 v32, v33, v32
    v_lshlrev_b32 v33, 16, v32
    v_and_b32 v32, 0xffff0000, v32
    v_fma_f32 v33, 2.0, v230, v33
    v_fma_f32 v32, 2.0, v231, v32
    v_mul_f32 v33, v33, v209
    v_mul_f32 v32, v32, v209
    v_add_f32 v246, v246, v33
    v_add_f32 v247, v247, v32
    buffer_store_dwordx4 v[244:247], v23, s[32:35], 0 offen offset:32
    v_cvt_pk_bf16_f32 v32, v248, v249
    v_lshlrev_b32 v33, 16, v32
    v_and_b32 v32, 0xffff0000, v32
    v_add_f32 v33, v33, v208
    v_add_f32 v32, v32, v208
    v_cvt_pk_bf16_f32 v32, v33, v32
    v_lshlrev_b32 v33, 16, v32
    v_and_b32 v32, 0xffff0000, v32
    v_mul_f32 v33, v33, v210
    v_mul_f32 v32, v32, v210
    v_cvt_pk_bf16_f32 v32, v33, v32
    v_lshlrev_b32 v248, 16, v32
    v_and_b32 v249, 0xffff0000, v32
    v_lshlrev_b32 v33, 16, v196
    v_and_b32 v32, 0xffff0000, v196
    v_lshlrev_b32 v34, 16, v204
    v_and_b32 v35, 0xffff0000, v204
    v_mul_f32 v33, v33, v34
    v_mul_f32 v32, v32, v35
    v_cvt_pk_bf16_f32 v32, v33, v32
    v_lshlrev_b32 v33, 16, v32
    v_and_b32 v32, 0xffff0000, v32
    v_fma_f32 v33, 2.0, v232, v33
    v_fma_f32 v32, 2.0, v233, v32
    v_mul_f32 v33, v33, v209
    v_mul_f32 v32, v32, v209
    v_add_f32 v248, v248, v33
    v_add_f32 v249, v249, v32
    v_cvt_pk_bf16_f32 v32, v250, v251
    v_lshlrev_b32 v33, 16, v32
    v_and_b32 v32, 0xffff0000, v32
    v_add_f32 v33, v33, v208
    v_add_f32 v32, v32, v208
    v_cvt_pk_bf16_f32 v32, v33, v32
    v_lshlrev_b32 v33, 16, v32
    v_and_b32 v32, 0xffff0000, v32
    v_mul_f32 v33, v33, v210
    v_mul_f32 v32, v32, v210
    v_cvt_pk_bf16_f32 v32, v33, v32
    v_lshlrev_b32 v250, 16, v32
    v_and_b32 v251, 0xffff0000, v32
    v_lshlrev_b32 v33, 16, v197
    v_and_b32 v32, 0xffff0000, v197
    v_lshlrev_b32 v34, 16, v205
    v_and_b32 v35, 0xffff0000, v205
    v_mul_f32 v33, v33, v34
    v_mul_f32 v32, v32, v35
    v_cvt_pk_bf16_f32 v32, v33, v32
    v_lshlrev_b32 v33, 16, v32
    v_and_b32 v32, 0xffff0000, v32
    v_fma_f32 v33, 2.0, v234, v33
    v_fma_f32 v32, 2.0, v235, v32
    v_mul_f32 v33, v33, v209
    v_mul_f32 v32, v32, v209
    v_add_f32 v250, v250, v33
    v_add_f32 v251, v251, v32
    buffer_store_dwordx4 v[248:251], v23, s[32:35], 0 offen offset:64
    v_cvt_pk_bf16_f32 v32, v252, v253
    v_lshlrev_b32 v33, 16, v32
    v_and_b32 v32, 0xffff0000, v32
    v_add_f32 v33, v33, v208
    v_add_f32 v32, v32, v208
    v_cvt_pk_bf16_f32 v32, v33, v32
    v_lshlrev_b32 v33, 16, v32
    v_and_b32 v32, 0xffff0000, v32
    v_mul_f32 v33, v33, v210
    v_mul_f32 v32, v32, v210
    v_cvt_pk_bf16_f32 v32, v33, v32
    v_lshlrev_b32 v252, 16, v32
    v_and_b32 v253, 0xffff0000, v32
    v_lshlrev_b32 v33, 16, v198
    v_and_b32 v32, 0xffff0000, v198
    v_lshlrev_b32 v34, 16, v206
    v_and_b32 v35, 0xffff0000, v206
    v_mul_f32 v33, v33, v34
    v_mul_f32 v32, v32, v35
    v_cvt_pk_bf16_f32 v32, v33, v32
    v_lshlrev_b32 v33, 16, v32
    v_and_b32 v32, 0xffff0000, v32
    v_fma_f32 v33, 2.0, v236, v33
    v_fma_f32 v32, 2.0, v237, v32
    v_mul_f32 v33, v33, v209
    v_mul_f32 v32, v32, v209
    v_add_f32 v252, v252, v33
    v_add_f32 v253, v253, v32
    v_cvt_pk_bf16_f32 v32, v254, v255
    v_lshlrev_b32 v33, 16, v32
    v_and_b32 v32, 0xffff0000, v32
    v_add_f32 v33, v33, v208
    v_add_f32 v32, v32, v208
    v_cvt_pk_bf16_f32 v32, v33, v32
    v_lshlrev_b32 v33, 16, v32
    v_and_b32 v32, 0xffff0000, v32
    v_mul_f32 v33, v33, v210
    v_mul_f32 v32, v32, v210
    v_cvt_pk_bf16_f32 v32, v33, v32
    v_lshlrev_b32 v254, 16, v32
    v_and_b32 v255, 0xffff0000, v32
    v_lshlrev_b32 v33, 16, v199
    v_and_b32 v32, 0xffff0000, v199
    v_lshlrev_b32 v34, 16, v207
    v_and_b32 v35, 0xffff0000, v207
    v_mul_f32 v33, v33, v34
    v_mul_f32 v32, v32, v35
    v_cvt_pk_bf16_f32 v32, v33, v32
    v_lshlrev_b32 v33, 16, v32
    v_and_b32 v32, 0xffff0000, v32
    v_fma_f32 v33, 2.0, v238, v33
    v_fma_f32 v32, 2.0, v239, v32
    v_mul_f32 v33, v33, v209
    v_mul_f32 v32, v32, v209
    v_add_f32 v254, v254, v33
    v_add_f32 v255, v255, v32
    buffer_store_dwordx4 v[252:255], v23, s[32:35], 0 offen offset:96
    s_endpgm
L_end:
    s_endpgm
.section .rodata,"a"
.p2align 6
.amdhsa_kernel gated_mix__ssm_conv_s5__mixer_token_mlp__prompt_kernel
  .amdhsa_next_free_vgpr 512
  .amdhsa_next_free_sgpr 102
  .amdhsa_accum_offset 256
  .amdhsa_group_segment_fixed_size 0
  .amdhsa_kernarg_size 144
  .amdhsa_user_sgpr_count 2
  .amdhsa_user_sgpr_kernarg_segment_ptr 1
  .amdhsa_system_sgpr_workgroup_id_x 1
.end_amdhsa_kernel
```
